```python
import torch

def _softmax(x, axis=-1):
    return torch.softmax(x, dim=axis)

def _gelu(x):
    return torch.nn.functional.gelu(x, approximate='tanh')

def _silu(x):
    return torch.nn.functional.silu(x)

def _sigmoid(x):
    return torch.sigmoid(x)

def _layernorm(x, axis=-1, eps=1e-05):
    m = x.mean(dim=axis, keepdim=True)
    v = x.var(dim=axis, keepdim=True, unbiased=False)
    return (x - m) / torch.sqrt(v + eps)

def _scatter_add(tgt, idx, src, axis=0):
    return tgt.clone().index_add_(axis, idx, src)

def _segment_sum(src, seg, n):
    out = torch.zeros((n,) + src.shape[1:], dtype=src.dtype)
    return out.index_add_(0, seg, src)

def _pad(x, pw):
    flat = tuple((v for pair in reversed(pw) for v in pair))
    return torch.nn.functional.pad(x, flat)
kernel_name = 'standalone__autoregressive_conv_wavernn__speech'

def setup_inputs():

    _w = lambda a: (lambda t: t.to(torch.bfloat16) if t.is_floating_point() else t)(torch.as_tensor(a))
    B, T, D, K = (2, 16000, 512, 5)
    return {'x': _w((lambda *s: torch.randn(*s, dtype=torch.bfloat16) * 0.05)(B, T, D)), 'w': _w((lambda *s: torch.randn(*s, dtype=torch.bfloat16) * 0.05)(K, D, 2 * D))}

def reference(x, w):
    B, T, D = x.shape
    K = w.shape[0]
    dil = 2
    pad = (K - 1) * dil
    xp = _pad(x, ((0, 0), (pad, 0), (0, 0)))
    h = torch.einsum('btd,de->bte', xp[:, 0:T, :], w[0])
    for i in range(1, K):
        h = h + torch.einsum('btd,de->bte', xp[:, i * dil:i * dil + T, :], w[i])
    f, g = (h[..., :D].clone(), h[..., D:].clone())
    return torch.tanh(f) * _sigmoid(g)
```

```asm
; @launch kernel=wprep_kernel grid=(256,1,1) block=(256,1,1) lds=0
; @launch kernel=standalone__autoregressive_conv_wavernn__speech_kernel grid=(256,1,1) block=(256,1,1) lds=131072
.amdgcn_target "amdgcn-amd-amdhsa--gfx950"
.text
.globl standalone__autoregressive_conv_wavernn__speech_kernel
.p2align 8
.type standalone__autoregressive_conv_wavernn__speech_kernel,@function
standalone__autoregressive_conv_wavernn__speech_kernel:
 s_cmp_ge_u32 s2, 256
 s_cbranch_scc1 L_END
 s_load_dwordx8 s[4:11], s[0:1], 0
 s_load_dwordx2 s[12:13], s[0:1], 32
 v_lshrrev_b32 v1, 6, v0
 v_and_b32 v11, 63, v0
 s_nop 0
 v_readfirstlane_b32 s28, v1
 s_and_b32 s80, s2, 7
 s_lshr_b32 s81, s2, 3
 s_and_b32 s82, s80, 1
 s_lshl_b32 s82, s82, 1
 s_and_b32 s29, s81, 1
 s_add_u32 s29, s29, s82
 s_lshr_b32 s80, s80, 1
 s_lshr_b32 s81, s81, 1
 s_mul_i32 s82, s80, 31
 s_and_b32 s83, s29, 1
 s_sub_u32 s83, 3, s83
 s_cmp_gt_u32 s80, s83
 s_cselect_b32 s14, 1, 0
 s_add_u32 s82, s82, s14
 s_add_u32 s15, s82, s81
 s_cmp_eq_u32 s80, s83
 s_cselect_b32 s83, 16, 15
 s_cmp_lt_u32 s81, s83
 s_cselect_b32 s30, 2, 1
 s_cselect_b32 s81, 16, 0
 s_add_u32 s14, s15, s81
 s_mov_b32 s48, 0
 s_mov_b32 s49, 4096
 s_mov_b32 s50, 8192
 s_mov_b32 s51, 12288
 s_mov_b32 s52, 16384
 s_mov_b32 s53, 20480
 s_mov_b32 s54, 24576
 s_mov_b32 s55, 28672
 s_mov_b32 s56, 32768
 s_mov_b32 s57, 36864
 s_mov_b32 s47, -768
 s_mov_b32 s58, 256
 s_mov_b32 s59, 2048
 s_lshl_b32 s44, s15, 8
 s_and_b32 s45, s28, 1
 s_lshl_b32 s46, s45, 7
 s_add_u32 s44, s44, s46
 v_lshrrev_b32 v28, 3, v11
 v_lshlrev_b32 v29, 4, v28
 v_add_u32 v29, s44, v29
 v_lshlrev_b32 v30, 1, v29
 v_cmp_le_u32 vcc, 8000, v29
 v_mov_b32 v31, 15999
 s_nop 1
 v_cndmask_b32 v31, 0, v31, vcc
 v_sub_u32 v30, v30, v31
 v_cmp_le_u32 vcc, 16000, v29
 v_mov_b32 v31, 1
 s_nop 1
 v_cndmask_b32 v31, 0, v31, vcc
 v_sub_u32 v30, v30, v31
 v_cmp_le_u32 vcc, 24000, v29
 v_mov_b32 v31, 15999
 s_nop 1
 v_cndmask_b32 v31, 0, v31, vcc
 v_sub_u32 v30, v30, v31
 v_lshlrev_b32 v30, 10, v30
 s_mul_i32 s45, s45, 3
 v_and_b32 v31, 7, v11
 v_xor_b32 v31, s45, v31
 v_lshlrev_b32 v31, 4, v31
 s_lshr_b32 s45, s28, 1
 s_lshl_b32 s45, s45, 7
 v_add3_u32 v2, v30, v31, s45
 v_mov_b32 v3, v2
 v_mov_b32 v32, 0x70000000
 v_cmp_eq_u32 vcc, 0, v29
 s_nop 1
 v_cndmask_b32 v3, v3, v32, vcc
 v_cmp_eq_u32 vcc, 8000, v29
 s_nop 1
 v_cndmask_b32 v3, v3, v32, vcc
 v_cmp_eq_u32 vcc, 16000, v29
 s_nop 1
 v_cndmask_b32 v3, v3, v32, vcc
 v_cmp_eq_u32 vcc, 24000, v29
 s_nop 1
 v_cndmask_b32 v3, v3, v32, vcc
 s_waitcnt lgkmcnt(0)
 s_sub_u32 s16, s4, 8192
 s_subb_u32 s17, s5, 0
 s_and_b32 s17, s17, 0xffff
 s_mov_b32 s18, 32776192
 s_mov_b32 s19, 0x00020000
 buffer_load_dwordx4 v[112:115], v3, s[16:19], s48 offen offset:2048
 buffer_load_dwordx4 v[116:119], v3, s[16:19], s49 offen offset:0
 buffer_load_dwordx4 v[120:123], v3, s[16:19], s49 offen offset:2048
 buffer_load_dwordx4 v[124:127], v2, s[16:19], s50 offen offset:0
 buffer_load_dwordx4 v[128:131], v2, s[16:19], s50 offen offset:2048
 buffer_load_dwordx4 v[132:135], v2, s[16:19], s51 offen offset:0
 buffer_load_dwordx4 v[136:139], v2, s[16:19], s51 offen offset:2048
 buffer_load_dwordx4 v[140:143], v2, s[16:19], s52 offen offset:0
 buffer_load_dwordx4 v[144:147], v2, s[16:19], s52 offen offset:2048
 buffer_load_dwordx4 v[148:151], v2, s[16:19], s53 offen offset:0
 buffer_load_dwordx4 v[152:155], v2, s[16:19], s53 offen offset:2048
 buffer_load_dwordx4 v[156:159], v2, s[16:19], s54 offen offset:0
 buffer_load_dwordx4 v[160:163], v2, s[16:19], s54 offen offset:2048
 buffer_load_dwordx4 v[164:167], v2, s[16:19], s55 offen offset:0
 buffer_load_dwordx4 v[168:171], v2, s[16:19], s55 offen offset:2048
 buffer_load_dwordx4 v[172:175], v2, s[16:19], s56 offen offset:0
 buffer_load_dwordx4 v[176:179], v2, s[16:19], s56 offen offset:2048
 buffer_load_dwordx4 v[180:183], v2, s[16:19], s57 offen offset:0
 v_lshlrev_b32 v1, 4, v11
 s_lshl_b32 s44, s29, 2
 s_and_b32 s45, s28, 3
 s_add_u32 s44, s44, s45
 s_lshl_b32 s44, s44, 19
 s_add_u32 s20, s12, s44
 s_addc_u32 s21, s13, 0
 s_and_b32 s21, s21, 0xffff
 s_mov_b32 s22, 32768
 s_mov_b32 s23, 0x00020000
 buffer_load_dwordx4 a[112:115], v1, s[20:23], s48 offen offset:0
 buffer_load_dwordx4 a[116:119], v1, s[20:23], s48 offen offset:1024
 buffer_load_dwordx4 a[120:123], v1, s[20:23], s48 offen offset:2048
 buffer_load_dwordx4 a[124:127], v1, s[20:23], s48 offen offset:3072
 buffer_load_dwordx4 a[128:131], v1, s[20:23], s49 offen offset:0
 buffer_load_dwordx4 a[132:135], v1, s[20:23], s49 offen offset:1024
 buffer_load_dwordx4 a[136:139], v1, s[20:23], s49 offen offset:2048
 buffer_load_dwordx4 a[140:143], v1, s[20:23], s49 offen offset:3072
 s_mov_b32 s24, s8
 s_and_b32 s25, s9, 0xffff
 s_mov_b32 s26, 32768000
 s_mov_b32 s27, 0x00020000
 s_mov_b32 s60, 0x4038aa3b
 s_mov_b32 s62, 0xbfb8aa3b
 s_mov_b32 s64, 0x3f76384f
 s_mov_b32 s66, 0xbef6384f
 s_mov_b32 s68, 0x3ff6384f
 s_mov_b32 s70, 0xbf76384f
 s_mov_b32 s72, 0x3f000000
 s_mov_b32 s78, 0xc0800000
 s_mov_b32 s80, 0x3e2aaaab
 s_mov_b32 s82, 0x3faaaaab
 s_mov_b32 s39, 0xc0880000
 s_mov_b32 s40, 0xc0a00000
 s_mov_b32 s41, 0x40a80000
 s_mov_b32 s42, 0xbfa00000
 s_mov_b32 s43, 0x3e800000
 s_mov_b32 s35, 0x42200000
 s_mov_b32 s34, 0xffff0000
 s_mov_b32 s84, -491520
 s_mov_b32 s32, 0
 s_lshl_b32 s44, s14, 8
 s_and_b32 s45, s28, 1
 s_lshl_b32 s46, s45, 7
 s_add_u32 s44, s44, s46
 v_lshrrev_b32 v28, 3, v11
 v_lshlrev_b32 v29, 4, v28
 v_add_u32 v29, s44, v29
 v_lshlrev_b32 v30, 1, v29
 v_cmp_le_u32 vcc, 8000, v29
 v_mov_b32 v31, 15999
 s_nop 1
 v_cndmask_b32 v31, 0, v31, vcc
 v_sub_u32 v30, v30, v31
 v_cmp_le_u32 vcc, 16000, v29
 v_mov_b32 v31, 1
 s_nop 1
 v_cndmask_b32 v31, 0, v31, vcc
 v_sub_u32 v30, v30, v31
 v_cmp_le_u32 vcc, 24000, v29
 v_mov_b32 v31, 15999
 s_nop 1
 v_cndmask_b32 v31, 0, v31, vcc
 v_sub_u32 v30, v30, v31
 v_lshlrev_b32 v30, 10, v30
 s_mul_i32 s45, s45, 3
 v_and_b32 v31, 7, v11
 v_xor_b32 v31, s45, v31
 v_lshlrev_b32 v31, 4, v31
 s_lshr_b32 s45, s28, 1
 s_lshl_b32 s45, s45, 7
 v_add3_u32 v5, v30, v31, s45
 v_mov_b32 v6, v5
 v_mov_b32 v32, 0x70000000
 v_cmp_eq_u32 vcc, 0, v29
 s_nop 1
 v_cndmask_b32 v6, v6, v32, vcc
 v_cmp_eq_u32 vcc, 8000, v29
 s_nop 1
 v_cndmask_b32 v6, v6, v32, vcc
 v_cmp_eq_u32 vcc, 16000, v29
 s_nop 1
 v_cndmask_b32 v6, v6, v32, vcc
 v_cmp_eq_u32 vcc, 24000, v29
 s_nop 1
 v_cndmask_b32 v6, v6, v32, vcc
 s_lshl_b32 s44, s15, 8
 v_and_b32 v28, 15, v11
 v_lshlrev_b32 v29, 4, v28
 v_add_u32 v29, s44, v29
 v_lshlrev_b32 v30, 1, v29
 v_cmp_le_u32 vcc, 8000, v29
 v_mov_b32 v31, 15999
 s_nop 1
 v_cndmask_b32 v31, 0, v31, vcc
 v_sub_u32 v30, v30, v31
 v_cmp_le_u32 vcc, 16000, v29
 v_mov_b32 v31, 1
 s_nop 1
 v_cndmask_b32 v31, 0, v31, vcc
 v_sub_u32 v30, v30, v31
 v_cmp_le_u32 vcc, 24000, v29
 v_mov_b32 v31, 15999
 s_nop 1
 v_cndmask_b32 v31, 0, v31, vcc
 v_sub_u32 v30, v30, v31
 v_lshlrev_b32 v30, 10, v30
 v_lshrrev_b32 v31, 4, v11
 v_lshlrev_b32 v31, 4, v31
 v_add_u32 v30, v30, v31
 s_lshl_b32 s45, s29, 8
 s_lshl_b32 s46, s28, 6
 s_add_u32 s45, s45, s46
 v_add_u32 v9, s45, v30
 s_lshl_b32 s44, s14, 8
 v_and_b32 v28, 15, v11
 v_lshlrev_b32 v29, 4, v28
 v_add_u32 v29, s44, v29
 v_lshlrev_b32 v30, 1, v29
 v_cmp_le_u32 vcc, 8000, v29
 v_mov_b32 v31, 15999
 s_nop 1
 v_cndmask_b32 v31, 0, v31, vcc
 v_sub_u32 v30, v30, v31
 v_cmp_le_u32 vcc, 16000, v29
 v_mov_b32 v31, 1
 s_nop 1
 v_cndmask_b32 v31, 0, v31, vcc
 v_sub_u32 v30, v30, v31
 v_cmp_le_u32 vcc, 24000, v29
 v_mov_b32 v31, 15999
 s_nop 1
 v_cndmask_b32 v31, 0, v31, vcc
 v_sub_u32 v30, v30, v31
 v_lshlrev_b32 v30, 10, v30
 v_lshrrev_b32 v31, 4, v11
 v_lshlrev_b32 v31, 4, v31
 v_add_u32 v30, v30, v31
 s_lshl_b32 s45, s29, 8
 s_lshl_b32 s46, s28, 6
 s_add_u32 s45, s45, s46
 v_add_u32 v10, s45, v30
 s_lshl_b32 s44, s14, 8
 s_lshl_b32 s45, s29, 6
 s_add_u32 s44, s44, s45
 s_lshl_b32 s45, s28, 4
 s_add_u32 s44, s44, s45
 v_lshrrev_b32 v29, 3, v11
 v_add_u32 v29, s44, v29
 v_lshlrev_b32 v30, 1, v29
 v_cmp_le_u32 vcc, 8000, v29
 v_mov_b32 v31, 15999
 s_nop 1
 v_cndmask_b32 v31, 0, v31, vcc
 v_sub_u32 v30, v30, v31
 v_cmp_le_u32 vcc, 16000, v29
 v_mov_b32 v31, 1
 s_nop 1
 v_cndmask_b32 v31, 0, v31, vcc
 v_sub_u32 v30, v30, v31
 v_cmp_le_u32 vcc, 24000, v29
 v_mov_b32 v31, 15999
 s_nop 1
 v_cndmask_b32 v31, 0, v31, vcc
 v_sub_u32 v30, v30, v31
 v_lshlrev_b32 v30, 10, v30
 v_and_b32 v28, 7, v11
 v_lshlrev_b32 v28, 7, v28
 v_add3_u32 v108, v30, v28, s50
 v_mov_b32 v28, 0x70000000
 v_cmp_gt_u32 vcc, 32, v11
 s_nop 1
 v_cndmask_b32 v108, v28, v108, vcc
 s_lshr_b32 s44, s28, 1
 s_lshl_b32 s44, s44, 15
 s_and_b32 s45, s28, 1
 s_lshl_b32 s45, s45, 9
 s_add_u32 s44, s44, s45
 v_bfe_u32 v28, v11, 2, 1
 v_lshlrev_b32 v28, 14, v28
 v_lshrrev_b32 v29, 3, v11
 v_lshl_add_u32 v28, v29, 6, v28
 v_and_b32 v29, 3, v11
 v_lshl_add_u32 v28, v29, 4, v28
 v_add_u32 v8, s44, v28
 v_and_b32 v28, 15, v11
 v_lshrrev_b32 v29, 3, v28
 v_mul_u32_u24 v29, 3, v29
 v_lshrrev_b32 v30, 4, v11
 v_xor_b32 v29, v29, v30
 v_lshlrev_b32 v28, 2, v28
 v_add_u32 v28, v28, v29
 v_lshlrev_b32 v28, 4, v28
 v_xor_b32 v7, 0x10000, v28
 s_mov_b32 s74, 0xc0880000
 s_mov_b32 s76, 0xc0a00000
 s_waitcnt vmcnt(24)
 v_lshlrev_b32 v184, 16, v112
 v_and_b32 v185, s34, v112
 v_lshlrev_b32 v186, 16, v113
 v_and_b32 v187, s34, v113
 v_lshlrev_b32 v188, 16, v114
 v_and_b32 v189, s34, v114
 v_lshlrev_b32 v190, 16, v115
 v_and_b32 v191, s34, v115
 v_lshlrev_b32 v192, 16, v116
 v_and_b32 v193, s34, v116
 v_lshlrev_b32 v194, 16, v117
 v_and_b32 v195, s34, v117
 v_lshlrev_b32 v196, 16, v118
 v_and_b32 v197, s34, v118
 v_lshlrev_b32 v198, 16, v119
 v_and_b32 v199, s34, v119
 s_add_u32 s32, s32, 1
 s_and_b32 s44, s32, 3
 s_cmp_eq_u32 s44, 0
 s_cselect_b32 s38, s47, s58
 v_add_u32 v2, s38, v2
 v_add_u32 v3, s38, v3
 s_cmp_lg_u32 s32, 8
 s_cbranch_scc1 LS1_a
 s_mov_b32 s32, 0
 v_mov_b32 v2, v5
 v_mov_b32 v3, v6
LS1_a:
 s_cmp_lt_u32 s32, 4
 s_cselect_b32 s33, s59, 0
 v_mov_b32 v4, v2
 s_cbranch_scc1 LS1_b
 v_mov_b32 v4, v3
LS1_b:
 s_waitcnt vmcnt(22)
 v_lshlrev_b32 v200, 16, v120
 v_and_b32 v201, s34, v120
 v_lshlrev_b32 v202, 16, v121
 v_and_b32 v203, s34, v121
 v_lshlrev_b32 v204, 16, v122
 v_and_b32 v205, s34, v122
 v_lshlrev_b32 v206, 16, v123
 v_and_b32 v207, s34, v123
 v_lshlrev_b32 v208, 16, v124
 v_and_b32 v209, s34, v124
 v_lshlrev_b32 v210, 16, v125
 v_and_b32 v211, s34, v125
 v_lshlrev_b32 v212, 16, v126
 v_and_b32 v213, s34, v126
 v_lshlrev_b32 v214, 16, v127
 v_and_b32 v215, s34, v127
 s_waitcnt vmcnt(20)
 v_lshlrev_b32 v216, 16, v128
 v_and_b32 v217, s34, v128
 v_lshlrev_b32 v218, 16, v129
 v_and_b32 v219, s34, v129
 v_lshlrev_b32 v220, 16, v130
 v_and_b32 v221, s34, v130
 v_lshlrev_b32 v222, 16, v131
 v_and_b32 v223, s34, v131
 v_lshlrev_b32 v224, 16, v132
 v_and_b32 v225, s34, v132
 v_lshlrev_b32 v226, 16, v133
 v_and_b32 v227, s34, v133
 v_lshlrev_b32 v228, 16, v134
 v_and_b32 v229, s34, v134
 v_lshlrev_b32 v230, 16, v135
 v_and_b32 v231, s34, v135
 buffer_load_dwordx4 v[68:71], v3, s[16:19], s33 offen offset:0
 buffer_load_dwordx4 v[72:75], v3, s[16:19], s33 offen offset:2048
 s_add_u32 s33, s33, 4096
 buffer_load_dwordx4 v[76:79], v3, s[16:19], s33 offen offset:0
 buffer_load_dwordx4 v[80:83], v4, s[16:19], s33 offen offset:2048
 s_add_u32 s33, s33, 4096
 buffer_load_dwordx4 v[84:87], v2, s[16:19], s33 offen offset:0
 buffer_load_dwordx4 v[88:91], v2, s[16:19], s33 offen offset:2048
 v_pk_fma_f32 v[232:233], v[208:209], s[74:75], v[224:225] op_sel_hi:[1,0,1]
 v_pk_fma_f32 v[234:235], v[210:211], s[74:75], v[226:227] op_sel_hi:[1,0,1]
 v_pk_fma_f32 v[236:237], v[212:213], s[74:75], v[228:229] op_sel_hi:[1,0,1]
 v_pk_fma_f32 v[238:239], v[214:215], s[74:75], v[230:231] op_sel_hi:[1,0,1]
 v_pk_fma_f32 v[240:241], v[200:201], s[74:75], v[216:217] op_sel_hi:[1,0,1]
 v_pk_fma_f32 v[242:243], v[202:203], s[74:75], v[218:219] op_sel_hi:[1,0,1]
 v_pk_fma_f32 v[244:245], v[204:205], s[74:75], v[220:221] op_sel_hi:[1,0,1]
 v_pk_fma_f32 v[246:247], v[206:207], s[74:75], v[222:223] op_sel_hi:[1,0,1]
 v_pk_fma_f32 v[208:209], v[208:209], s[76:77], v[224:225] op_sel_hi:[1,0,1]
 v_pk_fma_f32 v[210:211], v[210:211], s[76:77], v[226:227] op_sel_hi:[1,0,1]
 v_pk_fma_f32 v[212:213], v[212:213], s[76:77], v[228:229] op_sel_hi:[1,0,1]
 v_pk_fma_f32 v[214:215], v[214:215], s[76:77], v[230:231] op_sel_hi:[1,0,1]
 v_pk_fma_f32 v[200:201], v[200:201], s[76:77], v[216:217] op_sel_hi:[1,0,1]
 v_pk_fma_f32 v[202:203], v[202:203], s[76:77], v[218:219] op_sel_hi:[1,0,1]
 v_pk_fma_f32 v[204:205], v[204:205], s[76:77], v[220:221] op_sel_hi:[1,0,1]
 v_pk_fma_f32 v[206:207], v[206:207], s[76:77], v[222:223] op_sel_hi:[1,0,1]
 v_pk_add_f32 v[232:233], v[232:233], v[192:193]
 v_pk_add_f32 v[234:235], v[234:235], v[194:195]
 v_pk_add_f32 v[236:237], v[236:237], v[196:197]
 v_pk_add_f32 v[238:239], v[238:239], v[198:199]
 v_pk_add_f32 v[240:241], v[240:241], v[184:185]
 v_pk_add_f32 v[242:243], v[242:243], v[186:187]
 v_pk_add_f32 v[244:245], v[244:245], v[188:189]
 v_pk_add_f32 v[246:247], v[246:247], v[190:191]
 v_pk_fma_f32 v[208:209], v[192:193], 4.0, v[208:209] op_sel_hi:[1,0,1]
 v_pk_fma_f32 v[210:211], v[194:195], 4.0, v[210:211] op_sel_hi:[1,0,1]
 v_pk_fma_f32 v[212:213], v[196:197], 4.0, v[212:213] op_sel_hi:[1,0,1]
 v_pk_fma_f32 v[214:215], v[198:199], 4.0, v[214:215] op_sel_hi:[1,0,1]
 v_pk_fma_f32 v[200:201], v[184:185], 4.0, v[200:201] op_sel_hi:[1,0,1]
 v_pk_fma_f32 v[202:203], v[186:187], 4.0, v[202:203] op_sel_hi:[1,0,1]
 v_pk_fma_f32 v[204:205], v[188:189], 4.0, v[204:205] op_sel_hi:[1,0,1]
 v_pk_fma_f32 v[206:207], v[190:191], 4.0, v[206:207] op_sel_hi:[1,0,1]
 v_pk_add_f32 v[184:185], v[232:233], v[240:241]
 v_pk_add_f32 v[186:187], v[234:235], v[242:243]
 v_pk_add_f32 v[188:189], v[236:237], v[244:245]
 v_pk_add_f32 v[190:191], v[238:239], v[246:247]
 v_pk_add_f32 v[232:233], v[232:233], v[240:241] neg_lo:[0,1] neg_hi:[0,1]
 v_pk_add_f32 v[234:235], v[234:235], v[242:243] neg_lo:[0,1] neg_hi:[0,1]
 v_pk_add_f32 v[236:237], v[236:237], v[244:245] neg_lo:[0,1] neg_hi:[0,1]
 v_pk_add_f32 v[238:239], v[238:239], v[246:247] neg_lo:[0,1] neg_hi:[0,1]
 v_pk_fma_f32 v[192:193], v[200:201], 0.5, v[208:209] op_sel_hi:[1,0,1]
 v_pk_fma_f32 v[194:195], v[202:203], 0.5, v[210:211] op_sel_hi:[1,0,1]
 v_pk_fma_f32 v[196:197], v[204:205], 0.5, v[212:213] op_sel_hi:[1,0,1]
 v_pk_fma_f32 v[198:199], v[206:207], 0.5, v[214:215] op_sel_hi:[1,0,1]
 v_pk_fma_f32 v[208:209], v[200:201], -0.5, v[208:209] op_sel_hi:[1,0,1]
 v_pk_fma_f32 v[210:211], v[202:203], -0.5, v[210:211] op_sel_hi:[1,0,1]
 v_pk_fma_f32 v[212:213], v[204:205], -0.5, v[212:213] op_sel_hi:[1,0,1]
 v_pk_fma_f32 v[214:215], v[206:207], -0.5, v[214:215] op_sel_hi:[1,0,1]
 v_cvt_pk_bf16_f32 v12, v184, v185
 v_cvt_pk_bf16_f32 v13, v186, v187
 v_cvt_pk_bf16_f32 v14, v188, v189
 v_cvt_pk_bf16_f32 v15, v190, v191
 ds_write_b128 v8, v[12:15] offset:0
 v_cvt_pk_bf16_f32 v16, v232, v233
 v_cvt_pk_bf16_f32 v17, v234, v235
 v_cvt_pk_bf16_f32 v18, v236, v237
 v_cvt_pk_bf16_f32 v19, v238, v239
 ds_write_b128 v8, v[16:19] offset:4096
 v_cvt_pk_bf16_f32 v20, v192, v193
 v_cvt_pk_bf16_f32 v21, v194, v195
 v_cvt_pk_bf16_f32 v22, v196, v197
 v_cvt_pk_bf16_f32 v23, v198, v199
 ds_write_b128 v8, v[20:23] offset:8192
 v_cvt_pk_bf16_f32 v24, v208, v209
 v_cvt_pk_bf16_f32 v25, v210, v211
 v_cvt_pk_bf16_f32 v26, v212, v213
 v_cvt_pk_bf16_f32 v27, v214, v215
 ds_write_b128 v8, v[24:27] offset:12288
 s_waitcnt vmcnt(24)
 v_lshlrev_b32 v248, 16, v136
 v_and_b32 v249, s34, v136
 v_lshlrev_b32 v250, 16, v137
 v_and_b32 v251, s34, v137
 v_lshlrev_b32 v252, 16, v138
 v_and_b32 v253, s34, v138
 v_lshlrev_b32 v254, 16, v139
 v_and_b32 v255, s34, v139
 v_lshlrev_b32 v28, 16, v140
 v_and_b32 v29, s34, v140
 v_lshlrev_b32 v30, 16, v141
 v_and_b32 v31, s34, v141
 v_lshlrev_b32 v32, 16, v142
 v_and_b32 v33, s34, v142
 v_lshlrev_b32 v34, 16, v143
 v_and_b32 v35, s34, v143
 s_waitcnt vmcnt(22)
 v_lshlrev_b32 v36, 16, v144
 v_and_b32 v37, s34, v144
 v_lshlrev_b32 v38, 16, v145
 v_and_b32 v39, s34, v145
 v_lshlrev_b32 v40, 16, v146
 v_and_b32 v41, s34, v146
 v_lshlrev_b32 v42, 16, v147
 v_and_b32 v43, s34, v147
 v_lshlrev_b32 v44, 16, v148
 v_and_b32 v45, s34, v148
 v_lshlrev_b32 v46, 16, v149
 v_and_b32 v47, s34, v149
 v_lshlrev_b32 v48, 16, v150
 v_and_b32 v49, s34, v150
 v_lshlrev_b32 v50, 16, v151
 v_and_b32 v51, s34, v151
 s_add_u32 s33, s33, 4096
 buffer_load_dwordx4 v[92:95], v2, s[16:19], s33 offen offset:0
 buffer_load_dwordx4 v[96:99], v2, s[16:19], s33 offen offset:2048
 s_add_u32 s33, s33, 4096
 buffer_load_dwordx4 v[100:103], v2, s[16:19], s33 offen offset:0
 buffer_load_dwordx4 v[104:107], v2, s[16:19], s33 offen offset:2048
 s_add_u32 s33, s33, 4096
 buffer_load_dwordx4 a[144:147], v1, s[20:23], s50 offen offset:0
 buffer_load_dwordx4 a[148:151], v1, s[20:23], s50 offen offset:1024
 v_pk_fma_f32 v[52:53], v[28:29], s[74:75], v[44:45] op_sel_hi:[1,0,1]
 v_pk_fma_f32 v[54:55], v[30:31], s[74:75], v[46:47] op_sel_hi:[1,0,1]
 v_pk_fma_f32 v[56:57], v[32:33], s[74:75], v[48:49] op_sel_hi:[1,0,1]
 v_pk_fma_f32 v[58:59], v[34:35], s[74:75], v[50:51] op_sel_hi:[1,0,1]
 v_pk_fma_f32 v[60:61], v[248:249], s[74:75], v[36:37] op_sel_hi:[1,0,1]
 v_pk_fma_f32 v[62:63], v[250:251], s[74:75], v[38:39] op_sel_hi:[1,0,1]
 v_pk_fma_f32 v[64:65], v[252:253], s[74:75], v[40:41] op_sel_hi:[1,0,1]
 v_pk_fma_f32 v[66:67], v[254:255], s[74:75], v[42:43] op_sel_hi:[1,0,1]
 v_pk_fma_f32 v[28:29], v[28:29], s[76:77], v[44:45] op_sel_hi:[1,0,1]
 v_pk_fma_f32 v[30:31], v[30:31], s[76:77], v[46:47] op_sel_hi:[1,0,1]
 v_pk_fma_f32 v[32:33], v[32:33], s[76:77], v[48:49] op_sel_hi:[1,0,1]
 v_pk_fma_f32 v[34:35], v[34:35], s[76:77], v[50:51] op_sel_hi:[1,0,1]
 v_pk_fma_f32 v[248:249], v[248:249], s[76:77], v[36:37] op_sel_hi:[1,0,1]
 v_pk_fma_f32 v[250:251], v[250:251], s[76:77], v[38:39] op_sel_hi:[1,0,1]
 v_pk_fma_f32 v[252:253], v[252:253], s[76:77], v[40:41] op_sel_hi:[1,0,1]
 v_pk_fma_f32 v[254:255], v[254:255], s[76:77], v[42:43] op_sel_hi:[1,0,1]
 v_pk_add_f32 v[52:53], v[52:53], v[224:225]
 v_pk_add_f32 v[54:55], v[54:55], v[226:227]
 v_pk_add_f32 v[56:57], v[56:57], v[228:229]
 v_pk_add_f32 v[58:59], v[58:59], v[230:231]
 v_pk_add_f32 v[60:61], v[60:61], v[216:217]
 v_pk_add_f32 v[62:63], v[62:63], v[218:219]
 v_pk_add_f32 v[64:65], v[64:65], v[220:221]
 v_pk_add_f32 v[66:67], v[66:67], v[222:223]
 v_pk_fma_f32 v[28:29], v[224:225], 4.0, v[28:29] op_sel_hi:[1,0,1]
 v_pk_fma_f32 v[30:31], v[226:227], 4.0, v[30:31] op_sel_hi:[1,0,1]
 v_pk_fma_f32 v[32:33], v[228:229], 4.0, v[32:33] op_sel_hi:[1,0,1]
 v_pk_fma_f32 v[34:35], v[230:231], 4.0, v[34:35] op_sel_hi:[1,0,1]
 v_pk_fma_f32 v[248:249], v[216:217], 4.0, v[248:249] op_sel_hi:[1,0,1]
 v_pk_fma_f32 v[250:251], v[218:219], 4.0, v[250:251] op_sel_hi:[1,0,1]
 v_pk_fma_f32 v[252:253], v[220:221], 4.0, v[252:253] op_sel_hi:[1,0,1]
 v_pk_fma_f32 v[254:255], v[222:223], 4.0, v[254:255] op_sel_hi:[1,0,1]
 v_pk_add_f32 v[216:217], v[52:53], v[60:61]
 v_pk_add_f32 v[218:219], v[54:55], v[62:63]
 v_pk_add_f32 v[220:221], v[56:57], v[64:65]
 v_pk_add_f32 v[222:223], v[58:59], v[66:67]
 v_pk_add_f32 v[52:53], v[52:53], v[60:61] neg_lo:[0,1] neg_hi:[0,1]
 v_pk_add_f32 v[54:55], v[54:55], v[62:63] neg_lo:[0,1] neg_hi:[0,1]
 v_pk_add_f32 v[56:57], v[56:57], v[64:65] neg_lo:[0,1] neg_hi:[0,1]
 v_pk_add_f32 v[58:59], v[58:59], v[66:67] neg_lo:[0,1] neg_hi:[0,1]
 v_pk_fma_f32 v[224:225], v[248:249], 0.5, v[28:29] op_sel_hi:[1,0,1]
 v_pk_fma_f32 v[226:227], v[250:251], 0.5, v[30:31] op_sel_hi:[1,0,1]
 v_pk_fma_f32 v[228:229], v[252:253], 0.5, v[32:33] op_sel_hi:[1,0,1]
 v_pk_fma_f32 v[230:231], v[254:255], 0.5, v[34:35] op_sel_hi:[1,0,1]
 v_pk_fma_f32 v[28:29], v[248:249], -0.5, v[28:29] op_sel_hi:[1,0,1]
 v_pk_fma_f32 v[30:31], v[250:251], -0.5, v[30:31] op_sel_hi:[1,0,1]
 v_pk_fma_f32 v[32:33], v[252:253], -0.5, v[32:33] op_sel_hi:[1,0,1]
 v_pk_fma_f32 v[34:35], v[254:255], -0.5, v[34:35] op_sel_hi:[1,0,1]
 v_cvt_pk_bf16_f32 v12, v216, v217
 v_cvt_pk_bf16_f32 v13, v218, v219
 v_cvt_pk_bf16_f32 v14, v220, v221
 v_cvt_pk_bf16_f32 v15, v222, v223
 ds_write_b128 v8, v[12:15] offset:1024
 v_cvt_pk_bf16_f32 v16, v52, v53
 v_cvt_pk_bf16_f32 v17, v54, v55
 v_cvt_pk_bf16_f32 v18, v56, v57
 v_cvt_pk_bf16_f32 v19, v58, v59
 ds_write_b128 v8, v[16:19] offset:5120
 v_cvt_pk_bf16_f32 v20, v224, v225
 v_cvt_pk_bf16_f32 v21, v226, v227
 v_cvt_pk_bf16_f32 v22, v228, v229
 v_cvt_pk_bf16_f32 v23, v230, v231
 ds_write_b128 v8, v[20:23] offset:9216
 v_cvt_pk_bf16_f32 v24, v28, v29
 v_cvt_pk_bf16_f32 v25, v30, v31
 v_cvt_pk_bf16_f32 v26, v32, v33
 v_cvt_pk_bf16_f32 v27, v34, v35
 ds_write_b128 v8, v[24:27] offset:13312
 s_waitcnt vmcnt(26)
 v_lshlrev_b32 v184, 16, v152
 v_and_b32 v185, s34, v152
 v_lshlrev_b32 v186, 16, v153
 v_and_b32 v187, s34, v153
 v_lshlrev_b32 v188, 16, v154
 v_and_b32 v189, s34, v154
 v_lshlrev_b32 v190, 16, v155
 v_and_b32 v191, s34, v155
 v_lshlrev_b32 v192, 16, v156
 v_and_b32 v193, s34, v156
 v_lshlrev_b32 v194, 16, v157
 v_and_b32 v195, s34, v157
 v_lshlrev_b32 v196, 16, v158
 v_and_b32 v197, s34, v158
 v_lshlrev_b32 v198, 16, v159
 v_and_b32 v199, s34, v159
 s_waitcnt vmcnt(24)
 v_lshlrev_b32 v232, 16, v160
 v_and_b32 v233, s34, v160
 v_lshlrev_b32 v234, 16, v161
 v_and_b32 v235, s34, v161
 v_lshlrev_b32 v236, 16, v162
 v_and_b32 v237, s34, v162
 v_lshlrev_b32 v238, 16, v163
 v_and_b32 v239, s34, v163
 v_lshlrev_b32 v240, 16, v164
 v_and_b32 v241, s34, v164
 v_lshlrev_b32 v242, 16, v165
 v_and_b32 v243, s34, v165
 v_lshlrev_b32 v244, 16, v166
 v_and_b32 v245, s34, v166
 v_lshlrev_b32 v246, 16, v167
 v_and_b32 v247, s34, v167
 buffer_load_dwordx4 a[152:155], v1, s[20:23], s50 offen offset:2048
 buffer_load_dwordx4 a[156:159], v1, s[20:23], s50 offen offset:3072
 buffer_load_dwordx4 a[160:163], v1, s[20:23], s51 offen offset:0
 buffer_load_dwordx4 a[164:167], v1, s[20:23], s51 offen offset:1024
 buffer_load_dwordx4 a[168:171], v1, s[20:23], s51 offen offset:2048
 buffer_load_dwordx4 a[172:175], v1, s[20:23], s51 offen offset:3072
 buffer_load_dwordx4 a[176:179], v1, s[20:23], s52 offen offset:0
 buffer_load_dwordx4 a[180:183], v1, s[20:23], s52 offen offset:1024
 buffer_load_dwordx4 a[184:187], v1, s[20:23], s52 offen offset:2048
 v_pk_fma_f32 v[200:201], v[192:193], s[74:75], v[240:241] op_sel_hi:[1,0,1]
 v_pk_fma_f32 v[202:203], v[194:195], s[74:75], v[242:243] op_sel_hi:[1,0,1]
 v_pk_fma_f32 v[204:205], v[196:197], s[74:75], v[244:245] op_sel_hi:[1,0,1]
 v_pk_fma_f32 v[206:207], v[198:199], s[74:75], v[246:247] op_sel_hi:[1,0,1]
 v_pk_fma_f32 v[208:209], v[184:185], s[74:75], v[232:233] op_sel_hi:[1,0,1]
 v_pk_fma_f32 v[210:211], v[186:187], s[74:75], v[234:235] op_sel_hi:[1,0,1]
 v_pk_fma_f32 v[212:213], v[188:189], s[74:75], v[236:237] op_sel_hi:[1,0,1]
 v_pk_fma_f32 v[214:215], v[190:191], s[74:75], v[238:239] op_sel_hi:[1,0,1]
 v_pk_fma_f32 v[192:193], v[192:193], s[76:77], v[240:241] op_sel_hi:[1,0,1]
 v_pk_fma_f32 v[194:195], v[194:195], s[76:77], v[242:243] op_sel_hi:[1,0,1]
 v_pk_fma_f32 v[196:197], v[196:197], s[76:77], v[244:245] op_sel_hi:[1,0,1]
 v_pk_fma_f32 v[198:199], v[198:199], s[76:77], v[246:247] op_sel_hi:[1,0,1]
 v_pk_fma_f32 v[184:185], v[184:185], s[76:77], v[232:233] op_sel_hi:[1,0,1]
 v_pk_fma_f32 v[186:187], v[186:187], s[76:77], v[234:235] op_sel_hi:[1,0,1]
 v_pk_fma_f32 v[188:189], v[188:189], s[76:77], v[236:237] op_sel_hi:[1,0,1]
 v_pk_fma_f32 v[190:191], v[190:191], s[76:77], v[238:239] op_sel_hi:[1,0,1]
 v_pk_add_f32 v[200:201], v[200:201], v[44:45]
 v_pk_add_f32 v[202:203], v[202:203], v[46:47]
 v_pk_add_f32 v[204:205], v[204:205], v[48:49]
 v_pk_add_f32 v[206:207], v[206:207], v[50:51]
 v_pk_add_f32 v[208:209], v[208:209], v[36:37]
 v_pk_add_f32 v[210:211], v[210:211], v[38:39]
 v_pk_add_f32 v[212:213], v[212:213], v[40:41]
 v_pk_add_f32 v[214:215], v[214:215], v[42:43]
 v_pk_fma_f32 v[192:193], v[44:45], 4.0, v[192:193] op_sel_hi:[1,0,1]
 v_pk_fma_f32 v[194:195], v[46:47], 4.0, v[194:195] op_sel_hi:[1,0,1]
 v_pk_fma_f32 v[196:197], v[48:49], 4.0, v[196:197] op_sel_hi:[1,0,1]
 v_pk_fma_f32 v[198:199], v[50:51], 4.0, v[198:199] op_sel_hi:[1,0,1]
 v_pk_fma_f32 v[184:185], v[36:37], 4.0, v[184:185] op_sel_hi:[1,0,1]
 v_pk_fma_f32 v[186:187], v[38:39], 4.0, v[186:187] op_sel_hi:[1,0,1]
 v_pk_fma_f32 v[188:189], v[40:41], 4.0, v[188:189] op_sel_hi:[1,0,1]
 v_pk_fma_f32 v[190:191], v[42:43], 4.0, v[190:191] op_sel_hi:[1,0,1]
 v_pk_add_f32 v[36:37], v[200:201], v[208:209]
 v_pk_add_f32 v[38:39], v[202:203], v[210:211]
 v_pk_add_f32 v[40:41], v[204:205], v[212:213]
 v_pk_add_f32 v[42:43], v[206:207], v[214:215]
 v_pk_add_f32 v[200:201], v[200:201], v[208:209] neg_lo:[0,1] neg_hi:[0,1]
 v_pk_add_f32 v[202:203], v[202:203], v[210:211] neg_lo:[0,1] neg_hi:[0,1]
 v_pk_add_f32 v[204:205], v[204:205], v[212:213] neg_lo:[0,1] neg_hi:[0,1]
 v_pk_add_f32 v[206:207], v[206:207], v[214:215] neg_lo:[0,1] neg_hi:[0,1]
 v_pk_fma_f32 v[44:45], v[184:185], 0.5, v[192:193] op_sel_hi:[1,0,1]
 v_pk_fma_f32 v[46:47], v[186:187], 0.5, v[194:195] op_sel_hi:[1,0,1]
 v_pk_fma_f32 v[48:49], v[188:189], 0.5, v[196:197] op_sel_hi:[1,0,1]
 v_pk_fma_f32 v[50:51], v[190:191], 0.5, v[198:199] op_sel_hi:[1,0,1]
 v_pk_fma_f32 v[192:193], v[184:185], -0.5, v[192:193] op_sel_hi:[1,0,1]
 v_pk_fma_f32 v[194:195], v[186:187], -0.5, v[194:195] op_sel_hi:[1,0,1]
 v_pk_fma_f32 v[196:197], v[188:189], -0.5, v[196:197] op_sel_hi:[1,0,1]
 v_pk_fma_f32 v[198:199], v[190:191], -0.5, v[198:199] op_sel_hi:[1,0,1]
 v_cvt_pk_bf16_f32 v12, v36, v37
 v_cvt_pk_bf16_f32 v13, v38, v39
 v_cvt_pk_bf16_f32 v14, v40, v41
 v_cvt_pk_bf16_f32 v15, v42, v43
 ds_write_b128 v8, v[12:15] offset:2048
 v_cvt_pk_bf16_f32 v16, v200, v201
 v_cvt_pk_bf16_f32 v17, v202, v203
 v_cvt_pk_bf16_f32 v18, v204, v205
 v_cvt_pk_bf16_f32 v19, v206, v207
 ds_write_b128 v8, v[16:19] offset:6144
 v_cvt_pk_bf16_f32 v20, v44, v45
 v_cvt_pk_bf16_f32 v21, v46, v47
 v_cvt_pk_bf16_f32 v22, v48, v49
 v_cvt_pk_bf16_f32 v23, v50, v51
 ds_write_b128 v8, v[20:23] offset:10240
 v_cvt_pk_bf16_f32 v24, v192, v193
 v_cvt_pk_bf16_f32 v25, v194, v195
 v_cvt_pk_bf16_f32 v26, v196, v197
 v_cvt_pk_bf16_f32 v27, v198, v199
 ds_write_b128 v8, v[24:27] offset:14336
 s_waitcnt vmcnt(31)
 v_lshlrev_b32 v216, 16, v168
 v_and_b32 v217, s34, v168
 v_lshlrev_b32 v218, 16, v169
 v_and_b32 v219, s34, v169
 v_lshlrev_b32 v220, 16, v170
 v_and_b32 v221, s34, v170
 v_lshlrev_b32 v222, 16, v171
 v_and_b32 v223, s34, v171
 v_lshlrev_b32 v224, 16, v172
 v_and_b32 v225, s34, v172
 v_lshlrev_b32 v226, 16, v173
 v_and_b32 v227, s34, v173
 v_lshlrev_b32 v228, 16, v174
 v_and_b32 v229, s34, v174
 v_lshlrev_b32 v230, 16, v175
 v_and_b32 v231, s34, v175
 s_waitcnt vmcnt(29)
 v_lshlrev_b32 v52, 16, v176
 v_and_b32 v53, s34, v176
 v_lshlrev_b32 v54, 16, v177
 v_and_b32 v55, s34, v177
 v_lshlrev_b32 v56, 16, v178
 v_and_b32 v57, s34, v178
 v_lshlrev_b32 v58, 16, v179
 v_and_b32 v59, s34, v179
 v_lshlrev_b32 v60, 16, v180
 v_and_b32 v61, s34, v180
 v_lshlrev_b32 v62, 16, v181
 v_and_b32 v63, s34, v181
 v_lshlrev_b32 v64, 16, v182
 v_and_b32 v65, s34, v182
 v_lshlrev_b32 v66, 16, v183
 v_and_b32 v67, s34, v183
 buffer_load_dwordx4 a[188:191], v1, s[20:23], s52 offen offset:3072
 buffer_load_dwordx4 a[192:195], v1, s[20:23], s53 offen offset:0
 buffer_load_dwordx4 a[196:199], v1, s[20:23], s53 offen offset:1024
 buffer_load_dwordx4 a[200:203], v1, s[20:23], s53 offen offset:2048
 buffer_load_dwordx4 a[204:207], v1, s[20:23], s53 offen offset:3072
 buffer_load_dwordx4 a[208:211], v1, s[20:23], s54 offen offset:0
 buffer_load_dwordx4 a[212:215], v1, s[20:23], s54 offen offset:1024
 buffer_load_dwordx4 a[216:219], v1, s[20:23], s54 offen offset:2048
 buffer_load_dwordx4 a[220:223], v1, s[20:23], s54 offen offset:3072
 v_pk_fma_f32 v[248:249], v[224:225], s[74:75], v[60:61] op_sel_hi:[1,0,1]
 v_pk_fma_f32 v[250:251], v[226:227], s[74:75], v[62:63] op_sel_hi:[1,0,1]
 v_pk_fma_f32 v[252:253], v[228:229], s[74:75], v[64:65] op_sel_hi:[1,0,1]
 v_pk_fma_f32 v[254:255], v[230:231], s[74:75], v[66:67] op_sel_hi:[1,0,1]
 v_pk_fma_f32 v[28:29], v[216:217], s[74:75], v[52:53] op_sel_hi:[1,0,1]
 v_pk_fma_f32 v[30:31], v[218:219], s[74:75], v[54:55] op_sel_hi:[1,0,1]
 v_pk_fma_f32 v[32:33], v[220:221], s[74:75], v[56:57] op_sel_hi:[1,0,1]
 v_pk_fma_f32 v[34:35], v[222:223], s[74:75], v[58:59] op_sel_hi:[1,0,1]
 v_pk_fma_f32 v[224:225], v[224:225], s[76:77], v[60:61] op_sel_hi:[1,0,1]
 v_pk_fma_f32 v[226:227], v[226:227], s[76:77], v[62:63] op_sel_hi:[1,0,1]
 v_pk_fma_f32 v[228:229], v[228:229], s[76:77], v[64:65] op_sel_hi:[1,0,1]
 v_pk_fma_f32 v[230:231], v[230:231], s[76:77], v[66:67] op_sel_hi:[1,0,1]
 v_pk_fma_f32 v[216:217], v[216:217], s[76:77], v[52:53] op_sel_hi:[1,0,1]
 v_pk_fma_f32 v[218:219], v[218:219], s[76:77], v[54:55] op_sel_hi:[1,0,1]
 v_pk_fma_f32 v[220:221], v[220:221], s[76:77], v[56:57] op_sel_hi:[1,0,1]
 v_pk_fma_f32 v[222:223], v[222:223], s[76:77], v[58:59] op_sel_hi:[1,0,1]
 v_pk_add_f32 v[248:249], v[248:249], v[240:241]
 v_pk_add_f32 v[250:251], v[250:251], v[242:243]
 v_pk_add_f32 v[252:253], v[252:253], v[244:245]
 v_pk_add_f32 v[254:255], v[254:255], v[246:247]
 v_pk_add_f32 v[28:29], v[28:29], v[232:233]
 v_pk_add_f32 v[30:31], v[30:31], v[234:235]
 v_pk_add_f32 v[32:33], v[32:33], v[236:237]
 v_pk_add_f32 v[34:35], v[34:35], v[238:239]
 v_pk_fma_f32 v[224:225], v[240:241], 4.0, v[224:225] op_sel_hi:[1,0,1]
 v_pk_fma_f32 v[226:227], v[242:243], 4.0, v[226:227] op_sel_hi:[1,0,1]
 v_pk_fma_f32 v[228:229], v[244:245], 4.0, v[228:229] op_sel_hi:[1,0,1]
 v_pk_fma_f32 v[230:231], v[246:247], 4.0, v[230:231] op_sel_hi:[1,0,1]
 v_pk_fma_f32 v[216:217], v[232:233], 4.0, v[216:217] op_sel_hi:[1,0,1]
 v_pk_fma_f32 v[218:219], v[234:235], 4.0, v[218:219] op_sel_hi:[1,0,1]
 v_pk_fma_f32 v[220:221], v[236:237], 4.0, v[220:221] op_sel_hi:[1,0,1]
 v_pk_fma_f32 v[222:223], v[238:239], 4.0, v[222:223] op_sel_hi:[1,0,1]
 v_pk_add_f32 v[232:233], v[248:249], v[28:29]
 v_pk_add_f32 v[234:235], v[250:251], v[30:31]
 v_pk_add_f32 v[236:237], v[252:253], v[32:33]
 v_pk_add_f32 v[238:239], v[254:255], v[34:35]
 v_pk_add_f32 v[248:249], v[248:249], v[28:29] neg_lo:[0,1] neg_hi:[0,1]
 v_pk_add_f32 v[250:251], v[250:251], v[30:31] neg_lo:[0,1] neg_hi:[0,1]
 v_pk_add_f32 v[252:253], v[252:253], v[32:33] neg_lo:[0,1] neg_hi:[0,1]
 v_pk_add_f32 v[254:255], v[254:255], v[34:35] neg_lo:[0,1] neg_hi:[0,1]
 v_pk_fma_f32 v[240:241], v[216:217], 0.5, v[224:225] op_sel_hi:[1,0,1]
 v_pk_fma_f32 v[242:243], v[218:219], 0.5, v[226:227] op_sel_hi:[1,0,1]
 v_pk_fma_f32 v[244:245], v[220:221], 0.5, v[228:229] op_sel_hi:[1,0,1]
 v_pk_fma_f32 v[246:247], v[222:223], 0.5, v[230:231] op_sel_hi:[1,0,1]
 v_pk_fma_f32 v[224:225], v[216:217], -0.5, v[224:225] op_sel_hi:[1,0,1]
 v_pk_fma_f32 v[226:227], v[218:219], -0.5, v[226:227] op_sel_hi:[1,0,1]
 v_pk_fma_f32 v[228:229], v[220:221], -0.5, v[228:229] op_sel_hi:[1,0,1]
 v_pk_fma_f32 v[230:231], v[222:223], -0.5, v[230:231] op_sel_hi:[1,0,1]
 v_cvt_pk_bf16_f32 v12, v232, v233
 v_cvt_pk_bf16_f32 v13, v234, v235
 v_cvt_pk_bf16_f32 v14, v236, v237
 v_cvt_pk_bf16_f32 v15, v238, v239
 ds_write_b128 v8, v[12:15] offset:3072
 v_cvt_pk_bf16_f32 v16, v248, v249
 v_cvt_pk_bf16_f32 v17, v250, v251
 v_cvt_pk_bf16_f32 v18, v252, v253
 v_cvt_pk_bf16_f32 v19, v254, v255
 ds_write_b128 v8, v[16:19] offset:7168
 v_cvt_pk_bf16_f32 v20, v240, v241
 v_cvt_pk_bf16_f32 v21, v242, v243
 v_cvt_pk_bf16_f32 v22, v244, v245
 v_cvt_pk_bf16_f32 v23, v246, v247
 ds_write_b128 v8, v[20:23] offset:11264
 v_cvt_pk_bf16_f32 v24, v224, v225
 v_cvt_pk_bf16_f32 v25, v226, v227
 v_cvt_pk_bf16_f32 v26, v228, v229
 v_cvt_pk_bf16_f32 v27, v230, v231
 ds_write_b128 v8, v[24:27] offset:15360
 s_mov_b32 s74, 0x3dcccccd
 s_mov_b32 s76, 0x3e4ccccd
 s_waitcnt lgkmcnt(0)
 s_barrier
 v_xor_b32 v7, 0x10000, v7
 v_xor_b32 v8, 0x10000, v8
 ds_read_b128 a[240:243], v7 offset:0
 ds_read_b128 a[244:247], v7 offset:1024
 ds_read_b128 a[248:251], v7 offset:2048
 ds_read_b128 a[252:255], v7 offset:3072
 s_nop 1
L_TILE:
 s_mov_b32 s31, 0
 s_cmp_eq_u32 s30, 2
 s_cselect_b32 s85, 0, 0x70000000
 s_waitcnt vmcnt(34) lgkmcnt(3)
 v_mfma_f32_16x16x32_bf16 v[112:115], a[112:115], a[240:243], 0
 s_waitcnt vmcnt(28)
 v_lshlrev_b32 v28, 16, v68
 v_and_b32 v29, s34, v68
 v_lshlrev_b32 v30, 16, v72
 v_and_b32 v31, s34, v72
 v_mfma_f32_16x16x32_bf16 v[128:131], a[116:119], a[240:243], 0
 buffer_load_dwordx4 a[224:227], v1, s[20:23], s55 offen offset:0
 v_lshlrev_b32 v32, 16, v69
 v_mfma_f32_16x16x32_bf16 v[144:147], a[120:123], a[240:243], 0
 v_and_b32 v33, s34, v69
 v_lshlrev_b32 v34, 16, v73
 v_and_b32 v35, s34, v73
 v_lshlrev_b32 v36, 16, v70
 v_mfma_f32_16x16x32_bf16 v[160:163], a[124:127], a[240:243], 0
 ds_read_b128 a[240:243], v7 offset:4096
 v_and_b32 v37, s34, v70
 v_lshlrev_b32 v38, 16, v74
 v_and_b32 v39, s34, v74
 s_waitcnt lgkmcnt(3)
 v_mfma_f32_16x16x32_bf16 v[176:179], a[112:115], a[244:247], 0
 v_lshlrev_b32 v40, 16, v71
 v_and_b32 v41, s34, v71
 v_lshlrev_b32 v42, 16, v75
 v_and_b32 v43, s34, v75
 v_mfma_f32_16x16x32_bf16 v[192:195], a[116:119], a[244:247], 0
 buffer_load_dwordx4 a[228:231], v1, s[20:23], s55 offen offset:1024
 v_mfma_f32_16x16x32_bf16 v[208:211], a[120:123], a[244:247], 0
 s_waitcnt vmcnt(26)
 v_lshlrev_b32 v44, 16, v76
 v_mfma_f32_16x16x32_bf16 v[224:227], a[124:127], a[244:247], 0
 ds_read_b128 a[244:247], v7 offset:5120
 buffer_load_dwordx4 v[68:71], v2, s[16:19], s53 offen offset:2048
 v_and_b32 v45, s34, v76
 v_lshlrev_b32 v46, 16, v80
 v_and_b32 v47, s34, v80
 s_waitcnt lgkmcnt(3)
 v_mfma_f32_16x16x32_bf16 v[240:243], a[112:115], a[248:251], 0
 v_lshlrev_b32 v48, 16, v84
 v_and_b32 v49, s34, v84
 v_lshlrev_b32 v50, 16, v88
 v_mfma_f32_16x16x32_bf16 a[0:3], a[116:119], a[248:251], 0
 buffer_load_dwordx4 a[232:235], v1, s[20:23], s55 offen offset:2048
 v_and_b32 v51, s34, v88
 v_fma_f32 v52, s39, v46, v50
 v_mfma_f32_16x16x32_bf16 a[16:19], a[120:123], a[248:251], 0
 v_fma_f32 v53, s39, v47, v51
 v_fma_f32 v54, s39, v44, v48
 v_fma_f32 v55, s39, v45, v49
 v_fma_f32 v46, s40, v46, v50
 v_mfma_f32_16x16x32_bf16 a[32:35], a[124:127], a[248:251], 0
 ds_read_b128 a[248:251], v7 offset:6144
 v_fma_f32 v47, s40, v47, v51
 v_fma_f32 v44, s40, v44, v48
 s_waitcnt lgkmcnt(3)
 v_mfma_f32_16x16x32_bf16 a[48:51], a[112:115], a[252:255], 0
 v_fma_f32 v45, s40, v45, v49
 v_add_f32 v52, v52, v30
 v_add_f32 v53, v53, v31
 v_add_f32 v54, v54, v28
 v_mfma_f32_16x16x32_bf16 a[64:67], a[116:119], a[252:255], 0
 buffer_load_dwordx4 a[236:239], v1, s[20:23], s55 offen offset:3072
 v_add_f32 v55, v55, v29
 v_fmac_f32 v46, 4.0, v30
 v_mfma_f32_16x16x32_bf16 a[80:83], a[120:123], a[252:255], 0
 v_fmac_f32 v47, 4.0, v31
 v_fmac_f32 v44, 4.0, v28
 v_fmac_f32 v45, 4.0, v29
 v_add_f32 v28, v52, v54
 v_mfma_f32_16x16x32_bf16 a[96:99], a[124:127], a[252:255], 0
 ds_read_b128 a[252:255], v7 offset:7168
 buffer_load_dwordx4 v[72:75], v2, s[16:19], s54 offen offset:0
 v_add_f32 v29, v53, v55
 v_sub_f32 v52, v52, v54
 s_waitcnt lgkmcnt(3)
 v_mfma_f32_16x16x32_bf16 v[116:119], a[128:131], a[240:243], 0
 v_sub_f32 v53, v53, v55
 v_fma_f32 v30, 0.5, v44, v46
 v_fma_f32 v31, 0.5, v45, v47
 v_fma_f32 v46, -0.5, v44, v46
 v_mfma_f32_16x16x32_bf16 v[132:135], a[132:135], a[240:243], 0
 s_add_u32 s20, s20, 32768
 s_addc_u32 s21, s21, 0
 buffer_load_dwordx4 a[112:115], v1, s[20:23], s48 offen offset:0
 v_mfma_f32_16x16x32_bf16 v[148:151], a[136:139], a[240:243], 0
 v_fma_f32 v47, -0.5, v45, v47
 v_cvt_pk_bf16_f32 v12, v28, v29
 v_cvt_pk_bf16_f32 v16, v52, v53
 v_cvt_pk_bf16_f32 v20, v30, v31
 v_mfma_f32_16x16x32_bf16 v[164:167], a[140:143], a[240:243], 0
 ds_read_b128 a[240:243], v7 offset:8192
 v_cvt_pk_bf16_f32 v24, v46, v47
 v_lshlrev_b32 v56, 16, v77
 v_and_b32 v57, s34, v77
 s_waitcnt lgkmcnt(3)
 v_mfma_f32_16x16x32_bf16 v[180:183], a[128:131], a[244:247], 0
 v_lshlrev_b32 v58, 16, v81
 v_and_b32 v59, s34, v81
 v_lshlrev_b32 v60, 16, v85
 v_mfma_f32_16x16x32_bf16 v[196:199], a[132:135], a[244:247], 0
 buffer_load_dwordx4 a[116:119], v1, s[20:23], s48 offen offset:1024
 v_and_b32 v61, s34, v85
 v_lshlrev_b32 v62, 16, v89
 v_mfma_f32_16x16x32_bf16 v[212:215], a[136:139], a[244:247], 0
 v_and_b32 v63, s34, v89
 v_fma_f32 v64, s39, v58, v62
 v_fma_f32 v65, s39, v59, v63
 v_fma_f32 v66, s39, v56, v60
 v_mfma_f32_16x16x32_bf16 v[228:231], a[140:143], a[244:247], 0
 ds_read_b128 a[244:247], v7 offset:9216
 v_fma_f32 v67, s39, v57, v61
 v_fma_f32 v58, s40, v58, v62
 s_waitcnt lgkmcnt(3)
 v_mfma_f32_16x16x32_bf16 v[244:247], a[128:131], a[248:251], 0
 v_fma_f32 v59, s40, v59, v63
 v_fma_f32 v56, s40, v56, v60
 v_fma_f32 v57, s40, v57, v61
 v_add_f32 v64, v64, v34
 v_mfma_f32_16x16x32_bf16 a[4:7], a[132:135], a[248:251], 0
 buffer_load_dwordx4 a[120:123], v1, s[20:23], s48 offen offset:2048
 v_add_f32 v65, v65, v35
 v_add_f32 v66, v66, v32
 v_mfma_f32_16x16x32_bf16 a[20:23], a[136:139], a[248:251], 0
 v_add_f32 v67, v67, v33
 v_fmac_f32 v58, 4.0, v34
 v_fmac_f32 v59, 4.0, v35
 v_mfma_f32_16x16x32_bf16 a[36:39], a[140:143], a[248:251], 0
 ds_read_b128 a[248:251], v7 offset:10240
 v_fmac_f32 v56, 4.0, v32
 v_fmac_f32 v57, 4.0, v33
 v_add_f32 v32, v64, v66
 s_waitcnt lgkmcnt(3)
 v_mfma_f32_16x16x32_bf16 a[52:55], a[128:131], a[252:255], 0
 v_add_f32 v33, v65, v67
 v_sub_f32 v64, v64, v66
 v_sub_f32 v65, v65, v67
 v_fma_f32 v34, 0.5, v56, v58
 v_mfma_f32_16x16x32_bf16 a[68:71], a[132:135], a[252:255], 0
 buffer_load_dwordx4 a[124:127], v1, s[20:23], s48 offen offset:3072
 v_fma_f32 v35, 0.5, v57, v59
 v_fma_f32 v58, -0.5, v56, v58
 v_mfma_f32_16x16x32_bf16 a[84:87], a[136:139], a[252:255], 0
 v_fma_f32 v59, -0.5, v57, v59
 v_cvt_pk_bf16_f32 v13, v32, v33
 v_cvt_pk_bf16_f32 v17, v64, v65
 v_mfma_f32_16x16x32_bf16 a[100:103], a[140:143], a[252:255], 0
 ds_read_b128 a[252:255], v7 offset:11264
 v_cvt_pk_bf16_f32 v21, v34, v35
 v_cvt_pk_bf16_f32 v25, v58, v59
 v_lshlrev_b32 v28, 16, v78
 s_waitcnt vmcnt(26) lgkmcnt(3)
 v_mfma_f32_16x16x32_bf16 v[120:123], a[144:147], a[240:243], 0
 v_and_b32 v29, s34, v78
 v_lshlrev_b32 v30, 16, v82
 v_and_b32 v31, s34, v82
 v_lshlrev_b32 v52, 16, v86
 v_mfma_f32_16x16x32_bf16 v[136:139], a[148:151], a[240:243], 0
 buffer_load_dwordx4 a[128:131], v1, s[20:23], s49 offen offset:0
 v_and_b32 v53, s34, v86
 v_mfma_f32_16x16x32_bf16 v[152:155], a[152:155], a[240:243], 0
 v_lshlrev_b32 v54, 16, v90
 v_and_b32 v55, s34, v90
 v_fma_f32 v44, s39, v30, v54
 v_fma_f32 v45, s39, v31, v55
 v_mfma_f32_16x16x32_bf16 v[168:171], a[156:159], a[240:243], 0
 ds_read_b128 a[240:243], v7 offset:12288
 v_fma_f32 v46, s39, v28, v52
 v_fma_f32 v47, s39, v29, v53
 v_fma_f32 v30, s40, v30, v54
 s_waitcnt lgkmcnt(3)
 v_mfma_f32_16x16x32_bf16 v[184:187], a[144:147], a[244:247], 0
 v_fma_f32 v31, s40, v31, v55
 v_fma_f32 v28, s40, v28, v52
 v_fma_f32 v29, s40, v29, v53
 v_add_f32 v44, v44, v38
 v_mfma_f32_16x16x32_bf16 v[200:203], a[148:151], a[244:247], 0
 buffer_load_dwordx4 a[132:135], v1, s[20:23], s49 offen offset:1024
 v_add_f32 v45, v45, v39
 v_mfma_f32_16x16x32_bf16 v[216:219], a[152:155], a[244:247], 0
 v_add_f32 v46, v46, v36
 v_add_f32 v47, v47, v37
 v_fmac_f32 v30, 4.0, v38
 v_fmac_f32 v31, 4.0, v39
 v_mfma_f32_16x16x32_bf16 v[232:235], a[156:159], a[244:247], 0
 ds_read_b128 a[244:247], v7 offset:13312
 v_fmac_f32 v28, 4.0, v36
 v_fmac_f32 v29, 4.0, v37
 v_add_f32 v36, v44, v46
 s_waitcnt lgkmcnt(3)
 v_mfma_f32_16x16x32_bf16 v[248:251], a[144:147], a[248:251], 0
 v_add_f32 v37, v45, v47
 v_sub_f32 v44, v44, v46
 v_sub_f32 v45, v45, v47
 v_mfma_f32_16x16x32_bf16 a[8:11], a[148:151], a[248:251], 0
 buffer_load_dwordx4 a[136:139], v1, s[20:23], s49 offen offset:2048
 v_fma_f32 v38, 0.5, v28, v30
 v_fma_f32 v39, 0.5, v29, v31
 v_mfma_f32_16x16x32_bf16 a[24:27], a[152:155], a[248:251], 0
 v_fma_f32 v30, -0.5, v28, v30
 v_fma_f32 v31, -0.5, v29, v31
 v_cvt_pk_bf16_f32 v14, v36, v37
 v_cvt_pk_bf16_f32 v18, v44, v45
 v_mfma_f32_16x16x32_bf16 a[40:43], a[156:159], a[248:251], 0
 ds_read_b128 a[248:251], v7 offset:14336
 v_cvt_pk_bf16_f32 v22, v38, v39
 v_cvt_pk_bf16_f32 v26, v30, v31
 s_waitcnt lgkmcnt(3)
 v_mfma_f32_16x16x32_bf16 a[56:59], a[144:147], a[252:255], 0
 v_lshlrev_b32 v32, 16, v79
 v_and_b32 v33, s34, v79
 v_lshlrev_b32 v34, 16, v83
 v_and_b32 v35, s34, v83
 v_mfma_f32_16x16x32_bf16 a[72:75], a[148:151], a[252:255], 0
 buffer_load_dwordx4 a[140:143], v1, s[20:23], s49 offen offset:3072
 v_lshlrev_b32 v64, 16, v87
 v_and_b32 v65, s34, v87
 v_mfma_f32_16x16x32_bf16 a[88:91], a[152:155], a[252:255], 0
 v_lshlrev_b32 v66, 16, v91
 v_and_b32 v67, s34, v91
 v_mfma_f32_16x16x32_bf16 a[104:107], a[156:159], a[252:255], 0
 ds_read_b128 a[252:255], v7 offset:15360
 buffer_load_dwordx4 v[76:79], v2, s[16:19], s54 offen offset:2048
 s_waitcnt vmcnt(27) lgkmcnt(3)
 v_mfma_f32_16x16x32_bf16 v[124:127], a[160:163], a[240:243], 0
 v_mfma_f32_16x16x32_bf16 v[140:143], a[164:167], a[240:243], 0
 buffer_load_dwordx4 a[144:147], v1, s[20:23], s50 offen offset:0
 v_fma_f32 v56, s39, v34, v66
 v_fma_f32 v57, s39, v35, v67
 v_mfma_f32_16x16x32_bf16 v[156:159], a[168:171], a[240:243], 0
 v_fma_f32 v58, s39, v32, v64
 v_fma_f32 v59, s39, v33, v65
 v_fma_f32 v34, s40, v34, v66
 v_mfma_f32_16x16x32_bf16 v[172:175], a[172:175], a[240:243], 0
 ds_read_b128 a[240:243], v7 offset:16384
 v_fma_f32 v35, s40, v35, v67
 v_fma_f32 v32, s40, v32, v64
 v_fma_f32 v33, s40, v33, v65
 s_waitcnt lgkmcnt(3)
 v_mfma_f32_16x16x32_bf16 v[188:191], a[160:163], a[244:247], 0
 v_add_f32 v56, v56, v42
 v_add_f32 v57, v57, v43
 v_add_f32 v58, v58, v40
 v_add_f32 v59, v59, v41
 v_mfma_f32_16x16x32_bf16 v[204:207], a[164:167], a[244:247], 0
 buffer_load_dwordx4 a[148:151], v1, s[20:23], s50 offen offset:1024
 v_fmac_f32 v34, 4.0, v42
 v_mfma_f32_16x16x32_bf16 v[220:223], a[168:171], a[244:247], 0
 v_fmac_f32 v35, 4.0, v43
 v_fmac_f32 v32, 4.0, v40
 v_fmac_f32 v33, 4.0, v41
 v_add_f32 v40, v56, v58
 v_mfma_f32_16x16x32_bf16 v[236:239], a[172:175], a[244:247], 0
 ds_read_b128 a[244:247], v7 offset:17408
 buffer_load_dwordx4 v[80:83], v2, s[16:19], s55 offen offset:0
 v_add_f32 v41, v57, v59
 v_sub_f32 v56, v56, v58
 v_sub_f32 v57, v57, v59
 s_waitcnt lgkmcnt(3)
 v_mfma_f32_16x16x32_bf16 v[252:255], a[160:163], a[248:251], 0
 v_fma_f32 v42, 0.5, v32, v34
 v_fma_f32 v43, 0.5, v33, v35
 v_fma_f32 v34, -0.5, v32, v34
 v_fma_f32 v35, -0.5, v33, v35
 v_mfma_f32_16x16x32_bf16 a[12:15], a[164:167], a[248:251], 0
 buffer_load_dwordx4 a[152:155], v1, s[20:23], s50 offen offset:2048
 v_cvt_pk_bf16_f32 v15, v40, v41
 v_mfma_f32_16x16x32_bf16 a[28:31], a[168:171], a[248:251], 0
 v_cvt_pk_bf16_f32 v19, v56, v57
 v_cvt_pk_bf16_f32 v23, v42, v43
 v_cvt_pk_bf16_f32 v27, v34, v35
 v_lshlrev_b32 v36, 16, v92
 v_mfma_f32_16x16x32_bf16 a[44:47], a[172:175], a[248:251], 0
 ds_read_b128 a[248:251], v7 offset:18432
 ds_write_b128 v8, v[12:15] offset:0
 s_waitcnt lgkmcnt(4)
 v_mfma_f32_16x16x32_bf16 a[60:63], a[160:163], a[252:255], 0
 v_and_b32 v37, s34, v92
 v_lshlrev_b32 v38, 16, v96
 v_mfma_f32_16x16x32_bf16 a[76:79], a[164:167], a[252:255], 0
 buffer_load_dwordx4 a[156:159], v1, s[20:23], s50 offen offset:3072
 v_and_b32 v39, s34, v96
 v_lshlrev_b32 v44, 16, v100
 v_mfma_f32_16x16x32_bf16 a[92:95], a[168:171], a[252:255], 0
 v_and_b32 v45, s34, v100
 v_lshlrev_b32 v46, 16, v104
 v_and_b32 v47, s34, v104
 v_mfma_f32_16x16x32_bf16 a[108:111], a[172:175], a[252:255], 0
 ds_read_b128 a[252:255], v7 offset:19456
 buffer_load_dwordx4 v[84:87], v2, s[16:19], s55 offen offset:2048
 ds_write_b128 v8, v[16:19] offset:4096
 s_waitcnt vmcnt(29) lgkmcnt(5)
 v_mfma_f32_16x16x32_bf16 v[112:115], a[176:179], a[240:243], v[112:115]
 v_fma_f32 v28, s39, v38, v46
 v_fma_f32 v29, s39, v39, v47
 v_fma_f32 v30, s39, v36, v44
 v_mfma_f32_16x16x32_bf16 v[128:131], a[180:183], a[240:243], v[128:131]
 buffer_load_dwordx4 a[160:163], v1, s[20:23], s51 offen offset:0
 v_fma_f32 v31, s39, v37, v45
 v_fma_f32 v38, s40, v38, v46
 v_mfma_f32_16x16x32_bf16 v[144:147], a[184:187], a[240:243], v[144:147]
 v_fma_f32 v39, s40, v39, v47
 v_fma_f32 v36, s40, v36, v44
 v_mfma_f32_16x16x32_bf16 v[160:163], a[188:191], a[240:243], v[160:163]
 ds_read_b128 a[240:243], v7 offset:20480
 ds_write_b128 v8, v[20:23] offset:8192
 s_waitcnt lgkmcnt(6)
 v_mfma_f32_16x16x32_bf16 v[176:179], a[176:179], a[244:247], v[176:179]
 v_fma_f32 v37, s40, v37, v45
 v_add_f32 v28, v28, v50
 v_add_f32 v29, v29, v51
 v_add_f32 v30, v30, v48
 v_mfma_f32_16x16x32_bf16 v[192:195], a[180:183], a[244:247], v[192:195]
 buffer_load_dwordx4 a[164:167], v1, s[20:23], s51 offen offset:1024
 v_add_f32 v31, v31, v49
 v_fmac_f32 v38, 4.0, v50
 v_mfma_f32_16x16x32_bf16 v[208:211], a[184:187], a[244:247], v[208:211]
 v_fmac_f32 v39, 4.0, v51
 ds_write_b128 v8, v[24:27] offset:12288
 v_mfma_f32_16x16x32_bf16 v[224:227], a[188:191], a[244:247], v[224:227]
 ds_read_b128 a[244:247], v7 offset:21504
 buffer_load_dwordx4 v[88:91], v2, s[16:19], s56 offen offset:0
 v_fmac_f32 v36, 4.0, v48
 s_waitcnt lgkmcnt(7)
 v_mfma_f32_16x16x32_bf16 v[240:243], a[176:179], a[248:251], v[240:243]
 v_fmac_f32 v37, 4.0, v49
 v_add_f32 v48, v28, v30
 v_add_f32 v49, v29, v31
 v_sub_f32 v28, v28, v30
 v_mfma_f32_16x16x32_bf16 a[0:3], a[180:183], a[248:251], a[0:3]
 buffer_load_dwordx4 a[168:171], v1, s[20:23], s51 offen offset:2048
 v_sub_f32 v29, v29, v31
 v_fma_f32 v50, 0.5, v36, v38
 v_mfma_f32_16x16x32_bf16 a[16:19], a[184:187], a[248:251], a[16:19]
 v_fma_f32 v51, 0.5, v37, v39
 v_fma_f32 v38, -0.5, v36, v38
 v_fma_f32 v39, -0.5, v37, v39
 v_mfma_f32_16x16x32_bf16 a[32:35], a[188:191], a[248:251], a[32:35]
 ds_read_b128 a[248:251], v7 offset:22528
 v_cvt_pk_bf16_f32 v12, v48, v49
 v_cvt_pk_bf16_f32 v16, v28, v29
 v_cvt_pk_bf16_f32 v20, v50, v51
 s_waitcnt lgkmcnt(6)
 v_mfma_f32_16x16x32_bf16 a[48:51], a[176:179], a[252:255], a[48:51]
 v_cvt_pk_bf16_f32 v24, v38, v39
 v_lshlrev_b32 v40, 16, v93
 v_and_b32 v41, s34, v93
 v_lshlrev_b32 v42, 16, v97
 v_mfma_f32_16x16x32_bf16 a[64:67], a[180:183], a[252:255], a[64:67]
 buffer_load_dwordx4 a[172:175], v1, s[20:23], s51 offen offset:3072
 v_and_b32 v43, s34, v97
 v_mfma_f32_16x16x32_bf16 a[80:83], a[184:187], a[252:255], a[80:83]
 v_lshlrev_b32 v56, 16, v101
 v_and_b32 v57, s34, v101
 v_lshlrev_b32 v58, 16, v105
 v_and_b32 v59, s34, v105
 v_mfma_f32_16x16x32_bf16 a[96:99], a[188:191], a[252:255], a[96:99]
 ds_read_b128 a[252:255], v7 offset:23552
 v_fma_f32 v32, s39, v42, v58
 v_fma_f32 v33, s39, v43, v59
 v_fma_f32 v34, s39, v40, v56
 s_waitcnt vmcnt(30) lgkmcnt(5)
 v_mfma_f32_16x16x32_bf16 v[116:119], a[192:195], a[240:243], v[116:119]
 v_fma_f32 v35, s39, v41, v57
 v_fma_f32 v42, s40, v42, v58
 v_fma_f32 v43, s40, v43, v59
 v_mfma_f32_16x16x32_bf16 v[132:135], a[196:199], a[240:243], v[132:135]
 buffer_load_dwordx4 a[176:179], v1, s[20:23], s52 offen offset:0
 v_fma_f32 v40, s40, v40, v56
 v_fma_f32 v41, s40, v41, v57
 v_mfma_f32_16x16x32_bf16 v[148:151], a[200:203], a[240:243], v[148:151]
 v_add_f32 v32, v32, v62
 v_add_f32 v33, v33, v63
 v_add_f32 v34, v34, v60
 v_add_f32 v35, v35, v61
 v_mfma_f32_16x16x32_bf16 v[164:167], a[204:207], a[240:243], v[164:167]
 ds_read_b128 a[240:243], v7 offset:24576
 v_fmac_f32 v42, 4.0, v62
 v_fmac_f32 v43, 4.0, v63
 v_fmac_f32 v40, 4.0, v60
 s_waitcnt lgkmcnt(3)
 v_mfma_f32_16x16x32_bf16 v[180:183], a[192:195], a[244:247], v[180:183]
 v_fmac_f32 v41, 4.0, v61
 v_add_f32 v60, v32, v34
 v_add_f32 v61, v33, v35
 v_mfma_f32_16x16x32_bf16 v[196:199], a[196:199], a[244:247], v[196:199]
 buffer_load_dwordx4 a[180:183], v1, s[20:23], s52 offen offset:1024
 v_sub_f32 v32, v32, v34
 v_sub_f32 v33, v33, v35
 v_mfma_f32_16x16x32_bf16 v[212:215], a[200:203], a[244:247], v[212:215]
 v_fma_f32 v62, 0.5, v40, v42
 v_fma_f32 v63, 0.5, v41, v43
 v_fma_f32 v42, -0.5, v40, v42
 v_fma_f32 v43, -0.5, v41, v43
 v_mfma_f32_16x16x32_bf16 v[228:231], a[204:207], a[244:247], v[228:231]
 ds_read_b128 a[244:247], v7 offset:25600
 v_cvt_pk_bf16_f32 v13, v60, v61
 v_cvt_pk_bf16_f32 v17, v32, v33
 s_waitcnt lgkmcnt(3)
 v_mfma_f32_16x16x32_bf16 v[244:247], a[192:195], a[248:251], v[244:247]
 v_cvt_pk_bf16_f32 v21, v62, v63
 v_cvt_pk_bf16_f32 v25, v42, v43
 v_lshlrev_b32 v48, 16, v94
 v_and_b32 v49, s34, v94
 v_mfma_f32_16x16x32_bf16 a[4:7], a[196:199], a[248:251], a[4:7]
 buffer_load_dwordx4 a[184:187], v1, s[20:23], s52 offen offset:2048
 v_lshlrev_b32 v50, 16, v98
 v_and_b32 v51, s34, v98
 v_mfma_f32_16x16x32_bf16 a[20:23], a[200:203], a[248:251], a[20:23]
 v_lshlrev_b32 v28, 16, v102
 v_and_b32 v29, s34, v102
 v_lshlrev_b32 v30, 16, v106
 v_mfma_f32_16x16x32_bf16 a[36:39], a[204:207], a[248:251], a[36:39]
 ds_read_b128 a[248:251], v7 offset:26624
 v_and_b32 v31, s34, v106
 v_fma_f32 v36, s39, v50, v30
 v_fma_f32 v37, s39, v51, v31
 s_waitcnt lgkmcnt(3)
 v_mfma_f32_16x16x32_bf16 a[52:55], a[192:195], a[252:255], a[52:55]
 v_fma_f32 v38, s39, v48, v28
 v_fma_f32 v39, s39, v49, v29
 v_fma_f32 v50, s40, v50, v30
 v_fma_f32 v51, s40, v51, v31
 v_mfma_f32_16x16x32_bf16 a[68:71], a[196:199], a[252:255], a[68:71]
 buffer_load_dwordx4 a[188:191], v1, s[20:23], s52 offen offset:3072
 v_fma_f32 v48, s40, v48, v28
 v_fma_f32 v49, s40, v49, v29
 v_mfma_f32_16x16x32_bf16 a[84:87], a[200:203], a[252:255], a[84:87]
 v_add_f32 v36, v36, v54
 v_add_f32 v37, v37, v55
 v_add_f32 v38, v38, v52
 v_mfma_f32_16x16x32_bf16 a[100:103], a[204:207], a[252:255], a[100:103]
 ds_read_b128 a[252:255], v7 offset:27648
 v_add_f32 v39, v39, v53
 v_fmac_f32 v50, 4.0, v54
 v_fmac_f32 v51, 4.0, v55
 s_waitcnt vmcnt(30) lgkmcnt(3)
 v_mfma_f32_16x16x32_bf16 v[120:123], a[208:211], a[240:243], v[120:123]
 v_fmac_f32 v48, 4.0, v52
 v_fmac_f32 v49, 4.0, v53
 v_add_f32 v52, v36, v38
 v_add_f32 v53, v37, v39
 v_mfma_f32_16x16x32_bf16 v[136:139], a[212:215], a[240:243], v[136:139]
 buffer_load_dwordx4 a[192:195], v1, s[20:23], s53 offen offset:0
 v_sub_f32 v36, v36, v38
 v_mfma_f32_16x16x32_bf16 v[152:155], a[216:219], a[240:243], v[152:155]
 v_sub_f32 v37, v37, v39
 v_fma_f32 v54, 0.5, v48, v50
 v_fma_f32 v55, 0.5, v49, v51
 v_fma_f32 v50, -0.5, v48, v50
 v_mfma_f32_16x16x32_bf16 v[168:171], a[220:223], a[240:243], v[168:171]
 ds_read_b128 a[240:243], v7 offset:28672
 v_fma_f32 v51, -0.5, v49, v51
 v_cvt_pk_bf16_f32 v14, v52, v53
 v_cvt_pk_bf16_f32 v18, v36, v37
 s_waitcnt lgkmcnt(3)
 v_mfma_f32_16x16x32_bf16 v[184:187], a[208:211], a[244:247], v[184:187]
 v_cvt_pk_bf16_f32 v22, v54, v55
 v_cvt_pk_bf16_f32 v26, v50, v51
 v_lshlrev_b32 v60, 16, v95
 v_and_b32 v61, s34, v95
 v_mfma_f32_16x16x32_bf16 v[200:203], a[212:215], a[244:247], v[200:203]
 buffer_load_dwordx4 a[196:199], v1, s[20:23], s53 offen offset:1024
 v_lshlrev_b32 v62, 16, v99
 v_mfma_f32_16x16x32_bf16 v[216:219], a[216:219], a[244:247], v[216:219]
 v_and_b32 v63, s34, v99
 v_lshlrev_b32 v32, 16, v103
 v_and_b32 v33, s34, v103
 v_lshlrev_b32 v34, 16, v107
 v_mfma_f32_16x16x32_bf16 v[232:235], a[220:223], a[244:247], v[232:235]
 ds_read_b128 a[244:247], v7 offset:29696
 v_and_b32 v35, s34, v107
 s_waitcnt lgkmcnt(3)
 v_mfma_f32_16x16x32_bf16 v[248:251], a[208:211], a[248:251], v[248:251]
 v_fma_f32 v40, s39, v62, v34
 v_mfma_f32_16x16x32_bf16 a[8:11], a[212:215], a[248:251], a[8:11]
 buffer_load_dwordx4 a[200:203], v1, s[20:23], s53 offen offset:2048
 v_fma_f32 v41, s39, v63, v35
 v_fma_f32 v42, s39, v60, v32
 v_mfma_f32_16x16x32_bf16 a[24:27], a[216:219], a[248:251], a[24:27]
 v_fma_f32 v43, s39, v61, v33
 v_fma_f32 v62, s40, v62, v34
 v_fma_f32 v63, s40, v63, v35
 v_fma_f32 v60, s40, v60, v32
 v_mfma_f32_16x16x32_bf16 a[40:43], a[220:223], a[248:251], a[40:43]
 ds_read_b128 a[248:251], v7 offset:30720
 buffer_load_dwordx4 v[92:95], v2, s[16:19], s56 offen offset:2048
 v_fma_f32 v61, s40, v61, v33
 v_add_f32 v40, v40, v66
 s_waitcnt lgkmcnt(3)
 v_mfma_f32_16x16x32_bf16 a[56:59], a[208:211], a[252:255], a[56:59]
 v_add_f32 v41, v41, v67
 v_add_f32 v42, v42, v64
 v_add_f32 v43, v43, v65
 v_fmac_f32 v62, 4.0, v66
 v_mfma_f32_16x16x32_bf16 a[72:75], a[212:215], a[252:255], a[72:75]
 buffer_load_dwordx4 a[204:207], v1, s[20:23], s53 offen offset:3072
 v_fmac_f32 v63, 4.0, v67
 v_fmac_f32 v60, 4.0, v64
 v_mfma_f32_16x16x32_bf16 a[88:91], a[216:219], a[252:255], a[88:91]
 v_fmac_f32 v61, 4.0, v65
 v_add_f32 v64, v40, v42
 v_add_f32 v65, v41, v43
 v_sub_f32 v40, v40, v42
 v_mfma_f32_16x16x32_bf16 a[104:107], a[220:223], a[252:255], a[104:107]
 ds_read_b128 a[252:255], v7 offset:31744
 v_sub_f32 v41, v41, v43
 v_fma_f32 v66, 0.5, v60, v62
 s_waitcnt vmcnt(30) lgkmcnt(3)
 v_mfma_f32_16x16x32_bf16 v[124:127], a[224:227], a[240:243], v[124:127]
 v_fma_f32 v67, 0.5, v61, v63
 v_fma_f32 v62, -0.5, v60, v62
 v_fma_f32 v63, -0.5, v61, v63
 v_cvt_pk_bf16_f32 v15, v64, v65
 v_mfma_f32_16x16x32_bf16 v[140:143], a[228:231], a[240:243], v[140:143]
 buffer_load_dwordx4 a[208:211], v1, s[20:23], s54 offen offset:0
 v_cvt_pk_bf16_f32 v19, v40, v41
 v_cvt_pk_bf16_f32 v23, v66, v67
 v_mfma_f32_16x16x32_bf16 v[156:159], a[232:235], a[240:243], v[156:159]
 v_cvt_pk_bf16_f32 v27, v62, v63
 s_waitcnt vmcnt(18)
 v_lshlrev_b32 v52, 16, v68
 v_and_b32 v53, s34, v68
 v_mfma_f32_16x16x32_bf16 v[172:175], a[236:239], a[240:243], v[172:175]
 ds_read_b128 a[240:243], v7 offset:32768
 buffer_load_dwordx4 v[96:99], v2, s[16:19], s57 offen offset:0
 v_lshlrev_b32 v54, 16, v72
 v_and_b32 v55, s34, v72
 s_waitcnt lgkmcnt(3)
 v_mfma_f32_16x16x32_bf16 v[188:191], a[224:227], a[244:247], v[188:191]
 ds_write_b128 v8, v[12:15] offset:1024
 v_lshlrev_b32 v36, 16, v76
 v_mfma_f32_16x16x32_bf16 v[204:207], a[228:231], a[244:247], v[204:207]
 buffer_load_dwordx4 a[212:215], v1, s[20:23], s54 offen offset:1024
 v_and_b32 v37, s34, v76
 v_mfma_f32_16x16x32_bf16 v[220:223], a[232:235], a[244:247], v[220:223]
 v_lshlrev_b32 v38, 16, v80
 v_and_b32 v39, s34, v80
 v_fma_f32 v48, s39, v54, v38
 v_fma_f32 v49, s39, v55, v39
 v_mfma_f32_16x16x32_bf16 v[236:239], a[236:239], a[244:247], v[236:239]
 ds_read_b128 a[244:247], v7 offset:33792
 v_fma_f32 v50, s39, v52, v36
 s_waitcnt lgkmcnt(4)
 v_mfma_f32_16x16x32_bf16 v[252:255], a[224:227], a[248:251], v[252:255]
 ds_write_b128 v8, v[16:19] offset:5120
 v_fma_f32 v51, s39, v53, v37
 v_fma_f32 v54, s40, v54, v38
 v_mfma_f32_16x16x32_bf16 a[12:15], a[228:231], a[248:251], a[12:15]
 buffer_load_dwordx4 a[216:219], v1, s[20:23], s54 offen offset:2048
 v_fma_f32 v55, s40, v55, v39
 v_mfma_f32_16x16x32_bf16 a[28:31], a[232:235], a[248:251], a[28:31]
 v_fma_f32 v52, s40, v52, v36
 v_fma_f32 v53, s40, v53, v37
 v_add_f32 v48, v48, v46
 v_add_f32 v49, v49, v47
 v_mfma_f32_16x16x32_bf16 a[44:47], a[236:239], a[248:251], a[44:47]
 ds_read_b128 a[248:251], v7 offset:34816
 ds_write_b128 v8, v[20:23] offset:9216
 s_waitcnt lgkmcnt(6)
 v_mfma_f32_16x16x32_bf16 a[60:63], a[224:227], a[252:255], a[60:63]
 v_add_f32 v50, v50, v44
 v_add_f32 v51, v51, v45
 v_mfma_f32_16x16x32_bf16 a[76:79], a[228:231], a[252:255], a[76:79]
 buffer_load_dwordx4 a[220:223], v1, s[20:23], s54 offen offset:3072
 v_fmac_f32 v54, 4.0, v46
 v_fmac_f32 v55, 4.0, v47
 v_mfma_f32_16x16x32_bf16 a[92:95], a[232:235], a[252:255], a[92:95]
 v_fmac_f32 v52, 4.0, v44
 v_fmac_f32 v53, 4.0, v45
 v_add_f32 v44, v48, v50
 v_mfma_f32_16x16x32_bf16 a[108:111], a[236:239], a[252:255], a[108:111]
 ds_read_b128 a[252:255], v7 offset:35840
 ds_write_b128 v8, v[24:27] offset:13312
 s_waitcnt lgkmcnt(7)
 v_mfma_f32_16x16x32_bf16 v[112:115], a[112:115], a[240:243], v[112:115]
 v_add_f32 v45, v49, v51
 v_sub_f32 v48, v48, v50
 v_sub_f32 v49, v49, v51
 v_mfma_f32_16x16x32_bf16 v[128:131], a[116:119], a[240:243], v[128:131]
 buffer_load_dwordx4 a[224:227], v1, s[20:23], s55 offen offset:0
 v_fma_f32 v46, 0.5, v52, v54
 v_fma_f32 v47, 0.5, v53, v55
 v_mfma_f32_16x16x32_bf16 v[144:147], a[120:123], a[240:243], v[144:147]
 v_fma_f32 v54, -0.5, v52, v54
 v_fma_f32 v55, -0.5, v53, v55
 v_cvt_pk_bf16_f32 v12, v44, v45
 v_cvt_pk_bf16_f32 v16, v48, v49
 v_mfma_f32_16x16x32_bf16 v[160:163], a[124:127], a[240:243], v[160:163]
 ds_read_b128 a[240:243], v7 offset:36864
 v_cvt_pk_bf16_f32 v20, v46, v47
 v_cvt_pk_bf16_f32 v24, v54, v55
 s_waitcnt lgkmcnt(6)
 v_mfma_f32_16x16x32_bf16 v[176:179], a[112:115], a[244:247], v[176:179]
 v_lshlrev_b32 v64, 16, v69
 v_and_b32 v65, s34, v69
 v_lshlrev_b32 v66, 16, v73
 v_and_b32 v67, s34, v73
 v_mfma_f32_16x16x32_bf16 v[192:195], a[116:119], a[244:247], v[192:195]
 buffer_load_dwordx4 a[228:231], v1, s[20:23], s55 offen offset:1024
 v_lshlrev_b32 v40, 16, v77
 v_and_b32 v41, s34, v77
 v_mfma_f32_16x16x32_bf16 v[208:211], a[120:123], a[244:247], v[208:211]
 v_lshlrev_b32 v42, 16, v81
 v_and_b32 v43, s34, v81
 v_fma_f32 v60, s39, v66, v42
 v_mfma_f32_16x16x32_bf16 v[224:227], a[124:127], a[244:247], v[224:227]
 ds_read_b128 a[244:247], v7 offset:37888
 v_fma_f32 v61, s39, v67, v43
 v_fma_f32 v62, s39, v64, v40
 v_fma_f32 v63, s39, v65, v41
 s_waitcnt lgkmcnt(5)
 v_mfma_f32_16x16x32_bf16 v[240:243], a[112:115], a[248:251], v[240:243]
 v_fma_f32 v66, s40, v66, v42
 v_fma_f32 v67, s40, v67, v43
 v_fma_f32 v64, s40, v64, v40
 v_fma_f32 v65, s40, v65, v41
 v_mfma_f32_16x16x32_bf16 a[0:3], a[116:119], a[248:251], a[0:3]
 buffer_load_dwordx4 a[232:235], v1, s[20:23], s55 offen offset:2048
 v_add_f32 v60, v60, v58
 v_add_f32 v61, v61, v59
 v_mfma_f32_16x16x32_bf16 a[16:19], a[120:123], a[248:251], a[16:19]
 v_add_f32 v62, v62, v56
 v_add_f32 v63, v63, v57
 v_fmac_f32 v66, 4.0, v58
 v_mfma_f32_16x16x32_bf16 a[32:35], a[124:127], a[248:251], a[32:35]
 ds_read_b128 a[248:251], v7 offset:38912
 v_fmac_f32 v67, 4.0, v59
 v_fmac_f32 v64, 4.0, v56
 v_fmac_f32 v65, 4.0, v57
 s_waitcnt lgkmcnt(4)
 v_mfma_f32_16x16x32_bf16 a[48:51], a[112:115], a[252:255], a[48:51]
 v_add_f32 v56, v60, v62
 v_add_f32 v57, v61, v63
 v_sub_f32 v60, v60, v62
 v_sub_f32 v61, v61, v63
 v_mfma_f32_16x16x32_bf16 a[64:67], a[116:119], a[252:255], a[64:67]
 buffer_load_dwordx4 a[236:239], v1, s[20:23], s55 offen offset:3072
 v_fma_f32 v58, 0.5, v64, v66
 v_mfma_f32_16x16x32_bf16 a[80:83], a[120:123], a[252:255], a[80:83]
 v_fma_f32 v59, 0.5, v65, v67
 v_fma_f32 v66, -0.5, v64, v66
 v_fma_f32 v67, -0.5, v65, v67
 v_cvt_pk_bf16_f32 v13, v56, v57
 v_mfma_f32_16x16x32_bf16 a[96:99], a[124:127], a[252:255], a[96:99]
 ds_read_b128 a[252:255], v7 offset:39936
 v_cvt_pk_bf16_f32 v17, v60, v61
 v_cvt_pk_bf16_f32 v21, v58, v59
 v_cvt_pk_bf16_f32 v25, v66, v67
 s_waitcnt lgkmcnt(3)
 v_mfma_f32_16x16x32_bf16 v[116:119], a[128:131], a[240:243], v[116:119]
 v_lshlrev_b32 v44, 16, v70
 v_and_b32 v45, s34, v70
 v_lshlrev_b32 v46, 16, v74
 v_mfma_f32_16x16x32_bf16 v[132:135], a[132:135], a[240:243], v[132:135]
 s_cmp_eq_u32 s31, 7
 s_cselect_b32 s36, s84, s56
 s_cselect_b32 s37, -1, 0
 s_add_u32 s20, s20, s36
 s_addc_u32 s21, s21, s37
 buffer_load_dwordx4 a[112:115], v1, s[20:23], s48 offen offset:0
 v_mfma_f32_16x16x32_bf16 v[148:151], a[136:139], a[240:243], v[148:151]
 v_and_b32 v47, s34, v74
 v_lshlrev_b32 v48, 16, v78
 v_and_b32 v49, s34, v78
 v_lshlrev_b32 v50, 16, v82
 v_mfma_f32_16x16x32_bf16 v[164:167], a[140:143], a[240:243], v[164:167]
 ds_read_b128 a[240:243], v7 offset:40960
 v_and_b32 v51, s34, v82
 v_fma_f32 v52, s39, v46, v50
 v_fma_f32 v53, s39, v47, v51
 s_waitcnt lgkmcnt(3)
 v_mfma_f32_16x16x32_bf16 v[180:183], a[128:131], a[244:247], v[180:183]
 v_fma_f32 v54, s39, v44, v48
 v_fma_f32 v55, s39, v45, v49
 v_fma_f32 v46, s40, v46, v50
 v_fma_f32 v47, s40, v47, v51
 v_mfma_f32_16x16x32_bf16 v[196:199], a[132:135], a[244:247], v[196:199]
 buffer_load_dwordx4 a[116:119], v1, s[20:23], s48 offen offset:1024
 v_fma_f32 v44, s40, v44, v48
 v_mfma_f32_16x16x32_bf16 v[212:215], a[136:139], a[244:247], v[212:215]
 v_fma_f32 v45, s40, v45, v49
 v_add_f32 v52, v52, v30
 v_add_f32 v53, v53, v31
 v_add_f32 v54, v54, v28
 v_mfma_f32_16x16x32_bf16 v[228:231], a[140:143], a[244:247], v[228:231]
 ds_read_b128 a[244:247], v7 offset:41984
 v_add_f32 v55, v55, v29
 v_fmac_f32 v46, 4.0, v30
 v_fmac_f32 v47, 4.0, v31
 s_waitcnt lgkmcnt(3)
 v_mfma_f32_16x16x32_bf16 v[244:247], a[128:131], a[248:251], v[244:247]
 v_fmac_f32 v44, 4.0, v28
 v_fmac_f32 v45, 4.0, v29
 v_add_f32 v28, v52, v54
 v_mfma_f32_16x16x32_bf16 a[4:7], a[132:135], a[248:251], a[4:7]
 buffer_load_dwordx4 a[120:123], v1, s[20:23], s48 offen offset:2048
 v_add_f32 v29, v53, v55
 v_sub_f32 v52, v52, v54
 v_mfma_f32_16x16x32_bf16 a[20:23], a[136:139], a[248:251], a[20:23]
 v_sub_f32 v53, v53, v55
 v_fma_f32 v30, 0.5, v44, v46
 v_fma_f32 v31, 0.5, v45, v47
 v_fma_f32 v46, -0.5, v44, v46
 v_mfma_f32_16x16x32_bf16 a[36:39], a[140:143], a[248:251], a[36:39]
 ds_read_b128 a[248:251], v7 offset:43008
 v_fma_f32 v47, -0.5, v45, v47
 v_cvt_pk_bf16_f32 v14, v28, v29
 s_waitcnt lgkmcnt(3)
 v_mfma_f32_16x16x32_bf16 a[52:55], a[128:131], a[252:255], a[52:55]
 v_cvt_pk_bf16_f32 v18, v52, v53
 v_cvt_pk_bf16_f32 v22, v30, v31
 v_cvt_pk_bf16_f32 v26, v46, v47
 v_lshlrev_b32 v56, 16, v71
 v_mfma_f32_16x16x32_bf16 a[68:71], a[132:135], a[252:255], a[68:71]
 buffer_load_dwordx4 a[124:127], v1, s[20:23], s48 offen offset:3072
 v_and_b32 v57, s34, v71
 v_lshlrev_b32 v58, 16, v75
 v_mfma_f32_16x16x32_bf16 a[84:87], a[136:139], a[252:255], a[84:87]
 v_and_b32 v59, s34, v75
 v_lshlrev_b32 v60, 16, v79
 v_and_b32 v61, s34, v79
 v_lshlrev_b32 v62, 16, v83
 v_mfma_f32_16x16x32_bf16 a[100:103], a[140:143], a[252:255], a[100:103]
 ds_read_b128 a[252:255], v7 offset:44032
 v_and_b32 v63, s34, v83
 s_waitcnt vmcnt(28) lgkmcnt(3)
 v_mfma_f32_16x16x32_bf16 v[120:123], a[144:147], a[240:243], v[120:123]
 v_mfma_f32_16x16x32_bf16 v[136:139], a[148:151], a[240:243], v[136:139]
 buffer_load_dwordx4 a[128:131], v1, s[20:23], s49 offen offset:0
 v_mfma_f32_16x16x32_bf16 v[152:155], a[152:155], a[240:243], v[152:155]
 v_mfma_f32_16x16x32_bf16 v[168:171], a[156:159], a[240:243], v[168:171]
 ds_read_b128 a[240:243], v7 offset:45056
 s_add_u32 s32, s32, 1
 s_and_b32 s44, s32, 3
 s_cmp_eq_u32 s44, 0
 s_cselect_b32 s38, s47, s58
 v_add_u32 v2, s38, v2
 v_add_u32 v3, s38, v3
 s_cmp_lg_u32 s32, 8
 s_cbranch_scc1 LS2_a
 s_mov_b32 s32, 0
 v_mov_b32 v2, v5
 v_mov_b32 v3, v6
LS2_a:
 s_cmp_lt_u32 s32, 4
 s_cselect_b32 s33, s59, 0
 v_mov_b32 v4, v2
 s_cbranch_scc1 LS2_b
 v_mov_b32 v4, v3
LS2_b:
 s_waitcnt lgkmcnt(3)
 v_mfma_f32_16x16x32_bf16 v[184:187], a[144:147], a[244:247], v[184:187]
 v_mfma_f32_16x16x32_bf16 v[200:203], a[148:151], a[244:247], v[200:203]
 buffer_load_dwordx4 a[132:135], v1, s[20:23], s49 offen offset:1024
 v_mfma_f32_16x16x32_bf16 v[216:219], a[152:155], a[244:247], v[216:219]
 v_mfma_f32_16x16x32_bf16 v[232:235], a[156:159], a[244:247], v[232:235]
 ds_read_b128 a[244:247], v7 offset:46080
 v_fma_f32 v64, s39, v58, v62
 v_fma_f32 v65, s39, v59, v63
 s_waitcnt lgkmcnt(3)
 v_mfma_f32_16x16x32_bf16 v[248:251], a[144:147], a[248:251], v[248:251]
 v_fma_f32 v66, s39, v56, v60
 v_fma_f32 v67, s39, v57, v61
 v_fma_f32 v58, s40, v58, v62
 v_fma_f32 v59, s40, v59, v63
 v_mfma_f32_16x16x32_bf16 a[8:11], a[148:151], a[248:251], a[8:11]
 buffer_load_dwordx4 a[136:139], v1, s[20:23], s49 offen offset:2048
 v_fma_f32 v56, s40, v56, v60
 v_mfma_f32_16x16x32_bf16 a[24:27], a[152:155], a[248:251], a[24:27]
 v_fma_f32 v57, s40, v57, v61
 v_add_f32 v64, v64, v34
 v_add_f32 v65, v65, v35
 v_add_f32 v66, v66, v32
 v_mfma_f32_16x16x32_bf16 a[40:43], a[156:159], a[248:251], a[40:43]
 ds_read_b128 a[248:251], v7 offset:47104
 buffer_load_dwordx4 v[68:71], v3, s[16:19], s33 offen offset:0
 v_add_f32 v67, v67, v33
 v_fmac_f32 v58, 4.0, v34
 v_fmac_f32 v59, 4.0, v35
 s_waitcnt lgkmcnt(3)
 v_mfma_f32_16x16x32_bf16 a[56:59], a[144:147], a[252:255], a[56:59]
 v_fmac_f32 v56, 4.0, v32
 v_fmac_f32 v57, 4.0, v33
 v_add_f32 v32, v64, v66
 v_mfma_f32_16x16x32_bf16 a[72:75], a[148:151], a[252:255], a[72:75]
 buffer_load_dwordx4 a[140:143], v1, s[20:23], s49 offen offset:3072
 v_add_f32 v33, v65, v67
 v_sub_f32 v64, v64, v66
 v_mfma_f32_16x16x32_bf16 a[88:91], a[152:155], a[252:255], a[88:91]
 v_sub_f32 v65, v65, v67
 v_fma_f32 v34, 0.5, v56, v58
 v_fma_f32 v35, 0.5, v57, v59
 v_fma_f32 v58, -0.5, v56, v58
 v_mfma_f32_16x16x32_bf16 a[104:107], a[156:159], a[252:255], a[104:107]
 ds_read_b128 a[252:255], v7 offset:48128
 v_fma_f32 v59, -0.5, v57, v59
 v_cvt_pk_bf16_f32 v15, v32, v33
 v_cvt_pk_bf16_f32 v19, v64, v65
 s_waitcnt vmcnt(27) lgkmcnt(3)
 v_mfma_f32_16x16x32_bf16 v[124:127], a[160:163], a[240:243], v[124:127]
 v_cvt_pk_bf16_f32 v23, v34, v35
 v_cvt_pk_bf16_f32 v27, v58, v59
 s_waitcnt vmcnt(16)
 v_lshlrev_b32 v28, 16, v84
 v_mfma_f32_16x16x32_bf16 v[140:143], a[164:167], a[240:243], v[140:143]
 buffer_load_dwordx4 a[144:147], v1, s[20:23], s50 offen offset:0
 v_and_b32 v29, s34, v84
 v_lshlrev_b32 v30, 16, v88
 v_mfma_f32_16x16x32_bf16 v[156:159], a[168:171], a[240:243], v[156:159]
 v_and_b32 v31, s34, v88
 v_lshlrev_b32 v52, 16, v92
 v_and_b32 v53, s34, v92
 v_lshlrev_b32 v54, 16, v96
 v_mfma_f32_16x16x32_bf16 v[172:175], a[172:175], a[240:243], v[172:175]
 ds_read_b128 a[240:243], v7 offset:49152
 buffer_load_dwordx4 v[72:75], v3, s[16:19], s33 offen offset:2048
 s_add_u32 s33, s33, 4096
 ds_write_b128 v8, v[12:15] offset:2048
 s_waitcnt lgkmcnt(4)
 v_mfma_f32_16x16x32_bf16 v[188:191], a[160:163], a[244:247], v[188:191]
 v_and_b32 v55, s34, v96
 v_fma_f32 v44, s39, v30, v54
 v_mfma_f32_16x16x32_bf16 v[204:207], a[164:167], a[244:247], v[204:207]
 buffer_load_dwordx4 a[148:151], v1, s[20:23], s50 offen offset:1024
 v_fma_f32 v45, s39, v31, v55
 v_fma_f32 v46, s39, v28, v52
 v_mfma_f32_16x16x32_bf16 v[220:223], a[168:171], a[244:247], v[220:223]
 v_fma_f32 v47, s39, v29, v53
 v_fma_f32 v30, s40, v30, v54
 v_fma_f32 v31, s40, v31, v55
 v_mfma_f32_16x16x32_bf16 v[236:239], a[172:175], a[244:247], v[236:239]
 ds_read_b128 a[244:247], v7 offset:50176
 ds_write_b128 v8, v[16:19] offset:6144
 s_waitcnt lgkmcnt(5)
 v_mfma_f32_16x16x32_bf16 v[252:255], a[160:163], a[248:251], v[252:255]
 v_fma_f32 v28, s40, v28, v52
 v_fma_f32 v29, s40, v29, v53
 v_add_f32 v44, v44, v38
 v_mfma_f32_16x16x32_bf16 a[12:15], a[164:167], a[248:251], a[12:15]
 buffer_load_dwordx4 a[152:155], v1, s[20:23], s50 offen offset:2048
 v_add_f32 v45, v45, v39
 v_add_f32 v46, v46, v36
 v_mfma_f32_16x16x32_bf16 a[28:31], a[168:171], a[248:251], a[28:31]
 v_add_f32 v47, v47, v37
 v_fmac_f32 v30, 4.0, v38
 v_mfma_f32_16x16x32_bf16 a[44:47], a[172:175], a[248:251], a[44:47]
 ds_read_b128 a[248:251], v7 offset:51200
 buffer_load_dwordx4 v[76:79], v3, s[16:19], s33 offen offset:0
 ds_write_b128 v8, v[20:23] offset:10240
 s_waitcnt lgkmcnt(6)
 v_mfma_f32_16x16x32_bf16 a[60:63], a[160:163], a[252:255], a[60:63]
 v_fmac_f32 v31, 4.0, v39
 v_fmac_f32 v28, 4.0, v36
 v_fmac_f32 v29, 4.0, v37
 v_add_f32 v36, v44, v46
 v_mfma_f32_16x16x32_bf16 a[76:79], a[164:167], a[252:255], a[76:79]
 buffer_load_dwordx4 a[156:159], v1, s[20:23], s50 offen offset:3072
 v_add_f32 v37, v45, v47
 v_mfma_f32_16x16x32_bf16 a[92:95], a[168:171], a[252:255], a[92:95]
 v_sub_f32 v44, v44, v46
 v_sub_f32 v45, v45, v47
 ds_write_b128 v8, v[24:27] offset:14336
 v_mfma_f32_16x16x32_bf16 a[108:111], a[172:175], a[252:255], a[108:111]
 ds_read_b128 a[252:255], v7 offset:52224
 v_fma_f32 v38, 0.5, v28, v30
 s_waitcnt lgkmcnt(7)
 v_mfma_f32_16x16x32_bf16 v[112:115], a[176:179], a[240:243], v[112:115]
 v_fma_f32 v39, 0.5, v29, v31
 v_fma_f32 v30, -0.5, v28, v30
 v_fma_f32 v31, -0.5, v29, v31
 v_cvt_pk_bf16_f32 v12, v36, v37
 v_mfma_f32_16x16x32_bf16 v[128:131], a[180:183], a[240:243], v[128:131]
 buffer_load_dwordx4 a[160:163], v1, s[20:23], s51 offen offset:0
 v_cvt_pk_bf16_f32 v16, v44, v45
 v_mfma_f32_16x16x32_bf16 v[144:147], a[184:187], a[240:243], v[144:147]
 v_cvt_pk_bf16_f32 v20, v38, v39
 v_cvt_pk_bf16_f32 v24, v30, v31
 v_lshlrev_b32 v32, 16, v85
 v_and_b32 v33, s34, v85
 v_mfma_f32_16x16x32_bf16 v[160:163], a[188:191], a[240:243], v[160:163]
 ds_read_b128 a[240:243], v7 offset:53248
 buffer_load_dwordx4 v[80:83], v4, s[16:19], s33 offen offset:2048
 s_add_u32 s33, s33, 4096
 v_lshlrev_b32 v34, 16, v89
 v_and_b32 v35, s34, v89
 v_lshlrev_b32 v64, 16, v93
 s_waitcnt lgkmcnt(6)
 v_mfma_f32_16x16x32_bf16 v[176:179], a[176:179], a[244:247], v[176:179]
 v_and_b32 v65, s34, v93
 v_lshlrev_b32 v66, 16, v97
 v_and_b32 v67, s34, v97
 v_mfma_f32_16x16x32_bf16 v[192:195], a[180:183], a[244:247], v[192:195]
 buffer_load_dwordx4 a[164:167], v1, s[20:23], s51 offen offset:1024
 v_fma_f32 v56, s39, v34, v66
 v_fma_f32 v57, s39, v35, v67
 v_mfma_f32_16x16x32_bf16 v[208:211], a[184:187], a[244:247], v[208:211]
 v_fma_f32 v58, s39, v32, v64
 v_fma_f32 v59, s39, v33, v65
 v_fma_f32 v34, s40, v34, v66
 v_fma_f32 v35, s40, v35, v67
 v_mfma_f32_16x16x32_bf16 v[224:227], a[188:191], a[244:247], v[224:227]
 ds_read_b128 a[244:247], v7 offset:54272
 v_fma_f32 v32, s40, v32, v64
 v_fma_f32 v33, s40, v33, v65
 s_waitcnt lgkmcnt(5)
 v_mfma_f32_16x16x32_bf16 v[240:243], a[176:179], a[248:251], v[240:243]
 v_add_f32 v56, v56, v42
 v_add_f32 v57, v57, v43
 v_add_f32 v58, v58, v40
 v_add_f32 v59, v59, v41
 v_mfma_f32_16x16x32_bf16 a[0:3], a[180:183], a[248:251], a[0:3]
 buffer_load_dwordx4 a[168:171], v1, s[20:23], s51 offen offset:2048
 v_fmac_f32 v34, 4.0, v42
 v_fmac_f32 v35, 4.0, v43
 v_mfma_f32_16x16x32_bf16 a[16:19], a[184:187], a[248:251], a[16:19]
 v_fmac_f32 v32, 4.0, v40
 v_fmac_f32 v33, 4.0, v41
 v_add_f32 v40, v56, v58
 v_add_f32 v41, v57, v59
 v_mfma_f32_16x16x32_bf16 a[32:35], a[188:191], a[248:251], a[32:35]
 ds_read_b128 a[248:251], v7 offset:55296
 v_sub_f32 v56, v56, v58
 v_sub_f32 v57, v57, v59
 s_waitcnt lgkmcnt(3)
 v_mfma_f32_16x16x32_bf16 a[48:51], a[176:179], a[252:255], a[48:51]
 v_fma_f32 v42, 0.5, v32, v34
 v_fma_f32 v43, 0.5, v33, v35
 v_fma_f32 v34, -0.5, v32, v34
 v_fma_f32 v35, -0.5, v33, v35
 v_mfma_f32_16x16x32_bf16 a[64:67], a[180:183], a[252:255], a[64:67]
 buffer_load_dwordx4 a[172:175], v1, s[20:23], s51 offen offset:3072
 v_cvt_pk_bf16_f32 v13, v40, v41
 v_cvt_pk_bf16_f32 v17, v56, v57
 v_mfma_f32_16x16x32_bf16 a[80:83], a[184:187], a[252:255], a[80:83]
 v_cvt_pk_bf16_f32 v21, v42, v43
 v_cvt_pk_bf16_f32 v25, v34, v35
 v_lshlrev_b32 v36, 16, v86
 v_mfma_f32_16x16x32_bf16 a[96:99], a[188:191], a[252:255], a[96:99]
 ds_read_b128 a[252:255], v7 offset:56320
 v_and_b32 v37, s34, v86
 v_lshlrev_b32 v38, 16, v90
 v_and_b32 v39, s34, v90
 s_waitcnt lgkmcnt(3)
 v_mfma_f32_16x16x32_bf16 v[116:119], a[192:195], a[240:243], v[116:119]
 v_lshlrev_b32 v44, 16, v94
 v_and_b32 v45, s34, v94
 v_lshlrev_b32 v46, 16, v98
 v_and_b32 v47, s34, v98
 v_mfma_f32_16x16x32_bf16 v[132:135], a[196:199], a[240:243], v[132:135]
 buffer_load_dwordx4 a[176:179], v1, s[20:23], s52 offen offset:0
 v_fma_f32 v28, s39, v38, v46
 v_mfma_f32_16x16x32_bf16 v[148:151], a[200:203], a[240:243], v[148:151]
 v_fma_f32 v29, s39, v39, v47
 v_fma_f32 v30, s39, v36, v44
 v_fma_f32 v31, s39, v37, v45
 v_fma_f32 v38, s40, v38, v46
 v_mfma_f32_16x16x32_bf16 v[164:167], a[204:207], a[240:243], v[164:167]
 ds_read_b128 a[240:243], v7 offset:57344
 v_fma_f32 v39, s40, v39, v47
 v_fma_f32 v36, s40, v36, v44
 v_fma_f32 v37, s40, v37, v45
 s_waitcnt lgkmcnt(3)
 v_mfma_f32_16x16x32_bf16 v[180:183], a[192:195], a[244:247], v[180:183]
 v_add_f32 v28, v28, v50
 v_add_f32 v29, v29, v51
 v_add_f32 v30, v30, v48
 v_add_f32 v31, v31, v49
 v_mfma_f32_16x16x32_bf16 v[196:199], a[196:199], a[244:247], v[196:199]
 buffer_load_dwordx4 a[180:183], v1, s[20:23], s52 offen offset:1024
 v_fmac_f32 v38, 4.0, v50
 v_mfma_f32_16x16x32_bf16 v[212:215], a[200:203], a[244:247], v[212:215]
 v_fmac_f32 v39, 4.0, v51
 v_fmac_f32 v36, 4.0, v48
 v_fmac_f32 v37, 4.0, v49
 v_add_f32 v48, v28, v30
 v_mfma_f32_16x16x32_bf16 v[228:231], a[204:207], a[244:247], v[228:231]
 ds_read_b128 a[244:247], v7 offset:58368
 v_add_f32 v49, v29, v31
 v_sub_f32 v28, v28, v30
 v_sub_f32 v29, v29, v31
 s_waitcnt lgkmcnt(3)
 v_mfma_f32_16x16x32_bf16 v[244:247], a[192:195], a[248:251], v[244:247]
 v_fma_f32 v50, 0.5, v36, v38
 v_fma_f32 v51, 0.5, v37, v39
 v_fma_f32 v38, -0.5, v36, v38
 v_mfma_f32_16x16x32_bf16 a[4:7], a[196:199], a[248:251], a[4:7]
 buffer_load_dwordx4 a[184:187], v1, s[20:23], s52 offen offset:2048
 v_fma_f32 v39, -0.5, v37, v39
 v_cvt_pk_bf16_f32 v14, v48, v49
 v_mfma_f32_16x16x32_bf16 a[20:23], a[200:203], a[248:251], a[20:23]
 v_cvt_pk_bf16_f32 v18, v28, v29
 v_cvt_pk_bf16_f32 v22, v50, v51
 v_cvt_pk_bf16_f32 v26, v38, v39
 v_lshlrev_b32 v40, 16, v87
 v_mfma_f32_16x16x32_bf16 a[36:39], a[204:207], a[248:251], a[36:39]
 ds_read_b128 a[248:251], v7 offset:59392
 v_and_b32 v41, s34, v87
 v_lshlrev_b32 v42, 16, v91
 s_waitcnt lgkmcnt(3)
 v_mfma_f32_16x16x32_bf16 a[52:55], a[192:195], a[252:255], a[52:55]
 v_and_b32 v43, s34, v91
 v_lshlrev_b32 v56, 16, v95
 v_and_b32 v57, s34, v95
 v_lshlrev_b32 v58, 16, v99
 v_mfma_f32_16x16x32_bf16 a[68:71], a[196:199], a[252:255], a[68:71]
 buffer_load_dwordx4 a[188:191], v1, s[20:23], s52 offen offset:3072
 v_and_b32 v59, s34, v99
 v_mfma_f32_16x16x32_bf16 a[84:87], a[200:203], a[252:255], a[84:87]
 v_mfma_f32_16x16x32_bf16 a[100:103], a[204:207], a[252:255], a[100:103]
 ds_read_b128 a[252:255], v7 offset:60416
 buffer_load_dwordx4 v[84:87], v2, s[16:19], s33 offen offset:0
 s_waitcnt vmcnt(29) lgkmcnt(3)
 v_mfma_f32_16x16x32_bf16 v[120:123], a[208:211], a[240:243], v[120:123]
 v_mfma_f32_16x16x32_bf16 v[136:139], a[212:215], a[240:243], v[136:139]
 buffer_load_dwordx4 a[192:195], v1, s[20:23], s53 offen offset:0
 v_mfma_f32_16x16x32_bf16 v[152:155], a[216:219], a[240:243], v[152:155]
 v_fma_f32 v32, s39, v42, v58
 v_fma_f32 v33, s39, v43, v59
 v_mfma_f32_16x16x32_bf16 v[168:171], a[220:223], a[240:243], v[168:171]
 ds_read_b128 a[240:243], v7 offset:61440
 v_fma_f32 v34, s39, v40, v56
 v_fma_f32 v35, s39, v41, v57
 v_fma_f32 v42, s40, v42, v58
 s_waitcnt lgkmcnt(3)
 v_mfma_f32_16x16x32_bf16 v[184:187], a[208:211], a[244:247], v[184:187]
 v_fma_f32 v43, s40, v43, v59
 v_fma_f32 v40, s40, v40, v56
 v_fma_f32 v41, s40, v41, v57
 v_add_f32 v32, v32, v62
 v_mfma_f32_16x16x32_bf16 v[200:203], a[212:215], a[244:247], v[200:203]
 buffer_load_dwordx4 a[196:199], v1, s[20:23], s53 offen offset:1024
 v_add_f32 v33, v33, v63
 v_mfma_f32_16x16x32_bf16 v[216:219], a[216:219], a[244:247], v[216:219]
 v_add_f32 v34, v34, v60
 v_add_f32 v35, v35, v61
 v_fmac_f32 v42, 4.0, v62
 v_fmac_f32 v43, 4.0, v63
 v_mfma_f32_16x16x32_bf16 v[232:235], a[220:223], a[244:247], v[232:235]
 ds_read_b128 a[244:247], v7 offset:62464
 buffer_load_dwordx4 v[88:91], v2, s[16:19], s33 offen offset:2048
 s_add_u32 s33, s33, 4096
 v_fmac_f32 v40, 4.0, v60
 v_fmac_f32 v41, 4.0, v61
 v_add_f32 v60, v32, v34
 s_waitcnt lgkmcnt(3)
 v_mfma_f32_16x16x32_bf16 v[248:251], a[208:211], a[248:251], v[248:251]
 v_add_f32 v61, v33, v35
 v_sub_f32 v32, v32, v34
 v_sub_f32 v33, v33, v35
 v_mfma_f32_16x16x32_bf16 a[8:11], a[212:215], a[248:251], a[8:11]
 buffer_load_dwordx4 a[200:203], v1, s[20:23], s53 offen offset:2048
 v_fma_f32 v62, 0.5, v40, v42
 v_fma_f32 v63, 0.5, v41, v43
 v_mfma_f32_16x16x32_bf16 a[24:27], a[216:219], a[248:251], a[24:27]
 v_fma_f32 v42, -0.5, v40, v42
 v_fma_f32 v43, -0.5, v41, v43
 v_cvt_pk_bf16_f32 v15, v60, v61
 v_cvt_pk_bf16_f32 v19, v32, v33
 v_mfma_f32_16x16x32_bf16 a[40:43], a[220:223], a[248:251], a[40:43]
 ds_read_b128 a[248:251], v7 offset:63488
 v_cvt_pk_bf16_f32 v23, v62, v63
 v_cvt_pk_bf16_f32 v27, v42, v43
 s_waitcnt lgkmcnt(3)
 v_mfma_f32_16x16x32_bf16 a[56:59], a[208:211], a[252:255], a[56:59]
 ds_write_b128 v8, v[12:15] offset:3072
 v_mfma_f32_16x16x32_bf16 a[72:75], a[212:215], a[252:255], a[72:75]
 buffer_load_dwordx4 a[204:207], v1, s[20:23], s53 offen offset:3072
 v_mfma_f32_16x16x32_bf16 a[88:91], a[216:219], a[252:255], a[88:91]
 ds_write_b128 v8, v[16:19] offset:7168
 v_mfma_f32_16x16x32_bf16 a[104:107], a[220:223], a[252:255], a[104:107]
 ds_read_b128 a[252:255], v7 offset:64512
 buffer_load_dwordx4 v[92:95], v2, s[16:19], s33 offen offset:0
 ds_write_b128 v8, v[20:23] offset:11264
 s_waitcnt vmcnt(31) lgkmcnt(6)
 v_mfma_f32_16x16x32_bf16 v[124:127], a[224:227], a[240:243], v[124:127]
 ds_write_b128 v8, v[24:27] offset:15360
 v_mfma_f32_16x16x32_bf16 v[140:143], a[228:231], a[240:243], v[140:143]
 buffer_load_dwordx4 a[208:211], v1, s[20:23], s54 offen offset:0
 v_mfma_f32_16x16x32_bf16 v[156:159], a[232:235], a[240:243], v[156:159]
 v_mfma_f32_16x16x32_bf16 v[172:175], a[236:239], a[240:243], v[172:175]
 s_waitcnt lgkmcnt(0)
 s_barrier
 v_xor_b32 v7, 0x10000, v7
 v_xor_b32 v8, 0x10000, v8
 ds_read_b128 a[240:243], v7 offset:0
 v_mfma_f32_16x16x32_bf16 v[188:191], a[224:227], a[244:247], v[188:191]
 v_mfma_f32_16x16x32_bf16 v[204:207], a[228:231], a[244:247], v[204:207]
 buffer_load_dwordx4 a[212:215], v1, s[20:23], s54 offen offset:1024
 v_mfma_f32_16x16x32_bf16 v[220:223], a[232:235], a[244:247], v[220:223]
 v_mfma_f32_16x16x32_bf16 v[236:239], a[236:239], a[244:247], v[236:239]
 ds_read_b128 a[244:247], v7 offset:1024
 buffer_load_dwordx4 v[96:99], v2, s[16:19], s33 offen offset:2048
 s_add_u32 s33, s33, 4096
 v_mfma_f32_16x16x32_bf16 v[252:255], a[224:227], a[248:251], v[252:255]
 v_mfma_f32_16x16x32_bf16 a[12:15], a[228:231], a[248:251], a[12:15]
 buffer_load_dwordx4 a[216:219], v1, s[20:23], s54 offen offset:2048
 v_mfma_f32_16x16x32_bf16 a[28:31], a[232:235], a[248:251], a[28:31]
 v_mfma_f32_16x16x32_bf16 a[44:47], a[236:239], a[248:251], a[44:47]
 ds_read_b128 a[248:251], v7 offset:2048
 v_mfma_f32_16x16x32_bf16 a[60:63], a[224:227], a[252:255], a[60:63]
 v_mfma_f32_16x16x32_bf16 a[76:79], a[228:231], a[252:255], a[76:79]
 buffer_load_dwordx4 a[220:223], v1, s[20:23], s54 offen offset:3072
 v_mfma_f32_16x16x32_bf16 a[92:95], a[232:235], a[252:255], a[92:95]
 v_mfma_f32_16x16x32_bf16 a[108:111], a[236:239], a[252:255], a[108:111]
 ds_read_b128 a[252:255], v7 offset:3072
 buffer_load_dwordx4 v[100:103], v2, s[16:19], s33 offen offset:0
 buffer_load_dwordx4 v[104:107], v2, s[16:19], s33 offen offset:2048
 s_add_u32 s33, s33, 4096
 s_mov_b32 s31, 1
 s_branch L_B1
.p2align 6
L_B2:
 s_waitcnt vmcnt(32) lgkmcnt(3)
 v_mfma_f32_16x16x32_bf16 v[112:115], a[112:115], a[240:243], v[112:115]
 s_waitcnt vmcnt(21)
 v_lshlrev_b32 v28, 16, v68
 v_and_b32 v29, s34, v68
 v_lshlrev_b32 v30, 16, v72
 v_and_b32 v31, s34, v72
 v_mfma_f32_16x16x32_bf16 v[128:131], a[116:119], a[240:243], v[128:131]
 buffer_load_dwordx4 a[224:227], v1, s[20:23], s55 offen offset:0
 v_lshlrev_b32 v32, 16, v76
 v_and_b32 v33, s34, v76
 v_mfma_f32_16x16x32_bf16 v[144:147], a[120:123], a[240:243], v[144:147]
 v_lshlrev_b32 v34, 16, v80
 v_and_b32 v35, s34, v80
 v_fmac_f32 v30, s40, v34
 v_mfma_f32_16x16x32_bf16 v[160:163], a[124:127], a[240:243], v[160:163]
 ds_read_b128 a[240:243], v7 offset:4096
 v_fmac_f32 v31, s40, v35
 v_fma_f32 v28, -s41, v32, v28
 v_fma_f32 v29, -s41, v33, v29
 s_waitcnt lgkmcnt(3)
 v_mfma_f32_16x16x32_bf16 v[176:179], a[112:115], a[244:247], v[176:179]
 v_fma_f32 v34, s43, v34, -v30
 v_fma_f32 v35, s43, v35, -v31
 v_lshlrev_b32 v36, 16, v69
 v_and_b32 v37, s34, v69
 v_mfma_f32_16x16x32_bf16 v[192:195], a[116:119], a[244:247], v[192:195]
 buffer_load_dwordx4 a[228:231], v1, s[20:23], s55 offen offset:1024
 v_lshlrev_b32 v38, 16, v73
 v_and_b32 v39, s34, v73
 v_mfma_f32_16x16x32_bf16 v[208:211], a[120:123], a[244:247], v[208:211]
 v_lshlrev_b32 v40, 16, v77
 v_and_b32 v41, s34, v77
 v_lshlrev_b32 v42, 16, v81
 v_and_b32 v43, s34, v81
 v_mfma_f32_16x16x32_bf16 v[224:227], a[124:127], a[244:247], v[224:227]
 ds_read_b128 a[244:247], v7 offset:5120
 v_fmac_f32 v38, s40, v42
 v_fmac_f32 v39, s40, v43
 s_waitcnt lgkmcnt(3)
 v_mfma_f32_16x16x32_bf16 v[240:243], a[112:115], a[248:251], v[240:243]
 v_fma_f32 v36, -s41, v40, v36
 v_fma_f32 v37, -s41, v41, v37
 v_fma_f32 v42, s43, v42, -v38
 v_fma_f32 v43, s43, v43, -v39
 v_mfma_f32_16x16x32_bf16 a[0:3], a[116:119], a[248:251], a[0:3]
 buffer_load_dwordx4 a[232:235], v1, s[20:23], s55 offen offset:2048
 v_lshlrev_b32 v44, 16, v70
 v_and_b32 v45, s34, v70
 v_mfma_f32_16x16x32_bf16 a[16:19], a[120:123], a[248:251], a[16:19]
 v_lshlrev_b32 v46, 16, v74
 v_and_b32 v47, s34, v74
 v_lshlrev_b32 v48, 16, v78
 v_and_b32 v49, s34, v78
 v_mfma_f32_16x16x32_bf16 a[32:35], a[124:127], a[248:251], a[32:35]
 ds_read_b128 a[248:251], v7 offset:6144
 v_lshlrev_b32 v50, 16, v82
 v_and_b32 v51, s34, v82
 v_fmac_f32 v46, s40, v50
 s_waitcnt lgkmcnt(3)
 v_mfma_f32_16x16x32_bf16 a[48:51], a[112:115], a[252:255], a[48:51]
 v_fmac_f32 v47, s40, v51
 v_fma_f32 v44, -s41, v48, v44
 v_fma_f32 v45, -s41, v49, v45
 v_mfma_f32_16x16x32_bf16 a[64:67], a[116:119], a[252:255], a[64:67]
 buffer_load_dwordx4 a[236:239], v1, s[20:23], s55 offen offset:3072
 v_fma_f32 v50, s43, v50, -v46
 v_fma_f32 v51, s43, v51, -v47
 v_mfma_f32_16x16x32_bf16 a[80:83], a[120:123], a[252:255], a[80:83]
 v_lshlrev_b32 v52, 16, v71
 v_and_b32 v53, s34, v71
 v_lshlrev_b32 v54, 16, v75
 v_and_b32 v55, s34, v75
 v_mfma_f32_16x16x32_bf16 a[96:99], a[124:127], a[252:255], a[96:99]
 ds_read_b128 a[252:255], v7 offset:7168
 v_lshlrev_b32 v56, 16, v79
 v_and_b32 v57, s34, v79
 v_lshlrev_b32 v58, 16, v83
 s_waitcnt lgkmcnt(3)
 v_mfma_f32_16x16x32_bf16 v[116:119], a[128:131], a[240:243], v[116:119]
 v_and_b32 v59, s34, v83
 v_mfma_f32_16x16x32_bf16 v[132:135], a[132:135], a[240:243], v[132:135]
 s_add_u32 s20, s20, 32768
 s_addc_u32 s21, s21, 0
 buffer_load_dwordx4 a[112:115], v1, s[20:23], s48 offen offset:0
 v_mfma_f32_16x16x32_bf16 v[148:151], a[136:139], a[240:243], v[148:151]
 v_mfma_f32_16x16x32_bf16 v[164:167], a[140:143], a[240:243], v[164:167]
 ds_read_b128 a[240:243], v7 offset:8192
 buffer_load_dwordx4 v[68:71], v2, s[16:19], s53 offen offset:0
 v_fmac_f32 v54, s40, v58
 s_waitcnt lgkmcnt(3)
 v_mfma_f32_16x16x32_bf16 v[180:183], a[128:131], a[244:247], v[180:183]
 v_fmac_f32 v55, s40, v59
 v_fma_f32 v52, -s41, v56, v52
 v_fma_f32 v53, -s41, v57, v53
 v_fma_f32 v58, s43, v58, -v54
 v_mfma_f32_16x16x32_bf16 v[196:199], a[132:135], a[244:247], v[196:199]
 buffer_load_dwordx4 a[116:119], v1, s[20:23], s48 offen offset:1024
 v_fma_f32 v59, s43, v59, -v55
 s_waitcnt vmcnt(11)
 v_lshlrev_b32 v60, 16, v84
 v_mfma_f32_16x16x32_bf16 v[212:215], a[136:139], a[244:247], v[212:215]
 v_and_b32 v61, s34, v84
 v_lshlrev_b32 v62, 16, v88
 v_and_b32 v63, s34, v88
 v_lshlrev_b32 v64, 16, v92
 v_mfma_f32_16x16x32_bf16 v[228:231], a[140:143], a[244:247], v[228:231]
 ds_read_b128 a[244:247], v7 offset:9216
 v_and_b32 v65, s34, v92
 v_lshlrev_b32 v66, 16, v96
 v_and_b32 v67, s34, v96
 s_waitcnt lgkmcnt(3)
 v_mfma_f32_16x16x32_bf16 v[244:247], a[128:131], a[248:251], v[244:247]
 v_fma_f32 v32, s43, v32, v64
 v_fma_f32 v33, s43, v33, v65
 v_fma_f32 v30, s43, v30, v62
 v_mfma_f32_16x16x32_bf16 a[4:7], a[132:135], a[248:251], a[4:7]
 buffer_load_dwordx4 a[120:123], v1, s[20:23], s48 offen offset:2048
 v_fma_f32 v31, s43, v31, v63
 v_fmac_f32 v28, s41, v60
 v_mfma_f32_16x16x32_bf16 a[20:23], a[136:139], a[248:251], a[20:23]
 v_fmac_f32 v29, s41, v61
 v_fma_f32 v34, -s41, v62, v34
 v_fma_f32 v35, -s41, v63, v35
 v_fmac_f32 v32, s42, v60
 v_mfma_f32_16x16x32_bf16 a[36:39], a[140:143], a[248:251], a[36:39]
 ds_read_b128 a[248:251], v7 offset:10240
 buffer_load_dwordx4 v[72:75], v2, s[16:19], s53 offen offset:2048
 v_fmac_f32 v33, s42, v61
 v_sub_f32 v28, v28, v64
 v_sub_f32 v29, v29, v65
 s_waitcnt lgkmcnt(3)
 v_mfma_f32_16x16x32_bf16 a[52:55], a[128:131], a[252:255], a[52:55]
 v_add_f32 v34, v34, v66
 v_add_f32 v35, v35, v67
 v_fma_f32 v30, 2.0, v30, v32
 v_fma_f32 v31, 2.0, v31, v33
 v_mfma_f32_16x16x32_bf16 a[68:71], a[132:135], a[252:255], a[68:71]
 buffer_load_dwordx4 a[124:127], v1, s[20:23], s48 offen offset:3072
 v_cvt_pk_bf16_f32 v20, v28, v29
 v_mfma_f32_16x16x32_bf16 a[84:87], a[136:139], a[252:255], a[84:87]
 v_cvt_pk_bf16_f32 v24, v34, v35
 v_fma_f32 v32, 2.0, v32, -v30
 v_fma_f32 v33, 2.0, v33, -v31
 v_cvt_pk_bf16_f32 v12, v30, v31
 v_mfma_f32_16x16x32_bf16 a[100:103], a[140:143], a[252:255], a[100:103]
 ds_read_b128 a[252:255], v7 offset:11264
 v_cvt_pk_bf16_f32 v16, v32, v33
 v_fmac_f32 v62, s40, v66
 v_fmac_f32 v63, s40, v67
 s_waitcnt lgkmcnt(3)
 v_mfma_f32_16x16x32_bf16 v[120:123], a[144:147], a[240:243], v[120:123]
 v_fma_f32 v60, -s41, v64, v60
 v_fma_f32 v61, -s41, v65, v61
 v_fma_f32 v66, s43, v66, -v62
 v_fma_f32 v67, s43, v67, -v63
 v_mfma_f32_16x16x32_bf16 v[136:139], a[148:151], a[240:243], v[136:139]
 buffer_load_dwordx4 a[128:131], v1, s[20:23], s49 offen offset:0
 v_lshlrev_b32 v28, 16, v85
 v_and_b32 v29, s34, v85
 v_mfma_f32_16x16x32_bf16 v[152:155], a[152:155], a[240:243], v[152:155]
 v_lshlrev_b32 v34, 16, v89
 v_and_b32 v35, s34, v89
 v_lshlrev_b32 v32, 16, v93
 v_mfma_f32_16x16x32_bf16 v[168:171], a[156:159], a[240:243], v[168:171]
 ds_read_b128 a[240:243], v7 offset:12288
 buffer_load_dwordx4 v[76:79], v2, s[16:19], s54 offen offset:0
 v_and_b32 v33, s34, v93
 v_lshlrev_b32 v30, 16, v97
 v_and_b32 v31, s34, v97
 s_waitcnt lgkmcnt(3)
 v_mfma_f32_16x16x32_bf16 v[184:187], a[144:147], a[244:247], v[184:187]
 v_fma_f32 v40, s43, v40, v32
 v_fma_f32 v41, s43, v41, v33
 v_fma_f32 v38, s43, v38, v34
 v_fma_f32 v39, s43, v39, v35
 v_mfma_f32_16x16x32_bf16 v[200:203], a[148:151], a[244:247], v[200:203]
 buffer_load_dwordx4 a[132:135], v1, s[20:23], s49 offen offset:1024
 v_fmac_f32 v36, s41, v28
 v_fmac_f32 v37, s41, v29
 v_mfma_f32_16x16x32_bf16 v[216:219], a[152:155], a[244:247], v[216:219]
 v_fma_f32 v42, -s41, v34, v42
 v_fma_f32 v43, -s41, v35, v43
 v_fmac_f32 v40, s42, v28
 v_fmac_f32 v41, s42, v29
 v_mfma_f32_16x16x32_bf16 v[232:235], a[156:159], a[244:247], v[232:235]
 ds_read_b128 a[244:247], v7 offset:13312
 v_sub_f32 v36, v36, v32
 v_sub_f32 v37, v37, v33
 s_waitcnt lgkmcnt(3)
 v_mfma_f32_16x16x32_bf16 v[248:251], a[144:147], a[248:251], v[248:251]
 v_add_f32 v42, v42, v30
 v_add_f32 v43, v43, v31
 v_fma_f32 v38, 2.0, v38, v40
 v_fma_f32 v39, 2.0, v39, v41
 v_mfma_f32_16x16x32_bf16 a[8:11], a[148:151], a[248:251], a[8:11]
 buffer_load_dwordx4 a[136:139], v1, s[20:23], s49 offen offset:2048
 v_cvt_pk_bf16_f32 v21, v36, v37
 v_cvt_pk_bf16_f32 v25, v42, v43
 v_mfma_f32_16x16x32_bf16 a[24:27], a[152:155], a[248:251], a[24:27]
 v_fma_f32 v40, 2.0, v40, -v38
 v_fma_f32 v41, 2.0, v41, -v39
 v_cvt_pk_bf16_f32 v13, v38, v39
 v_cvt_pk_bf16_f32 v17, v40, v41
 v_mfma_f32_16x16x32_bf16 a[40:43], a[156:159], a[248:251], a[40:43]
 ds_read_b128 a[248:251], v7 offset:14336
 buffer_load_dwordx4 v[80:83], v2, s[16:19], s54 offen offset:2048
 v_fmac_f32 v34, s40, v30
 v_fmac_f32 v35, s40, v31
 v_fma_f32 v28, -s41, v32, v28
 s_waitcnt lgkmcnt(3)
 v_mfma_f32_16x16x32_bf16 a[56:59], a[144:147], a[252:255], a[56:59]
 v_fma_f32 v29, -s41, v33, v29
 v_fma_f32 v30, s43, v30, -v34
 v_fma_f32 v31, s43, v31, -v35
 v_mfma_f32_16x16x32_bf16 a[72:75], a[148:151], a[252:255], a[72:75]
 buffer_load_dwordx4 a[140:143], v1, s[20:23], s49 offen offset:3072
 v_lshlrev_b32 v36, 16, v86
 v_and_b32 v37, s34, v86
 v_mfma_f32_16x16x32_bf16 a[88:91], a[152:155], a[252:255], a[88:91]
 v_lshlrev_b32 v42, 16, v90
 v_and_b32 v43, s34, v90
 v_lshlrev_b32 v40, 16, v94
 v_and_b32 v41, s34, v94
 v_mfma_f32_16x16x32_bf16 a[104:107], a[156:159], a[252:255], a[104:107]
 ds_read_b128 a[252:255], v7 offset:15360
 v_lshlrev_b32 v38, 16, v98
 v_and_b32 v39, s34, v98
 v_fma_f32 v48, s43, v48, v40
 s_waitcnt lgkmcnt(3)
 v_mfma_f32_16x16x32_bf16 v[124:127], a[160:163], a[240:243], v[124:127]
 v_fma_f32 v49, s43, v49, v41
 v_fma_f32 v46, s43, v46, v42
 v_fma_f32 v47, s43, v47, v43
 v_fmac_f32 v44, s41, v36
 v_mfma_f32_16x16x32_bf16 v[140:143], a[164:167], a[240:243], v[140:143]
 buffer_load_dwordx4 a[144:147], v1, s[20:23], s50 offen offset:0
 v_fmac_f32 v45, s41, v37
 v_mfma_f32_16x16x32_bf16 v[156:159], a[168:171], a[240:243], v[156:159]
 v_fma_f32 v50, -s41, v42, v50
 v_fma_f32 v51, -s41, v43, v51
 v_fmac_f32 v48, s42, v36
 v_fmac_f32 v49, s42, v37
 v_mfma_f32_16x16x32_bf16 v[172:175], a[172:175], a[240:243], v[172:175]
 ds_read_b128 a[240:243], v7 offset:16384
 v_sub_f32 v44, v44, v40
 v_sub_f32 v45, v45, v41
 v_add_f32 v50, v50, v38
 s_waitcnt lgkmcnt(3)
 v_mfma_f32_16x16x32_bf16 v[188:191], a[160:163], a[244:247], v[188:191]
 v_add_f32 v51, v51, v39
 v_fma_f32 v46, 2.0, v46, v48
 v_fma_f32 v47, 2.0, v47, v49
 v_cvt_pk_bf16_f32 v22, v44, v45
 v_mfma_f32_16x16x32_bf16 v[204:207], a[164:167], a[244:247], v[204:207]
 buffer_load_dwordx4 a[148:151], v1, s[20:23], s50 offen offset:1024
 v_cvt_pk_bf16_f32 v26, v50, v51
 v_fma_f32 v48, 2.0, v48, -v46
 v_mfma_f32_16x16x32_bf16 v[220:223], a[168:171], a[244:247], v[220:223]
 v_fma_f32 v49, 2.0, v49, -v47
 v_cvt_pk_bf16_f32 v14, v46, v47
 v_cvt_pk_bf16_f32 v18, v48, v49
 v_mfma_f32_16x16x32_bf16 v[236:239], a[172:175], a[244:247], v[236:239]
 ds_read_b128 a[244:247], v7 offset:17408
 v_fmac_f32 v42, s40, v38
 v_fmac_f32 v43, s40, v39
 v_fma_f32 v36, -s41, v40, v36
 s_waitcnt lgkmcnt(3)
 v_mfma_f32_16x16x32_bf16 v[252:255], a[160:163], a[248:251], v[252:255]
 v_fma_f32 v37, -s41, v41, v37
 v_fma_f32 v38, s43, v38, -v42
 v_fma_f32 v39, s43, v39, -v43
 v_lshlrev_b32 v44, 16, v87
 v_mfma_f32_16x16x32_bf16 a[12:15], a[164:167], a[248:251], a[12:15]
 buffer_load_dwordx4 a[152:155], v1, s[20:23], s50 offen offset:2048
 v_and_b32 v45, s34, v87
 v_lshlrev_b32 v50, 16, v91
 v_mfma_f32_16x16x32_bf16 a[28:31], a[168:171], a[248:251], a[28:31]
 v_and_b32 v51, s34, v91
 v_lshlrev_b32 v48, 16, v95
 v_and_b32 v49, s34, v95
 v_lshlrev_b32 v46, 16, v99
 v_mfma_f32_16x16x32_bf16 a[44:47], a[172:175], a[248:251], a[44:47]
 ds_read_b128 a[248:251], v7 offset:18432
 v_and_b32 v47, s34, v99
 s_waitcnt lgkmcnt(3)
 v_mfma_f32_16x16x32_bf16 a[60:63], a[160:163], a[252:255], a[60:63]
 v_mfma_f32_16x16x32_bf16 a[76:79], a[164:167], a[252:255], a[76:79]
 buffer_load_dwordx4 a[156:159], v1, s[20:23], s50 offen offset:3072
 v_mfma_f32_16x16x32_bf16 a[92:95], a[168:171], a[252:255], a[92:95]
 v_fma_f32 v56, s43, v56, v48
 v_fma_f32 v57, s43, v57, v49
 v_fma_f32 v54, s43, v54, v50
 v_mfma_f32_16x16x32_bf16 a[108:111], a[172:175], a[252:255], a[108:111]
 ds_read_b128 a[252:255], v7 offset:19456
 buffer_load_dwordx4 v[84:87], v2, s[16:19], s55 offen offset:0
 v_fma_f32 v55, s43, v55, v51
 v_fmac_f32 v52, s41, v44
 v_fmac_f32 v53, s41, v45
 s_waitcnt lgkmcnt(3)
 v_mfma_f32_16x16x32_bf16 v[112:115], a[176:179], a[240:243], v[112:115]
 v_fma_f32 v58, -s41, v50, v58
 v_fma_f32 v59, -s41, v51, v59
 v_fmac_f32 v56, s42, v44
 v_mfma_f32_16x16x32_bf16 v[128:131], a[180:183], a[240:243], v[128:131]
 buffer_load_dwordx4 a[160:163], v1, s[20:23], s51 offen offset:0
 v_fmac_f32 v57, s42, v45
 v_sub_f32 v52, v52, v48
 v_mfma_f32_16x16x32_bf16 v[144:147], a[184:187], a[240:243], v[144:147]
 v_sub_f32 v53, v53, v49
 v_add_f32 v58, v58, v46
 v_add_f32 v59, v59, v47
 v_fma_f32 v54, 2.0, v54, v56
 v_mfma_f32_16x16x32_bf16 v[160:163], a[188:191], a[240:243], v[160:163]
 ds_read_b128 a[240:243], v7 offset:20480
 v_fma_f32 v55, 2.0, v55, v57
 v_cvt_pk_bf16_f32 v23, v52, v53
 v_cvt_pk_bf16_f32 v27, v58, v59
 s_waitcnt lgkmcnt(3)
 v_mfma_f32_16x16x32_bf16 v[176:179], a[176:179], a[244:247], v[176:179]
 v_fma_f32 v56, 2.0, v56, -v54
 v_fma_f32 v57, 2.0, v57, -v55
 v_cvt_pk_bf16_f32 v15, v54, v55
 v_cvt_pk_bf16_f32 v19, v56, v57
 v_mfma_f32_16x16x32_bf16 v[192:195], a[180:183], a[244:247], v[192:195]
 buffer_load_dwordx4 a[164:167], v1, s[20:23], s51 offen offset:1024
 v_fmac_f32 v50, s40, v46
 v_mfma_f32_16x16x32_bf16 v[208:211], a[184:187], a[244:247], v[208:211]
 v_fmac_f32 v51, s40, v47
 v_fma_f32 v44, -s41, v48, v44
 v_fma_f32 v45, -s41, v49, v45
 v_fma_f32 v46, s43, v46, -v50
 v_mfma_f32_16x16x32_bf16 v[224:227], a[188:191], a[244:247], v[224:227]
 ds_read_b128 a[244:247], v7 offset:21504
 buffer_load_dwordx4 v[88:91], v2, s[16:19], s55 offen offset:2048
 v_fma_f32 v47, s43, v47, -v51
 s_waitcnt vmcnt(15)
 v_lshlrev_b32 v52, 16, v100
 v_and_b32 v53, s34, v100
 s_waitcnt lgkmcnt(3)
 v_mfma_f32_16x16x32_bf16 v[240:243], a[176:179], a[248:251], v[240:243]
 v_lshlrev_b32 v58, 16, v104
 ds_write_b128 v8, v[12:15] offset:0
 v_mfma_f32_16x16x32_bf16 a[0:3], a[180:183], a[248:251], a[0:3]
 buffer_load_dwordx4 a[168:171], v1, s[20:23], s51 offen offset:2048
 v_and_b32 v59, s34, v104
 v_mfma_f32_16x16x32_bf16 a[16:19], a[184:187], a[248:251], a[16:19]
 v_lshlrev_b32 v56, 16, v68
 v_and_b32 v57, s34, v68
 v_lshlrev_b32 v54, 16, v72
 v_mfma_f32_16x16x32_bf16 a[32:35], a[188:191], a[248:251], a[32:35]
 ds_read_b128 a[248:251], v7 offset:22528
 v_and_b32 v55, s34, v72
 v_fma_f32 v64, s43, v64, v56
 v_fma_f32 v65, s43, v65, v57
 s_waitcnt lgkmcnt(4)
 v_mfma_f32_16x16x32_bf16 a[48:51], a[176:179], a[252:255], a[48:51]
 ds_write_b128 v8, v[16:19] offset:4096
 v_mfma_f32_16x16x32_bf16 a[64:67], a[180:183], a[252:255], a[64:67]
 buffer_load_dwordx4 a[172:175], v1, s[20:23], s51 offen offset:3072
 v_fma_f32 v62, s43, v62, v58
 v_fma_f32 v63, s43, v63, v59
 v_mfma_f32_16x16x32_bf16 a[80:83], a[184:187], a[252:255], a[80:83]
 v_fmac_f32 v60, s41, v52
 v_fmac_f32 v61, s41, v53
 v_fma_f32 v66, -s41, v58, v66
 v_fma_f32 v67, -s41, v59, v67
 v_mfma_f32_16x16x32_bf16 a[96:99], a[188:191], a[252:255], a[96:99]
 ds_read_b128 a[252:255], v7 offset:23552
 buffer_load_dwordx4 v[92:95], v2, s[16:19], s56 offen offset:0
 v_fmac_f32 v64, s42, v52
 s_waitcnt lgkmcnt(5)
 v_mfma_f32_16x16x32_bf16 v[116:119], a[192:195], a[240:243], v[116:119]
 ds_write_b128 v8, v[20:23] offset:8192
 v_fmac_f32 v65, s42, v53
 v_mfma_f32_16x16x32_bf16 v[132:135], a[196:199], a[240:243], v[132:135]
 buffer_load_dwordx4 a[176:179], v1, s[20:23], s52 offen offset:0
 v_sub_f32 v60, v60, v56
 v_sub_f32 v61, v61, v57
 v_mfma_f32_16x16x32_bf16 v[148:151], a[200:203], a[240:243], v[148:151]
 v_add_f32 v66, v66, v54
 v_add_f32 v67, v67, v55
 v_fma_f32 v62, 2.0, v62, v64
 v_fma_f32 v63, 2.0, v63, v65
 v_mfma_f32_16x16x32_bf16 v[164:167], a[204:207], a[240:243], v[164:167]
 ds_read_b128 a[240:243], v7 offset:24576
 ds_write_b128 v8, v[24:27] offset:12288
 s_waitcnt lgkmcnt(7)
 v_mfma_f32_16x16x32_bf16 v[180:183], a[192:195], a[244:247], v[180:183]
 v_cvt_pk_bf16_f32 v20, v60, v61
 v_cvt_pk_bf16_f32 v24, v66, v67
 v_mfma_f32_16x16x32_bf16 v[196:199], a[196:199], a[244:247], v[196:199]
 buffer_load_dwordx4 a[180:183], v1, s[20:23], s52 offen offset:1024
 v_fma_f32 v64, 2.0, v64, -v62
 v_fma_f32 v65, 2.0, v65, -v63
 v_mfma_f32_16x16x32_bf16 v[212:215], a[200:203], a[244:247], v[212:215]
 v_cvt_pk_bf16_f32 v12, v62, v63
 v_cvt_pk_bf16_f32 v16, v64, v65
 v_fmac_f32 v58, s40, v54
 v_fmac_f32 v59, s40, v55
 v_mfma_f32_16x16x32_bf16 v[228:231], a[204:207], a[244:247], v[228:231]
 ds_read_b128 a[244:247], v7 offset:25600
 buffer_load_dwordx4 v[96:99], v2, s[16:19], s56 offen offset:2048
 v_fma_f32 v52, -s41, v56, v52
 v_fma_f32 v53, -s41, v57, v53
 v_fma_f32 v54, s43, v54, -v58
 s_waitcnt lgkmcnt(6)
 v_mfma_f32_16x16x32_bf16 v[244:247], a[192:195], a[248:251], v[244:247]
 v_fma_f32 v55, s43, v55, -v59
 v_lshlrev_b32 v60, 16, v101
 v_and_b32 v61, s34, v101
 v_lshlrev_b32 v66, 16, v105
 v_mfma_f32_16x16x32_bf16 a[4:7], a[196:199], a[248:251], a[4:7]
 buffer_load_dwordx4 a[184:187], v1, s[20:23], s52 offen offset:2048
 v_and_b32 v67, s34, v105
 v_mfma_f32_16x16x32_bf16 a[20:23], a[200:203], a[248:251], a[20:23]
 v_lshlrev_b32 v64, 16, v69
 v_and_b32 v65, s34, v69
 v_lshlrev_b32 v62, 16, v73
 v_and_b32 v63, s34, v73
 v_mfma_f32_16x16x32_bf16 a[36:39], a[204:207], a[248:251], a[36:39]
 ds_read_b128 a[248:251], v7 offset:26624
 v_fma_f32 v32, s43, v32, v64
 v_fma_f32 v33, s43, v33, v65
 v_fma_f32 v34, s43, v34, v66
 s_waitcnt lgkmcnt(5)
 v_mfma_f32_16x16x32_bf16 a[52:55], a[192:195], a[252:255], a[52:55]
 v_fma_f32 v35, s43, v35, v67
 v_fmac_f32 v28, s41, v60
 v_fmac_f32 v29, s41, v61
 v_fma_f32 v30, -s41, v66, v30
 v_mfma_f32_16x16x32_bf16 a[68:71], a[196:199], a[252:255], a[68:71]
 buffer_load_dwordx4 a[188:191], v1, s[20:23], s52 offen offset:3072
 v_fma_f32 v31, -s41, v67, v31
 v_fmac_f32 v32, s42, v60
 v_mfma_f32_16x16x32_bf16 a[84:87], a[200:203], a[252:255], a[84:87]
 v_fmac_f32 v33, s42, v61
 v_sub_f32 v28, v28, v64
 v_sub_f32 v29, v29, v65
 v_mfma_f32_16x16x32_bf16 a[100:103], a[204:207], a[252:255], a[100:103]
 ds_read_b128 a[252:255], v7 offset:27648
 v_add_f32 v30, v30, v62
 v_add_f32 v31, v31, v63
 v_fma_f32 v34, 2.0, v34, v32
 s_waitcnt lgkmcnt(4)
 v_mfma_f32_16x16x32_bf16 v[120:123], a[208:211], a[240:243], v[120:123]
 v_fma_f32 v35, 2.0, v35, v33
 v_cvt_pk_bf16_f32 v21, v28, v29
 v_cvt_pk_bf16_f32 v25, v30, v31
 v_fma_f32 v32, 2.0, v32, -v34
 v_mfma_f32_16x16x32_bf16 v[136:139], a[212:215], a[240:243], v[136:139]
 buffer_load_dwordx4 a[192:195], v1, s[20:23], s53 offen offset:0
 v_fma_f32 v33, 2.0, v33, -v35
 v_cvt_pk_bf16_f32 v13, v34, v35
 v_mfma_f32_16x16x32_bf16 v[152:155], a[216:219], a[240:243], v[152:155]
 v_cvt_pk_bf16_f32 v17, v32, v33
 v_fmac_f32 v66, s40, v62
 v_fmac_f32 v67, s40, v63
 v_mfma_f32_16x16x32_bf16 v[168:171], a[220:223], a[240:243], v[168:171]
 ds_read_b128 a[240:243], v7 offset:28672
 v_fma_f32 v60, -s41, v64, v60
 v_fma_f32 v61, -s41, v65, v61
 v_fma_f32 v62, s43, v62, -v66
 s_waitcnt lgkmcnt(3)
 v_mfma_f32_16x16x32_bf16 v[184:187], a[208:211], a[244:247], v[184:187]
 v_fma_f32 v63, s43, v63, -v67
 v_lshlrev_b32 v28, 16, v102
 v_and_b32 v29, s34, v102
 v_lshlrev_b32 v30, 16, v106
 v_mfma_f32_16x16x32_bf16 v[200:203], a[212:215], a[244:247], v[200:203]
 buffer_load_dwordx4 a[196:199], v1, s[20:23], s53 offen offset:1024
 v_and_b32 v31, s34, v106
 v_lshlrev_b32 v32, 16, v70
 v_mfma_f32_16x16x32_bf16 v[216:219], a[216:219], a[244:247], v[216:219]
 v_and_b32 v33, s34, v70
 v_lshlrev_b32 v34, 16, v74
 v_and_b32 v35, s34, v74
 v_fma_f32 v40, s43, v40, v32
 v_mfma_f32_16x16x32_bf16 v[232:235], a[220:223], a[244:247], v[232:235]
 ds_read_b128 a[244:247], v7 offset:29696
 v_fma_f32 v41, s43, v41, v33
 v_fma_f32 v42, s43, v42, v30
 s_waitcnt lgkmcnt(3)
 v_mfma_f32_16x16x32_bf16 v[248:251], a[208:211], a[248:251], v[248:251]
 v_fma_f32 v43, s43, v43, v31
 v_fmac_f32 v36, s41, v28
 v_fmac_f32 v37, s41, v29
 v_fma_f32 v38, -s41, v30, v38
 v_mfma_f32_16x16x32_bf16 a[8:11], a[212:215], a[248:251], a[8:11]
 buffer_load_dwordx4 a[200:203], v1, s[20:23], s53 offen offset:2048
 v_fma_f32 v39, -s41, v31, v39
 v_fmac_f32 v40, s42, v28
 v_mfma_f32_16x16x32_bf16 a[24:27], a[216:219], a[248:251], a[24:27]
 v_fmac_f32 v41, s42, v29
 v_sub_f32 v36, v36, v32
 v_sub_f32 v37, v37, v33
 v_add_f32 v38, v38, v34
 v_mfma_f32_16x16x32_bf16 a[40:43], a[220:223], a[248:251], a[40:43]
 ds_read_b128 a[248:251], v7 offset:30720
 v_add_f32 v39, v39, v35
 v_fma_f32 v42, 2.0, v42, v40
 v_fma_f32 v43, 2.0, v43, v41
 s_waitcnt lgkmcnt(3)
 v_mfma_f32_16x16x32_bf16 a[56:59], a[208:211], a[252:255], a[56:59]
 v_cvt_pk_bf16_f32 v22, v36, v37
 v_cvt_pk_bf16_f32 v26, v38, v39
 v_fma_f32 v40, 2.0, v40, -v42
 v_mfma_f32_16x16x32_bf16 a[72:75], a[212:215], a[252:255], a[72:75]
 buffer_load_dwordx4 a[204:207], v1, s[20:23], s53 offen offset:3072
 v_fma_f32 v41, 2.0, v41, -v43
 v_cvt_pk_bf16_f32 v14, v42, v43
 v_mfma_f32_16x16x32_bf16 a[88:91], a[216:219], a[252:255], a[88:91]
 v_cvt_pk_bf16_f32 v18, v40, v41
 v_fmac_f32 v30, s40, v34
 v_fmac_f32 v31, s40, v35
 v_fma_f32 v28, -s41, v32, v28
 v_mfma_f32_16x16x32_bf16 a[104:107], a[220:223], a[252:255], a[104:107]
 ds_read_b128 a[252:255], v7 offset:31744
 v_fma_f32 v29, -s41, v33, v29
 v_fma_f32 v34, s43, v34, -v30
 v_fma_f32 v35, s43, v35, -v31
 s_waitcnt lgkmcnt(3)
 v_mfma_f32_16x16x32_bf16 v[124:127], a[224:227], a[240:243], v[124:127]
 v_lshlrev_b32 v36, 16, v103
 v_and_b32 v37, s34, v103
 v_lshlrev_b32 v38, 16, v107
 v_and_b32 v39, s34, v107
 v_mfma_f32_16x16x32_bf16 v[140:143], a[228:231], a[240:243], v[140:143]
 buffer_load_dwordx4 a[208:211], v1, s[20:23], s54 offen offset:0
 v_lshlrev_b32 v40, 16, v71
 v_mfma_f32_16x16x32_bf16 v[156:159], a[232:235], a[240:243], v[156:159]
 v_and_b32 v41, s34, v71
 v_lshlrev_b32 v42, 16, v75
 v_and_b32 v43, s34, v75
 v_mfma_f32_16x16x32_bf16 v[172:175], a[236:239], a[240:243], v[172:175]
 ds_read_b128 a[240:243], v7 offset:32768
 buffer_load_dwordx4 v[100:103], v2, s[16:19], s57 offen offset:0
 s_waitcnt lgkmcnt(3)
 v_mfma_f32_16x16x32_bf16 v[188:191], a[224:227], a[244:247], v[188:191]
 v_mfma_f32_16x16x32_bf16 v[204:207], a[228:231], a[244:247], v[204:207]
 buffer_load_dwordx4 a[212:215], v1, s[20:23], s54 offen offset:1024
 v_mfma_f32_16x16x32_bf16 v[220:223], a[232:235], a[244:247], v[220:223]
 v_mfma_f32_16x16x32_bf16 v[236:239], a[236:239], a[244:247], v[236:239]
 ds_read_b128 a[244:247], v7 offset:33792
 s_waitcnt lgkmcnt(3)
 v_mfma_f32_16x16x32_bf16 v[252:255], a[224:227], a[248:251], v[252:255]
 v_mfma_f32_16x16x32_bf16 a[12:15], a[228:231], a[248:251], a[12:15]
 buffer_load_dwordx4 a[216:219], v1, s[20:23], s54 offen offset:2048
 v_mfma_f32_16x16x32_bf16 a[28:31], a[232:235], a[248:251], a[28:31]
 v_fma_f32 v48, s43, v48, v40
 v_fma_f32 v49, s43, v49, v41
 v_fma_f32 v50, s43, v50, v38
 v_mfma_f32_16x16x32_bf16 a[44:47], a[236:239], a[248:251], a[44:47]
 ds_read_b128 a[248:251], v7 offset:34816
 buffer_load_dwordx4 v[104:107], v2, s[16:19], s57 offen offset:2048
 v_fma_f32 v51, s43, v51, v39
 v_fmac_f32 v44, s41, v36
 v_fmac_f32 v45, s41, v37
 s_waitcnt lgkmcnt(3)
 v_mfma_f32_16x16x32_bf16 a[60:63], a[224:227], a[252:255], a[60:63]
 v_fma_f32 v46, -s41, v38, v46
 v_fma_f32 v47, -s41, v39, v47
 v_fmac_f32 v48, s42, v36
 v_fmac_f32 v49, s42, v37
 v_mfma_f32_16x16x32_bf16 a[76:79], a[228:231], a[252:255], a[76:79]
 buffer_load_dwordx4 a[220:223], v1, s[20:23], s54 offen offset:3072
 v_sub_f32 v44, v44, v40
 v_sub_f32 v45, v45, v41
 v_mfma_f32_16x16x32_bf16 a[92:95], a[232:235], a[252:255], a[92:95]
 v_add_f32 v46, v46, v42
 v_add_f32 v47, v47, v43
 v_fma_f32 v50, 2.0, v50, v48
 v_fma_f32 v51, 2.0, v51, v49
 v_mfma_f32_16x16x32_bf16 a[108:111], a[236:239], a[252:255], a[108:111]
 ds_read_b128 a[252:255], v7 offset:35840
 v_cvt_pk_bf16_f32 v23, v44, v45
 v_cvt_pk_bf16_f32 v27, v46, v47
 s_waitcnt vmcnt(32) lgkmcnt(3)
 v_mfma_f32_16x16x32_bf16 v[112:115], a[112:115], a[240:243], v[112:115]
 v_fma_f32 v48, 2.0, v48, -v50
 v_fma_f32 v49, 2.0, v49, -v51
 v_cvt_pk_bf16_f32 v15, v50, v51
 v_cvt_pk_bf16_f32 v19, v48, v49
 v_mfma_f32_16x16x32_bf16 v[128:131], a[116:119], a[240:243], v[128:131]
 buffer_load_dwordx4 a[224:227], v1, s[20:23], s55 offen offset:0
 v_fmac_f32 v38, s40, v42
 v_fmac_f32 v39, s40, v43
 v_mfma_f32_16x16x32_bf16 v[144:147], a[120:123], a[240:243], v[144:147]
 buffer_load_dword v109, v108, s[16:19], s85 offen
 s_add_u32 s85, s85, 8192
 v_fma_f32 v36, -s41, v40, v36
 v_mfma_f32_16x16x32_bf16 v[160:163], a[124:127], a[240:243], v[160:163]
 ds_read_b128 a[240:243], v7 offset:36864
 s_add_u32 s32, s32, 1
 s_and_b32 s44, s32, 3
 s_cmp_eq_u32 s44, 0
 s_cselect_b32 s38, s47, s58
 v_add_u32 v2, s38, v2
 v_add_u32 v3, s38, v3
 s_cmp_lg_u32 s32, 8
 s_cbranch_scc1 LS4_a
 s_mov_b32 s32, 0
 v_mov_b32 v2, v5
 v_mov_b32 v3, v6
LS4_a:
 s_cmp_lt_u32 s32, 4
 s_cselect_b32 s33, s59, 0
 v_mov_b32 v4, v2
 s_cbranch_scc1 LS4_b
 v_mov_b32 v4, v3
LS4_b:
 v_fma_f32 v37, -s41, v41, v37
 v_fma_f32 v42, s43, v42, -v38
 v_fma_f32 v43, s43, v43, -v39
 s_waitcnt lgkmcnt(3)
 v_mfma_f32_16x16x32_bf16 v[176:179], a[112:115], a[244:247], v[176:179]
 s_waitcnt vmcnt(20)
 v_lshlrev_b32 v44, 16, v76
 v_and_b32 v45, s34, v76
 v_lshlrev_b32 v46, 16, v80
 v_and_b32 v47, s34, v80
 v_mfma_f32_16x16x32_bf16 v[192:195], a[116:119], a[244:247], v[192:195]
 buffer_load_dwordx4 a[228:231], v1, s[20:23], s55 offen offset:1024
 v_lshlrev_b32 v48, 16, v84
 v_mfma_f32_16x16x32_bf16 v[208:211], a[120:123], a[244:247], v[208:211]
 v_and_b32 v49, s34, v84
 ds_write_b128 v8, v[12:15] offset:1024
 v_mfma_f32_16x16x32_bf16 v[224:227], a[124:127], a[244:247], v[224:227]
 ds_read_b128 a[244:247], v7 offset:37888
 v_lshlrev_b32 v50, 16, v88
 v_and_b32 v51, s34, v88
 s_waitcnt lgkmcnt(4)
 v_mfma_f32_16x16x32_bf16 v[240:243], a[112:115], a[248:251], v[240:243]
 v_fma_f32 v56, s43, v56, v48
 v_fma_f32 v57, s43, v57, v49
 v_fma_f32 v58, s43, v58, v46
 v_fma_f32 v59, s43, v59, v47
 v_mfma_f32_16x16x32_bf16 a[0:3], a[116:119], a[248:251], a[0:3]
 buffer_load_dwordx4 a[232:235], v1, s[20:23], s55 offen offset:2048
 v_fmac_f32 v52, s41, v44
 v_mfma_f32_16x16x32_bf16 a[16:19], a[120:123], a[248:251], a[16:19]
 ds_write_b128 v8, v[16:19] offset:5120
 v_mfma_f32_16x16x32_bf16 a[32:35], a[124:127], a[248:251], a[32:35]
 ds_read_b128 a[248:251], v7 offset:38912
 buffer_load_dwordx4 v[68:71], v3, s[16:19], s33 offen offset:0
 v_fmac_f32 v53, s41, v45
 v_fma_f32 v54, -s41, v46, v54
 v_fma_f32 v55, -s41, v47, v55
 s_waitcnt lgkmcnt(5)
 v_mfma_f32_16x16x32_bf16 a[48:51], a[112:115], a[252:255], a[48:51]
 v_fmac_f32 v56, s42, v44
 v_fmac_f32 v57, s42, v45
 v_sub_f32 v52, v52, v48
 v_sub_f32 v53, v53, v49
 v_mfma_f32_16x16x32_bf16 a[64:67], a[116:119], a[252:255], a[64:67]
 buffer_load_dwordx4 a[236:239], v1, s[20:23], s55 offen offset:3072
 v_mfma_f32_16x16x32_bf16 a[80:83], a[120:123], a[252:255], a[80:83]
 ds_write_b128 v8, v[20:23] offset:9216
 v_add_f32 v54, v54, v50
 v_add_f32 v55, v55, v51
 v_mfma_f32_16x16x32_bf16 a[96:99], a[124:127], a[252:255], a[96:99]
 ds_read_b128 a[252:255], v7 offset:39936
 v_fma_f32 v58, 2.0, v58, v56
 v_fma_f32 v59, 2.0, v59, v57
 s_waitcnt lgkmcnt(6)
 v_mfma_f32_16x16x32_bf16 v[116:119], a[128:131], a[240:243], v[116:119]
 ds_write_b128 v8, v[24:27] offset:13312
 v_mfma_f32_16x16x32_bf16 v[132:135], a[132:135], a[240:243], v[132:135]
 s_cmp_eq_u32 s31, 7
 s_cselect_b32 s36, s84, s56
 s_cselect_b32 s37, -1, 0
 s_add_u32 s20, s20, s36
 s_addc_u32 s21, s21, s37
 buffer_load_dwordx4 a[112:115], v1, s[20:23], s48 offen offset:0
 v_mfma_f32_16x16x32_bf16 v[148:151], a[136:139], a[240:243], v[148:151]
 v_cvt_pk_bf16_f32 v20, v52, v53
 v_cvt_pk_bf16_f32 v24, v54, v55
 v_fma_f32 v56, 2.0, v56, -v58
 v_fma_f32 v57, 2.0, v57, -v59
 v_mfma_f32_16x16x32_bf16 v[164:167], a[140:143], a[240:243], v[164:167]
 ds_read_b128 a[240:243], v7 offset:40960
 buffer_load_dwordx4 v[72:75], v3, s[16:19], s33 offen offset:2048
 s_add_u32 s33, s33, 4096
 v_cvt_pk_bf16_f32 v12, v58, v59
 v_cvt_pk_bf16_f32 v16, v56, v57
 v_fmac_f32 v46, s40, v50
 s_waitcnt lgkmcnt(6)
 v_mfma_f32_16x16x32_bf16 v[180:183], a[128:131], a[244:247], v[180:183]
 v_fmac_f32 v47, s40, v51
 v_fma_f32 v44, -s41, v48, v44
 v_fma_f32 v45, -s41, v49, v45
 v_fma_f32 v50, s43, v50, -v46
 v_mfma_f32_16x16x32_bf16 v[196:199], a[132:135], a[244:247], v[196:199]
 buffer_load_dwordx4 a[116:119], v1, s[20:23], s48 offen offset:1024
 v_fma_f32 v51, s43, v51, -v47
 v_mfma_f32_16x16x32_bf16 v[212:215], a[136:139], a[244:247], v[212:215]
 v_lshlrev_b32 v52, 16, v77
 v_and_b32 v53, s34, v77
 v_lshlrev_b32 v54, 16, v81
 v_and_b32 v55, s34, v81
 v_mfma_f32_16x16x32_bf16 v[228:231], a[140:143], a[244:247], v[228:231]
 ds_read_b128 a[244:247], v7 offset:41984
 v_lshlrev_b32 v56, 16, v85
 v_and_b32 v57, s34, v85
 v_lshlrev_b32 v58, 16, v89
 s_waitcnt lgkmcnt(5)
 v_mfma_f32_16x16x32_bf16 v[244:247], a[128:131], a[248:251], v[244:247]
 v_and_b32 v59, s34, v89
 v_fma_f32 v64, s43, v64, v56
 v_fma_f32 v65, s43, v65, v57
 v_fma_f32 v66, s43, v66, v54
 v_mfma_f32_16x16x32_bf16 a[4:7], a[132:135], a[248:251], a[4:7]
 buffer_load_dwordx4 a[120:123], v1, s[20:23], s48 offen offset:2048
 v_fma_f32 v67, s43, v67, v55
 v_fmac_f32 v60, s41, v52
 v_mfma_f32_16x16x32_bf16 a[20:23], a[136:139], a[248:251], a[20:23]
 v_fmac_f32 v61, s41, v53
 v_fma_f32 v62, -s41, v54, v62
 v_fma_f32 v63, -s41, v55, v63
 v_mfma_f32_16x16x32_bf16 a[36:39], a[140:143], a[248:251], a[36:39]
 ds_read_b128 a[248:251], v7 offset:43008
 v_fmac_f32 v64, s42, v52
 v_fmac_f32 v65, s42, v53
 v_sub_f32 v60, v60, v56
 s_waitcnt lgkmcnt(4)
 v_mfma_f32_16x16x32_bf16 a[52:55], a[128:131], a[252:255], a[52:55]
 v_sub_f32 v61, v61, v57
 v_add_f32 v62, v62, v58
 v_add_f32 v63, v63, v59
 v_fma_f32 v66, 2.0, v66, v64
 v_mfma_f32_16x16x32_bf16 a[68:71], a[132:135], a[252:255], a[68:71]
 buffer_load_dwordx4 a[124:127], v1, s[20:23], s48 offen offset:3072
 v_fma_f32 v67, 2.0, v67, v65
 v_cvt_pk_bf16_f32 v21, v60, v61
 v_mfma_f32_16x16x32_bf16 a[84:87], a[136:139], a[252:255], a[84:87]
 v_cvt_pk_bf16_f32 v25, v62, v63
 v_fma_f32 v64, 2.0, v64, -v66
 v_fma_f32 v65, 2.0, v65, -v67
 v_cvt_pk_bf16_f32 v13, v66, v67
 v_mfma_f32_16x16x32_bf16 a[100:103], a[140:143], a[252:255], a[100:103]
 ds_read_b128 a[252:255], v7 offset:44032
 v_cvt_pk_bf16_f32 v17, v64, v65
 v_fmac_f32 v54, s40, v58
 s_waitcnt lgkmcnt(3)
 v_mfma_f32_16x16x32_bf16 v[120:123], a[144:147], a[240:243], v[120:123]
 v_fmac_f32 v55, s40, v59
 v_fma_f32 v52, -s41, v56, v52
 v_fma_f32 v53, -s41, v57, v53
 v_fma_f32 v58, s43, v58, -v54
 v_mfma_f32_16x16x32_bf16 v[136:139], a[148:151], a[240:243], v[136:139]
 buffer_load_dwordx4 a[128:131], v1, s[20:23], s49 offen offset:0
 v_fma_f32 v59, s43, v59, -v55
 v_lshlrev_b32 v60, 16, v78
 v_mfma_f32_16x16x32_bf16 v[152:155], a[152:155], a[240:243], v[152:155]
 v_and_b32 v61, s34, v78
 v_lshlrev_b32 v62, 16, v82
 v_and_b32 v63, s34, v82
 v_lshlrev_b32 v64, 16, v86
 v_mfma_f32_16x16x32_bf16 v[168:171], a[156:159], a[240:243], v[168:171]
 ds_read_b128 a[240:243], v7 offset:45056
 v_and_b32 v65, s34, v86
 v_lshlrev_b32 v66, 16, v90
 v_and_b32 v67, s34, v90
 s_waitcnt lgkmcnt(3)
 v_mfma_f32_16x16x32_bf16 v[184:187], a[144:147], a[244:247], v[184:187]
 v_fma_f32 v32, s43, v32, v64
 v_fma_f32 v33, s43, v33, v65
 v_fma_f32 v30, s43, v30, v62
 v_mfma_f32_16x16x32_bf16 v[200:203], a[148:151], a[244:247], v[200:203]
 buffer_load_dwordx4 a[132:135], v1, s[20:23], s49 offen offset:1024
 v_fma_f32 v31, s43, v31, v63
 v_fmac_f32 v28, s41, v60
 v_mfma_f32_16x16x32_bf16 v[216:219], a[152:155], a[244:247], v[216:219]
 v_fmac_f32 v29, s41, v61
 v_fma_f32 v34, -s41, v62, v34
 v_fma_f32 v35, -s41, v63, v35
 v_fmac_f32 v32, s42, v60
 v_mfma_f32_16x16x32_bf16 v[232:235], a[156:159], a[244:247], v[232:235]
 ds_read_b128 a[244:247], v7 offset:46080
 v_fmac_f32 v33, s42, v61
 v_sub_f32 v28, v28, v64
 v_sub_f32 v29, v29, v65
 s_waitcnt lgkmcnt(3)
 v_mfma_f32_16x16x32_bf16 v[248:251], a[144:147], a[248:251], v[248:251]
 v_add_f32 v34, v34, v66
 v_add_f32 v35, v35, v67
 v_fma_f32 v30, 2.0, v30, v32
 v_fma_f32 v31, 2.0, v31, v33
 v_mfma_f32_16x16x32_bf16 a[8:11], a[148:151], a[248:251], a[8:11]
 buffer_load_dwordx4 a[136:139], v1, s[20:23], s49 offen offset:2048
 v_cvt_pk_bf16_f32 v22, v28, v29
 v_mfma_f32_16x16x32_bf16 a[24:27], a[152:155], a[248:251], a[24:27]
 v_cvt_pk_bf16_f32 v26, v34, v35
 v_fma_f32 v32, 2.0, v32, -v30
 v_fma_f32 v33, 2.0, v33, -v31
 v_cvt_pk_bf16_f32 v14, v30, v31
 v_mfma_f32_16x16x32_bf16 a[40:43], a[156:159], a[248:251], a[40:43]
 ds_read_b128 a[248:251], v7 offset:47104
 v_cvt_pk_bf16_f32 v18, v32, v33
 v_fmac_f32 v62, s40, v66
 v_fmac_f32 v63, s40, v67
 s_waitcnt lgkmcnt(3)
 v_mfma_f32_16x16x32_bf16 a[56:59], a[144:147], a[252:255], a[56:59]
 v_fma_f32 v60, -s41, v64, v60
 v_fma_f32 v61, -s41, v65, v61
 v_fma_f32 v66, s43, v66, -v62
 v_fma_f32 v67, s43, v67, -v63
 v_mfma_f32_16x16x32_bf16 a[72:75], a[148:151], a[252:255], a[72:75]
 buffer_load_dwordx4 a[140:143], v1, s[20:23], s49 offen offset:3072
 v_lshlrev_b32 v28, 16, v79
 v_and_b32 v29, s34, v79
 v_mfma_f32_16x16x32_bf16 a[88:91], a[152:155], a[252:255], a[88:91]
 v_lshlrev_b32 v34, 16, v83
 v_and_b32 v35, s34, v83
 v_lshlrev_b32 v32, 16, v87
 v_mfma_f32_16x16x32_bf16 a[104:107], a[156:159], a[252:255], a[104:107]
 ds_read_b128 a[252:255], v7 offset:48128
 v_and_b32 v33, s34, v87
 v_lshlrev_b32 v30, 16, v91
 v_and_b32 v31, s34, v91
 s_waitcnt vmcnt(31) lgkmcnt(3)
 v_mfma_f32_16x16x32_bf16 v[124:127], a[160:163], a[240:243], v[124:127]
 v_mfma_f32_16x16x32_bf16 v[140:143], a[164:167], a[240:243], v[140:143]
 buffer_load_dwordx4 a[144:147], v1, s[20:23], s50 offen offset:0
 v_mfma_f32_16x16x32_bf16 v[156:159], a[168:171], a[240:243], v[156:159]
 v_mfma_f32_16x16x32_bf16 v[172:175], a[172:175], a[240:243], v[172:175]
 ds_read_b128 a[240:243], v7 offset:49152
 buffer_load_dwordx4 v[76:79], v3, s[16:19], s33 offen offset:0
 v_fma_f32 v40, s43, v40, v32
 v_fma_f32 v41, s43, v41, v33
 v_fma_f32 v38, s43, v38, v34
 s_waitcnt lgkmcnt(3)
 v_mfma_f32_16x16x32_bf16 v[188:191], a[160:163], a[244:247], v[188:191]
 v_fma_f32 v39, s43, v39, v35
 v_fmac_f32 v36, s41, v28
 v_fmac_f32 v37, s41, v29
 v_fma_f32 v42, -s41, v34, v42
 v_mfma_f32_16x16x32_bf16 v[204:207], a[164:167], a[244:247], v[204:207]
 buffer_load_dwordx4 a[148:151], v1, s[20:23], s50 offen offset:1024
 v_fma_f32 v43, -s41, v35, v43
 v_mfma_f32_16x16x32_bf16 v[220:223], a[168:171], a[244:247], v[220:223]
 v_fmac_f32 v40, s42, v28
 v_fmac_f32 v41, s42, v29
 v_sub_f32 v36, v36, v32
 v_sub_f32 v37, v37, v33
 v_mfma_f32_16x16x32_bf16 v[236:239], a[172:175], a[244:247], v[236:239]
 ds_read_b128 a[244:247], v7 offset:50176
 v_add_f32 v42, v42, v30
 v_add_f32 v43, v43, v31
 v_fma_f32 v38, 2.0, v38, v40
 s_waitcnt lgkmcnt(3)
 v_mfma_f32_16x16x32_bf16 v[252:255], a[160:163], a[248:251], v[252:255]
 v_fma_f32 v39, 2.0, v39, v41
 v_cvt_pk_bf16_f32 v23, v36, v37
 v_cvt_pk_bf16_f32 v27, v42, v43
 v_fma_f32 v40, 2.0, v40, -v38
 v_mfma_f32_16x16x32_bf16 a[12:15], a[164:167], a[248:251], a[12:15]
 buffer_load_dwordx4 a[152:155], v1, s[20:23], s50 offen offset:2048
 v_fma_f32 v41, 2.0, v41, -v39
 v_cvt_pk_bf16_f32 v15, v38, v39
 v_mfma_f32_16x16x32_bf16 a[28:31], a[168:171], a[248:251], a[28:31]
 v_cvt_pk_bf16_f32 v19, v40, v41
 v_fmac_f32 v34, s40, v30
 v_fmac_f32 v35, s40, v31
 v_mfma_f32_16x16x32_bf16 a[44:47], a[172:175], a[248:251], a[44:47]
 ds_read_b128 a[248:251], v7 offset:51200
 buffer_load_dwordx4 v[80:83], v4, s[16:19], s33 offen offset:2048
 s_add_u32 s33, s33, 4096
 v_fma_f32 v28, -s41, v32, v28
 v_fma_f32 v29, -s41, v33, v29
 v_fma_f32 v30, s43, v30, -v34
 s_waitcnt lgkmcnt(3)
 v_mfma_f32_16x16x32_bf16 a[60:63], a[160:163], a[252:255], a[60:63]
 v_fma_f32 v31, s43, v31, -v35
 s_waitcnt vmcnt(21)
 v_lshlrev_b32 v36, 16, v92
 v_and_b32 v37, s34, v92
 v_mfma_f32_16x16x32_bf16 a[76:79], a[164:167], a[252:255], a[76:79]
 buffer_load_dwordx4 a[156:159], v1, s[20:23], s50 offen offset:3072
 ds_write_b128 v8, v[12:15] offset:2048
 v_mfma_f32_16x16x32_bf16 a[92:95], a[168:171], a[252:255], a[92:95]
 v_lshlrev_b32 v42, 16, v96
 v_and_b32 v43, s34, v96
 v_lshlrev_b32 v40, 16, v100
 v_mfma_f32_16x16x32_bf16 a[108:111], a[172:175], a[252:255], a[108:111]
 ds_read_b128 a[252:255], v7 offset:52224
 v_and_b32 v41, s34, v100
 v_lshlrev_b32 v38, 16, v104
 s_waitcnt lgkmcnt(4)
 v_mfma_f32_16x16x32_bf16 v[112:115], a[176:179], a[240:243], v[112:115]
 v_and_b32 v39, s34, v104
 v_fma_f32 v48, s43, v48, v40
 ds_write_b128 v8, v[16:19] offset:6144
 v_mfma_f32_16x16x32_bf16 v[128:131], a[180:183], a[240:243], v[128:131]
 buffer_load_dwordx4 a[160:163], v1, s[20:23], s51 offen offset:0
 v_mfma_f32_16x16x32_bf16 v[144:147], a[184:187], a[240:243], v[144:147]
 v_fma_f32 v49, s43, v49, v41
 v_fma_f32 v46, s43, v46, v42
 v_fma_f32 v47, s43, v47, v43
 v_fmac_f32 v44, s41, v36
 v_mfma_f32_16x16x32_bf16 v[160:163], a[188:191], a[240:243], v[160:163]
 ds_read_b128 a[240:243], v7 offset:53248
 buffer_load_dwordx4 v[84:87], v2, s[16:19], s33 offen offset:0
 v_fmac_f32 v45, s41, v37
 v_fma_f32 v50, -s41, v42, v50
 v_fma_f32 v51, -s41, v43, v51
 s_waitcnt lgkmcnt(5)
 v_mfma_f32_16x16x32_bf16 v[176:179], a[176:179], a[244:247], v[176:179]
 ds_write_b128 v8, v[20:23] offset:10240
 v_mfma_f32_16x16x32_bf16 v[192:195], a[180:183], a[244:247], v[192:195]
 buffer_load_dwordx4 a[164:167], v1, s[20:23], s51 offen offset:1024
 v_fmac_f32 v48, s42, v36
 v_mfma_f32_16x16x32_bf16 v[208:211], a[184:187], a[244:247], v[208:211]
 v_fmac_f32 v49, s42, v37
 v_sub_f32 v44, v44, v40
 v_sub_f32 v45, v45, v41
 v_add_f32 v50, v50, v38
 v_mfma_f32_16x16x32_bf16 v[224:227], a[188:191], a[244:247], v[224:227]
 ds_read_b128 a[244:247], v7 offset:54272
 v_add_f32 v51, v51, v39
 v_fma_f32 v46, 2.0, v46, v48
 s_waitcnt lgkmcnt(6)
 v_mfma_f32_16x16x32_bf16 v[240:243], a[176:179], a[248:251], v[240:243]
 ds_write_b128 v8, v[24:27] offset:14336
 v_fma_f32 v47, 2.0, v47, v49
 v_mfma_f32_16x16x32_bf16 a[0:3], a[180:183], a[248:251], a[0:3]
 buffer_load_dwordx4 a[168:171], v1, s[20:23], s51 offen offset:2048
 v_cvt_pk_bf16_f32 v20, v44, v45
 v_mfma_f32_16x16x32_bf16 a[16:19], a[184:187], a[248:251], a[16:19]
 v_cvt_pk_bf16_f32 v24, v50, v51
 v_fma_f32 v48, 2.0, v48, -v46
 v_fma_f32 v49, 2.0, v49, -v47
 v_cvt_pk_bf16_f32 v12, v46, v47
 v_mfma_f32_16x16x32_bf16 a[32:35], a[188:191], a[248:251], a[32:35]
 ds_read_b128 a[248:251], v7 offset:55296
 buffer_load_dwordx4 v[88:91], v2, s[16:19], s33 offen offset:2048
 s_add_u32 s33, s33, 4096
 v_cvt_pk_bf16_f32 v16, v48, v49
 v_lshlrev_b32 v44, 16, v93
 v_and_b32 v45, s34, v93
 s_waitcnt lgkmcnt(6)
 v_mfma_f32_16x16x32_bf16 a[48:51], a[176:179], a[252:255], a[48:51]
 v_lshlrev_b32 v50, 16, v97
 v_and_b32 v51, s34, v97
 v_lshlrev_b32 v48, 16, v101
 v_and_b32 v49, s34, v101
 v_mfma_f32_16x16x32_bf16 a[64:67], a[180:183], a[252:255], a[64:67]
 buffer_load_dwordx4 a[172:175], v1, s[20:23], s51 offen offset:3072
 v_lshlrev_b32 v46, 16, v105
 v_and_b32 v47, s34, v105
 v_mfma_f32_16x16x32_bf16 a[80:83], a[184:187], a[252:255], a[80:83]
 v_fma_f32 v56, s43, v56, v48
 v_fma_f32 v57, s43, v57, v49
 v_fma_f32 v54, s43, v54, v50
 v_mfma_f32_16x16x32_bf16 a[96:99], a[188:191], a[252:255], a[96:99]
 ds_read_b128 a[252:255], v7 offset:56320
 v_fma_f32 v55, s43, v55, v51
 v_fmac_f32 v52, s41, v44
 v_fmac_f32 v53, s41, v45
 s_waitcnt lgkmcnt(5)
 v_mfma_f32_16x16x32_bf16 v[116:119], a[192:195], a[240:243], v[116:119]
 v_fma_f32 v58, -s41, v50, v58
 v_fma_f32 v59, -s41, v51, v59
 v_fmac_f32 v56, s42, v44
 v_fmac_f32 v57, s42, v45
 v_mfma_f32_16x16x32_bf16 v[132:135], a[196:199], a[240:243], v[132:135]
 buffer_load_dwordx4 a[176:179], v1, s[20:23], s52 offen offset:0
 v_sub_f32 v52, v52, v48
 v_sub_f32 v53, v53, v49
 v_mfma_f32_16x16x32_bf16 v[148:151], a[200:203], a[240:243], v[148:151]
 v_add_f32 v58, v58, v46
 v_add_f32 v59, v59, v47
 v_fma_f32 v54, 2.0, v54, v56
 v_fma_f32 v55, 2.0, v55, v57
 v_mfma_f32_16x16x32_bf16 v[164:167], a[204:207], a[240:243], v[164:167]
 ds_read_b128 a[240:243], v7 offset:57344
 v_cvt_pk_bf16_f32 v21, v52, v53
 v_cvt_pk_bf16_f32 v25, v58, v59
 s_waitcnt lgkmcnt(4)
 v_mfma_f32_16x16x32_bf16 v[180:183], a[192:195], a[244:247], v[180:183]
 v_fma_f32 v56, 2.0, v56, -v54
 v_fma_f32 v57, 2.0, v57, -v55
 v_cvt_pk_bf16_f32 v13, v54, v55
 v_cvt_pk_bf16_f32 v17, v56, v57
 v_mfma_f32_16x16x32_bf16 v[196:199], a[196:199], a[244:247], v[196:199]
 buffer_load_dwordx4 a[180:183], v1, s[20:23], s52 offen offset:1024
 v_lshlrev_b32 v36, 16, v94
 v_and_b32 v37, s34, v94
 v_mfma_f32_16x16x32_bf16 v[212:215], a[200:203], a[244:247], v[212:215]
 v_lshlrev_b32 v42, 16, v98
 v_and_b32 v43, s34, v98
 v_lshlrev_b32 v40, 16, v102
 v_and_b32 v41, s34, v102
 v_mfma_f32_16x16x32_bf16 v[228:231], a[204:207], a[244:247], v[228:231]
 ds_read_b128 a[244:247], v7 offset:58368
 v_lshlrev_b32 v38, 16, v106
 v_and_b32 v39, s34, v106
 v_fma_f32 v64, s43, v64, v40
 s_waitcnt lgkmcnt(3)
 v_mfma_f32_16x16x32_bf16 v[244:247], a[192:195], a[248:251], v[244:247]
 v_fma_f32 v65, s43, v65, v41
 v_fma_f32 v62, s43, v62, v42
 v_fma_f32 v63, s43, v63, v43
 v_mfma_f32_16x16x32_bf16 a[4:7], a[196:199], a[248:251], a[4:7]
 buffer_load_dwordx4 a[184:187], v1, s[20:23], s52 offen offset:2048
 v_fmac_f32 v60, s41, v36
 v_fmac_f32 v61, s41, v37
 v_mfma_f32_16x16x32_bf16 a[20:23], a[200:203], a[248:251], a[20:23]
 v_fma_f32 v66, -s41, v42, v66
 v_fma_f32 v67, -s41, v43, v67
 v_fmac_f32 v64, s42, v36
 v_fmac_f32 v65, s42, v37
 v_mfma_f32_16x16x32_bf16 a[36:39], a[204:207], a[248:251], a[36:39]
 ds_read_b128 a[248:251], v7 offset:59392
 v_sub_f32 v60, v60, v40
 v_sub_f32 v61, v61, v41
 v_add_f32 v66, v66, v38
 s_waitcnt lgkmcnt(3)
 v_mfma_f32_16x16x32_bf16 a[52:55], a[192:195], a[252:255], a[52:55]
 v_add_f32 v67, v67, v39
 v_fma_f32 v62, 2.0, v62, v64
 v_fma_f32 v63, 2.0, v63, v65
 v_cvt_pk_bf16_f32 v22, v60, v61
 v_mfma_f32_16x16x32_bf16 a[68:71], a[196:199], a[252:255], a[68:71]
 buffer_load_dwordx4 a[188:191], v1, s[20:23], s52 offen offset:3072
 v_cvt_pk_bf16_f32 v26, v66, v67
 v_mfma_f32_16x16x32_bf16 a[84:87], a[200:203], a[252:255], a[84:87]
 v_fma_f32 v64, 2.0, v64, -v62
 v_fma_f32 v65, 2.0, v65, -v63
 v_cvt_pk_bf16_f32 v14, v62, v63
 v_cvt_pk_bf16_f32 v18, v64, v65
 v_mfma_f32_16x16x32_bf16 a[100:103], a[204:207], a[252:255], a[100:103]
 ds_read_b128 a[252:255], v7 offset:60416
 v_lshlrev_b32 v52, 16, v95
 v_and_b32 v53, s34, v95
 v_lshlrev_b32 v58, 16, v99
 s_waitcnt vmcnt(31) lgkmcnt(3)
 v_mfma_f32_16x16x32_bf16 v[120:123], a[208:211], a[240:243], v[120:123]
 v_and_b32 v59, s34, v99
 v_lshlrev_b32 v56, 16, v103
 v_and_b32 v57, s34, v103
 v_lshlrev_b32 v54, 16, v107
 v_mfma_f32_16x16x32_bf16 v[136:139], a[212:215], a[240:243], v[136:139]
 buffer_load_dwordx4 a[192:195], v1, s[20:23], s53 offen offset:0
 v_and_b32 v55, s34, v107
 v_mfma_f32_16x16x32_bf16 v[152:155], a[216:219], a[240:243], v[152:155]
 v_mfma_f32_16x16x32_bf16 v[168:171], a[220:223], a[240:243], v[168:171]
 ds_read_b128 a[240:243], v7 offset:61440
 buffer_load_dwordx4 v[92:95], v2, s[16:19], s33 offen offset:0
 s_waitcnt lgkmcnt(3)
 v_mfma_f32_16x16x32_bf16 v[184:187], a[208:211], a[244:247], v[184:187]
 v_fma_f32 v32, s43, v32, v56
 v_mfma_f32_16x16x32_bf16 v[200:203], a[212:215], a[244:247], v[200:203]
 buffer_load_dwordx4 a[196:199], v1, s[20:23], s53 offen offset:1024
 v_fma_f32 v33, s43, v33, v57
 v_fma_f32 v34, s43, v34, v58
 v_mfma_f32_16x16x32_bf16 v[216:219], a[216:219], a[244:247], v[216:219]
 v_fma_f32 v35, s43, v35, v59
 v_fmac_f32 v28, s41, v52
 v_fmac_f32 v29, s41, v53
 v_fma_f32 v30, -s41, v58, v30
 v_mfma_f32_16x16x32_bf16 v[232:235], a[220:223], a[244:247], v[232:235]
 ds_read_b128 a[244:247], v7 offset:62464
 v_fma_f32 v31, -s41, v59, v31
 v_fmac_f32 v32, s42, v52
 v_fmac_f32 v33, s42, v53
 s_waitcnt lgkmcnt(3)
 v_mfma_f32_16x16x32_bf16 v[248:251], a[208:211], a[248:251], v[248:251]
 v_sub_f32 v28, v28, v56
 v_sub_f32 v29, v29, v57
 v_add_f32 v30, v30, v54
 v_add_f32 v31, v31, v55
 v_mfma_f32_16x16x32_bf16 a[8:11], a[212:215], a[248:251], a[8:11]
 buffer_load_dwordx4 a[200:203], v1, s[20:23], s53 offen offset:2048
 v_fma_f32 v34, 2.0, v34, v32
 v_mfma_f32_16x16x32_bf16 a[24:27], a[216:219], a[248:251], a[24:27]
 v_fma_f32 v35, 2.0, v35, v33
 v_cvt_pk_bf16_f32 v23, v28, v29
 v_cvt_pk_bf16_f32 v27, v30, v31
 v_fma_f32 v32, 2.0, v32, -v34
 v_mfma_f32_16x16x32_bf16 a[40:43], a[220:223], a[248:251], a[40:43]
 ds_read_b128 a[248:251], v7 offset:63488
 buffer_load_dwordx4 v[96:99], v2, s[16:19], s33 offen offset:2048
 s_add_u32 s33, s33, 4096
 v_fma_f32 v33, 2.0, v33, -v35
 v_cvt_pk_bf16_f32 v15, v34, v35
 v_cvt_pk_bf16_f32 v19, v32, v33
 s_waitcnt lgkmcnt(3)
 v_mfma_f32_16x16x32_bf16 a[56:59], a[208:211], a[252:255], a[56:59]
 ds_write_b128 v8, v[12:15] offset:3072
 v_mfma_f32_16x16x32_bf16 a[72:75], a[212:215], a[252:255], a[72:75]
 buffer_load_dwordx4 a[204:207], v1, s[20:23], s53 offen offset:3072
 v_mfma_f32_16x16x32_bf16 a[88:91], a[216:219], a[252:255], a[88:91]
 ds_write_b128 v8, v[16:19] offset:7168
 v_mfma_f32_16x16x32_bf16 a[104:107], a[220:223], a[252:255], a[104:107]
 ds_read_b128 a[252:255], v7 offset:64512
 ds_write_b128 v8, v[20:23] offset:11264
 s_waitcnt vmcnt(31) lgkmcnt(6)
 v_mfma_f32_16x16x32_bf16 v[124:127], a[224:227], a[240:243], v[124:127]
 ds_write_b128 v8, v[24:27] offset:15360
 v_mfma_f32_16x16x32_bf16 v[140:143], a[228:231], a[240:243], v[140:143]
 buffer_load_dwordx4 a[208:211], v1, s[20:23], s54 offen offset:0
 v_mfma_f32_16x16x32_bf16 v[156:159], a[232:235], a[240:243], v[156:159]
 v_mfma_f32_16x16x32_bf16 v[172:175], a[236:239], a[240:243], v[172:175]
 s_waitcnt lgkmcnt(0)
 s_barrier
 v_xor_b32 v7, 0x10000, v7
 v_xor_b32 v8, 0x10000, v8
 ds_read_b128 a[240:243], v7 offset:0
 buffer_load_dwordx4 v[100:103], v2, s[16:19], s33 offen offset:0
 v_mfma_f32_16x16x32_bf16 v[188:191], a[224:227], a[244:247], v[188:191]
 v_mfma_f32_16x16x32_bf16 v[204:207], a[228:231], a[244:247], v[204:207]
 buffer_load_dwordx4 a[212:215], v1, s[20:23], s54 offen offset:1024
 v_mfma_f32_16x16x32_bf16 v[220:223], a[232:235], a[244:247], v[220:223]
 v_mfma_f32_16x16x32_bf16 v[236:239], a[236:239], a[244:247], v[236:239]
 ds_read_b128 a[244:247], v7 offset:1024
 v_mfma_f32_16x16x32_bf16 v[252:255], a[224:227], a[248:251], v[252:255]
 v_mfma_f32_16x16x32_bf16 a[12:15], a[228:231], a[248:251], a[12:15]
 buffer_load_dwordx4 a[216:219], v1, s[20:23], s54 offen offset:2048
 v_mfma_f32_16x16x32_bf16 a[28:31], a[232:235], a[248:251], a[28:31]
 v_mfma_f32_16x16x32_bf16 a[44:47], a[236:239], a[248:251], a[44:47]
 ds_read_b128 a[248:251], v7 offset:2048
 buffer_load_dwordx4 v[104:107], v2, s[16:19], s33 offen offset:2048
 s_add_u32 s33, s33, 4096
 v_mfma_f32_16x16x32_bf16 a[60:63], a[224:227], a[252:255], a[60:63]
 v_mfma_f32_16x16x32_bf16 a[76:79], a[228:231], a[252:255], a[76:79]
 buffer_load_dwordx4 a[220:223], v1, s[20:23], s54 offen offset:3072
 v_mfma_f32_16x16x32_bf16 a[92:95], a[232:235], a[252:255], a[92:95]
 v_mfma_f32_16x16x32_bf16 a[108:111], a[236:239], a[252:255], a[108:111]
 ds_read_b128 a[252:255], v7 offset:3072
 s_add_u32 s31, s31, 1
 s_cmp_eq_u32 s31, 7
 s_cbranch_scc1 L_B1
 s_cmp_lg_u32 s31, 4
 s_cbranch_scc1 L_B2
 s_nop 7
 v_pk_add_f32 v[12:13], v[112:113], v[116:117]
 v_pk_add_f32 v[14:15], v[114:115], v[118:119]
 v_pk_add_f32 v[20:21], v[128:129], v[132:133]
 v_pk_add_f32 v[22:23], v[130:131], v[134:135]
 v_pk_add_f32 v[28:29], v[144:145], v[148:149]
 v_pk_add_f32 v[30:31], v[146:147], v[150:151]
 v_pk_add_f32 v[16:17], v[120:121], v[124:125]
 v_pk_add_f32 v[18:19], v[122:123], v[126:127]
 v_pk_add_f32 v[24:25], v[136:137], v[140:141]
 v_pk_add_f32 v[26:27], v[138:139], v[142:143]
 v_pk_add_f32 v[32:33], v[152:153], v[156:157]
 v_pk_add_f32 v[34:35], v[154:155], v[158:159]
 v_pk_add_f32 v[112:113], v[112:113], v[116:117] neg_lo:[0,1] neg_hi:[0,1]
 v_pk_add_f32 v[114:115], v[114:115], v[118:119] neg_lo:[0,1] neg_hi:[0,1]
 v_pk_add_f32 v[128:129], v[128:129], v[132:133] neg_lo:[0,1] neg_hi:[0,1]
 v_pk_add_f32 v[130:131], v[130:131], v[134:135] neg_lo:[0,1] neg_hi:[0,1]
 v_pk_add_f32 v[144:145], v[144:145], v[148:149] neg_lo:[0,1] neg_hi:[0,1]
 v_pk_add_f32 v[146:147], v[146:147], v[150:151] neg_lo:[0,1] neg_hi:[0,1]
 v_pk_add_f32 v[116:117], v[120:121], v[124:125] neg_lo:[0,1] neg_hi:[0,1]
 v_pk_add_f32 v[118:119], v[122:123], v[126:127] neg_lo:[0,1] neg_hi:[0,1]
 v_pk_add_f32 v[132:133], v[136:137], v[140:141] neg_lo:[0,1] neg_hi:[0,1]
 v_pk_add_f32 v[134:135], v[138:139], v[142:143] neg_lo:[0,1] neg_hi:[0,1]
 v_pk_add_f32 v[148:149], v[152:153], v[156:157] neg_lo:[0,1] neg_hi:[0,1]
 v_pk_add_f32 v[150:151], v[154:155], v[158:159] neg_lo:[0,1] neg_hi:[0,1]
 v_pk_fma_f32 v[120:121], v[16:17], s[72:73], v[12:13] op_sel_hi:[1,0,1]
 v_pk_fma_f32 v[122:123], v[18:19], s[72:73], v[14:15] op_sel_hi:[1,0,1]
 v_pk_fma_f32 v[136:137], v[24:25], s[72:73], v[20:21] op_sel_hi:[1,0,1]
 v_pk_fma_f32 v[138:139], v[26:27], s[72:73], v[22:23] op_sel_hi:[1,0,1]
 v_pk_fma_f32 v[152:153], v[32:33], s[72:73], v[28:29] op_sel_hi:[1,0,1]
 v_pk_fma_f32 v[154:155], v[34:35], s[72:73], v[30:31] op_sel_hi:[1,0,1]
 v_pk_fma_f32 v[124:125], v[112:113], s[78:79], v[116:117] op_sel_hi:[1,0,1] neg_lo:[0,0,1] neg_hi:[0,0,1]
 v_pk_fma_f32 v[126:127], v[114:115], s[78:79], v[118:119] op_sel_hi:[1,0,1] neg_lo:[0,0,1] neg_hi:[0,0,1]
 v_pk_fma_f32 v[140:141], v[128:129], s[78:79], v[132:133] op_sel_hi:[1,0,1] neg_lo:[0,0,1] neg_hi:[0,0,1]
 v_pk_fma_f32 v[142:143], v[130:131], s[78:79], v[134:135] op_sel_hi:[1,0,1] neg_lo:[0,0,1] neg_hi:[0,0,1]
 v_pk_fma_f32 v[156:157], v[144:145], s[78:79], v[148:149] op_sel_hi:[1,0,1] neg_lo:[0,0,1] neg_hi:[0,0,1]
 v_pk_fma_f32 v[158:159], v[146:147], s[78:79], v[150:151] op_sel_hi:[1,0,1] neg_lo:[0,0,1] neg_hi:[0,0,1]
 v_pk_fma_f32 v[12:13], v[16:17], s[74:75], v[12:13] op_sel_hi:[1,0,1]
 v_pk_fma_f32 v[14:15], v[18:19], s[74:75], v[14:15] op_sel_hi:[1,0,1]
 v_pk_fma_f32 v[20:21], v[24:25], s[74:75], v[20:21] op_sel_hi:[1,0,1]
 v_pk_fma_f32 v[22:23], v[26:27], s[74:75], v[22:23] op_sel_hi:[1,0,1]
 v_pk_fma_f32 v[28:29], v[32:33], s[74:75], v[28:29] op_sel_hi:[1,0,1]
 v_pk_fma_f32 v[30:31], v[34:35], s[74:75], v[30:31] op_sel_hi:[1,0,1]
 v_pk_fma_f32 v[16:17], v[116:117], s[76:77], v[112:113] op_sel_hi:[1,0,1]
 v_pk_fma_f32 v[18:19], v[118:119], s[76:77], v[114:115] op_sel_hi:[1,0,1]
 v_pk_fma_f32 v[24:25], v[132:133], s[76:77], v[128:129] op_sel_hi:[1,0,1]
 v_pk_fma_f32 v[26:27], v[134:135], s[76:77], v[130:131] op_sel_hi:[1,0,1]
 v_pk_fma_f32 v[32:33], v[148:149], s[76:77], v[144:145] op_sel_hi:[1,0,1]
 v_pk_fma_f32 v[34:35], v[150:151], s[76:77], v[146:147] op_sel_hi:[1,0,1]
 v_pk_fma_f32 v[112:113], v[16:17], 2.0, v[12:13] op_sel_hi:[1,0,1]
 v_pk_fma_f32 v[114:115], v[18:19], 2.0, v[14:15] op_sel_hi:[1,0,1]
 v_pk_fma_f32 v[128:129], v[24:25], 2.0, v[20:21] op_sel_hi:[1,0,1]
 v_pk_fma_f32 v[130:131], v[26:27], 2.0, v[22:23] op_sel_hi:[1,0,1]
 v_pk_fma_f32 v[144:145], v[32:33], 2.0, v[28:29] op_sel_hi:[1,0,1]
 v_pk_fma_f32 v[146:147], v[34:35], 2.0, v[30:31] op_sel_hi:[1,0,1]
 v_pk_fma_f32 v[116:117], v[16:17], -2.0, v[12:13] op_sel_hi:[1,0,1]
 v_pk_fma_f32 v[118:119], v[18:19], -2.0, v[14:15] op_sel_hi:[1,0,1]
 v_pk_fma_f32 v[132:133], v[24:25], -2.0, v[20:21] op_sel_hi:[1,0,1]
 v_pk_fma_f32 v[134:135], v[26:27], -2.0, v[22:23] op_sel_hi:[1,0,1]
 v_pk_fma_f32 v[148:149], v[32:33], -2.0, v[28:29] op_sel_hi:[1,0,1]
 v_pk_fma_f32 v[150:151], v[34:35], -2.0, v[30:31] op_sel_hi:[1,0,1]
 v_pk_add_f32 v[12:13], v[160:161], v[164:165]
 v_pk_add_f32 v[14:15], v[162:163], v[166:167]
 v_pk_add_f32 v[20:21], v[176:177], v[180:181]
 v_pk_add_f32 v[22:23], v[178:179], v[182:183]
 v_pk_add_f32 v[28:29], v[192:193], v[196:197]
 v_pk_add_f32 v[30:31], v[194:195], v[198:199]
 v_pk_add_f32 v[16:17], v[168:169], v[172:173]
 v_pk_add_f32 v[18:19], v[170:171], v[174:175]
 v_pk_add_f32 v[24:25], v[184:185], v[188:189]
 v_pk_add_f32 v[26:27], v[186:187], v[190:191]
 v_pk_add_f32 v[32:33], v[200:201], v[204:205]
 v_pk_add_f32 v[34:35], v[202:203], v[206:207]
 v_pk_add_f32 v[160:161], v[160:161], v[164:165] neg_lo:[0,1] neg_hi:[0,1]
 v_pk_add_f32 v[162:163], v[162:163], v[166:167] neg_lo:[0,1] neg_hi:[0,1]
 v_pk_add_f32 v[176:177], v[176:177], v[180:181] neg_lo:[0,1] neg_hi:[0,1]
 v_pk_add_f32 v[178:179], v[178:179], v[182:183] neg_lo:[0,1] neg_hi:[0,1]
 v_pk_add_f32 v[192:193], v[192:193], v[196:197] neg_lo:[0,1] neg_hi:[0,1]
 v_pk_add_f32 v[194:195], v[194:195], v[198:199] neg_lo:[0,1] neg_hi:[0,1]
 v_pk_add_f32 v[164:165], v[168:169], v[172:173] neg_lo:[0,1] neg_hi:[0,1]
 v_pk_add_f32 v[166:167], v[170:171], v[174:175] neg_lo:[0,1] neg_hi:[0,1]
 v_pk_add_f32 v[180:181], v[184:185], v[188:189] neg_lo:[0,1] neg_hi:[0,1]
 v_pk_add_f32 v[182:183], v[186:187], v[190:191] neg_lo:[0,1] neg_hi:[0,1]
 v_pk_add_f32 v[196:197], v[200:201], v[204:205] neg_lo:[0,1] neg_hi:[0,1]
 v_pk_add_f32 v[198:199], v[202:203], v[206:207] neg_lo:[0,1] neg_hi:[0,1]
 v_pk_fma_f32 v[168:169], v[16:17], s[72:73], v[12:13] op_sel_hi:[1,0,1]
 v_pk_fma_f32 v[170:171], v[18:19], s[72:73], v[14:15] op_sel_hi:[1,0,1]
 v_pk_fma_f32 v[184:185], v[24:25], s[72:73], v[20:21] op_sel_hi:[1,0,1]
 v_pk_fma_f32 v[186:187], v[26:27], s[72:73], v[22:23] op_sel_hi:[1,0,1]
 v_pk_fma_f32 v[200:201], v[32:33], s[72:73], v[28:29] op_sel_hi:[1,0,1]
 v_pk_fma_f32 v[202:203], v[34:35], s[72:73], v[30:31] op_sel_hi:[1,0,1]
 v_pk_fma_f32 v[172:173], v[160:161], s[78:79], v[164:165] op_sel_hi:[1,0,1] neg_lo:[0,0,1] neg_hi:[0,0,1]
 v_pk_fma_f32 v[174:175], v[162:163], s[78:79], v[166:167] op_sel_hi:[1,0,1] neg_lo:[0,0,1] neg_hi:[0,0,1]
 v_pk_fma_f32 v[188:189], v[176:177], s[78:79], v[180:181] op_sel_hi:[1,0,1] neg_lo:[0,0,1] neg_hi:[0,0,1]
 v_pk_fma_f32 v[190:191], v[178:179], s[78:79], v[182:183] op_sel_hi:[1,0,1] neg_lo:[0,0,1] neg_hi:[0,0,1]
 v_pk_fma_f32 v[204:205], v[192:193], s[78:79], v[196:197] op_sel_hi:[1,0,1] neg_lo:[0,0,1] neg_hi:[0,0,1]
 v_pk_fma_f32 v[206:207], v[194:195], s[78:79], v[198:199] op_sel_hi:[1,0,1] neg_lo:[0,0,1] neg_hi:[0,0,1]
 v_pk_fma_f32 v[12:13], v[16:17], s[74:75], v[12:13] op_sel_hi:[1,0,1]
 v_pk_fma_f32 v[14:15], v[18:19], s[74:75], v[14:15] op_sel_hi:[1,0,1]
 v_pk_fma_f32 v[20:21], v[24:25], s[74:75], v[20:21] op_sel_hi:[1,0,1]
 v_pk_fma_f32 v[22:23], v[26:27], s[74:75], v[22:23] op_sel_hi:[1,0,1]
 v_pk_fma_f32 v[28:29], v[32:33], s[74:75], v[28:29] op_sel_hi:[1,0,1]
 v_pk_fma_f32 v[30:31], v[34:35], s[74:75], v[30:31] op_sel_hi:[1,0,1]
 v_pk_fma_f32 v[16:17], v[164:165], s[76:77], v[160:161] op_sel_hi:[1,0,1]
 v_pk_fma_f32 v[18:19], v[166:167], s[76:77], v[162:163] op_sel_hi:[1,0,1]
 v_pk_fma_f32 v[24:25], v[180:181], s[76:77], v[176:177] op_sel_hi:[1,0,1]
 v_pk_fma_f32 v[26:27], v[182:183], s[76:77], v[178:179] op_sel_hi:[1,0,1]
 v_pk_fma_f32 v[32:33], v[196:197], s[76:77], v[192:193] op_sel_hi:[1,0,1]
 v_pk_fma_f32 v[34:35], v[198:199], s[76:77], v[194:195] op_sel_hi:[1,0,1]
 v_pk_fma_f32 v[160:161], v[16:17], 2.0, v[12:13] op_sel_hi:[1,0,1]
 v_pk_fma_f32 v[162:163], v[18:19], 2.0, v[14:15] op_sel_hi:[1,0,1]
 v_pk_fma_f32 v[176:177], v[24:25], 2.0, v[20:21] op_sel_hi:[1,0,1]
 v_pk_fma_f32 v[178:179], v[26:27], 2.0, v[22:23] op_sel_hi:[1,0,1]
 v_pk_fma_f32 v[192:193], v[32:33], 2.0, v[28:29] op_sel_hi:[1,0,1]
 v_pk_fma_f32 v[194:195], v[34:35], 2.0, v[30:31] op_sel_hi:[1,0,1]
 v_pk_fma_f32 v[164:165], v[16:17], -2.0, v[12:13] op_sel_hi:[1,0,1]
 v_pk_fma_f32 v[166:167], v[18:19], -2.0, v[14:15] op_sel_hi:[1,0,1]
 v_pk_fma_f32 v[180:181], v[24:25], -2.0, v[20:21] op_sel_hi:[1,0,1]
 v_pk_fma_f32 v[182:183], v[26:27], -2.0, v[22:23] op_sel_hi:[1,0,1]
 v_pk_fma_f32 v[196:197], v[32:33], -2.0, v[28:29] op_sel_hi:[1,0,1]
 v_pk_fma_f32 v[198:199], v[34:35], -2.0, v[30:31] op_sel_hi:[1,0,1]
 v_pk_add_f32 v[12:13], v[208:209], v[212:213]
 v_pk_add_f32 v[14:15], v[210:211], v[214:215]
 v_pk_add_f32 v[20:21], v[224:225], v[228:229]
 v_pk_add_f32 v[22:23], v[226:227], v[230:231]
 v_pk_add_f32 v[28:29], v[240:241], v[244:245]
 v_pk_add_f32 v[30:31], v[242:243], v[246:247]
 v_pk_add_f32 v[16:17], v[216:217], v[220:221]
 v_pk_add_f32 v[18:19], v[218:219], v[222:223]
 v_pk_add_f32 v[24:25], v[232:233], v[236:237]
 v_pk_add_f32 v[26:27], v[234:235], v[238:239]
 v_pk_add_f32 v[32:33], v[248:249], v[252:253]
 v_pk_add_f32 v[34:35], v[250:251], v[254:255]
 v_pk_add_f32 v[208:209], v[208:209], v[212:213] neg_lo:[0,1] neg_hi:[0,1]
 v_pk_add_f32 v[210:211], v[210:211], v[214:215] neg_lo:[0,1] neg_hi:[0,1]
 v_pk_add_f32 v[224:225], v[224:225], v[228:229] neg_lo:[0,1] neg_hi:[0,1]
 v_pk_add_f32 v[226:227], v[226:227], v[230:231] neg_lo:[0,1] neg_hi:[0,1]
 v_pk_add_f32 v[240:241], v[240:241], v[244:245] neg_lo:[0,1] neg_hi:[0,1]
 v_pk_add_f32 v[242:243], v[242:243], v[246:247] neg_lo:[0,1] neg_hi:[0,1]
 v_pk_add_f32 v[212:213], v[216:217], v[220:221] neg_lo:[0,1] neg_hi:[0,1]
 v_pk_add_f32 v[214:215], v[218:219], v[222:223] neg_lo:[0,1] neg_hi:[0,1]
 v_pk_add_f32 v[228:229], v[232:233], v[236:237] neg_lo:[0,1] neg_hi:[0,1]
 v_pk_add_f32 v[230:231], v[234:235], v[238:239] neg_lo:[0,1] neg_hi:[0,1]
 v_pk_add_f32 v[244:245], v[248:249], v[252:253] neg_lo:[0,1] neg_hi:[0,1]
 v_pk_add_f32 v[246:247], v[250:251], v[254:255] neg_lo:[0,1] neg_hi:[0,1]
 v_pk_fma_f32 v[216:217], v[16:17], s[72:73], v[12:13] op_sel_hi:[1,0,1]
 v_pk_fma_f32 v[218:219], v[18:19], s[72:73], v[14:15] op_sel_hi:[1,0,1]
 v_pk_fma_f32 v[232:233], v[24:25], s[72:73], v[20:21] op_sel_hi:[1,0,1]
 v_pk_fma_f32 v[234:235], v[26:27], s[72:73], v[22:23] op_sel_hi:[1,0,1]
 v_pk_fma_f32 v[248:249], v[32:33], s[72:73], v[28:29] op_sel_hi:[1,0,1]
 v_pk_fma_f32 v[250:251], v[34:35], s[72:73], v[30:31] op_sel_hi:[1,0,1]
 v_pk_fma_f32 v[220:221], v[208:209], s[78:79], v[212:213] op_sel_hi:[1,0,1] neg_lo:[0,0,1] neg_hi:[0,0,1]
 v_pk_fma_f32 v[222:223], v[210:211], s[78:79], v[214:215] op_sel_hi:[1,0,1] neg_lo:[0,0,1] neg_hi:[0,0,1]
 v_pk_fma_f32 v[236:237], v[224:225], s[78:79], v[228:229] op_sel_hi:[1,0,1] neg_lo:[0,0,1] neg_hi:[0,0,1]
 v_pk_fma_f32 v[238:239], v[226:227], s[78:79], v[230:231] op_sel_hi:[1,0,1] neg_lo:[0,0,1] neg_hi:[0,0,1]
 v_pk_fma_f32 v[252:253], v[240:241], s[78:79], v[244:245] op_sel_hi:[1,0,1] neg_lo:[0,0,1] neg_hi:[0,0,1]
 v_pk_fma_f32 v[254:255], v[242:243], s[78:79], v[246:247] op_sel_hi:[1,0,1] neg_lo:[0,0,1] neg_hi:[0,0,1]
 v_pk_fma_f32 v[12:13], v[16:17], s[74:75], v[12:13] op_sel_hi:[1,0,1]
 v_pk_fma_f32 v[14:15], v[18:19], s[74:75], v[14:15] op_sel_hi:[1,0,1]
 v_pk_fma_f32 v[20:21], v[24:25], s[74:75], v[20:21] op_sel_hi:[1,0,1]
 v_pk_fma_f32 v[22:23], v[26:27], s[74:75], v[22:23] op_sel_hi:[1,0,1]
 v_pk_fma_f32 v[28:29], v[32:33], s[74:75], v[28:29] op_sel_hi:[1,0,1]
 v_pk_fma_f32 v[30:31], v[34:35], s[74:75], v[30:31] op_sel_hi:[1,0,1]
 v_pk_fma_f32 v[16:17], v[212:213], s[76:77], v[208:209] op_sel_hi:[1,0,1]
 v_pk_fma_f32 v[18:19], v[214:215], s[76:77], v[210:211] op_sel_hi:[1,0,1]
 v_pk_fma_f32 v[24:25], v[228:229], s[76:77], v[224:225] op_sel_hi:[1,0,1]
 v_pk_fma_f32 v[26:27], v[230:231], s[76:77], v[226:227] op_sel_hi:[1,0,1]
 v_pk_fma_f32 v[32:33], v[244:245], s[76:77], v[240:241] op_sel_hi:[1,0,1]
 v_pk_fma_f32 v[34:35], v[246:247], s[76:77], v[242:243] op_sel_hi:[1,0,1]
 v_pk_fma_f32 v[208:209], v[16:17], 2.0, v[12:13] op_sel_hi:[1,0,1]
 v_pk_fma_f32 v[210:211], v[18:19], 2.0, v[14:15] op_sel_hi:[1,0,1]
 v_pk_fma_f32 v[224:225], v[24:25], 2.0, v[20:21] op_sel_hi:[1,0,1]
 v_pk_fma_f32 v[226:227], v[26:27], 2.0, v[22:23] op_sel_hi:[1,0,1]
 v_pk_fma_f32 v[240:241], v[32:33], 2.0, v[28:29] op_sel_hi:[1,0,1]
 v_pk_fma_f32 v[242:243], v[34:35], 2.0, v[30:31] op_sel_hi:[1,0,1]
 v_pk_fma_f32 v[212:213], v[16:17], -2.0, v[12:13] op_sel_hi:[1,0,1]
 v_pk_fma_f32 v[214:215], v[18:19], -2.0, v[14:15] op_sel_hi:[1,0,1]
 v_pk_fma_f32 v[228:229], v[24:25], -2.0, v[20:21] op_sel_hi:[1,0,1]
 v_pk_fma_f32 v[230:231], v[26:27], -2.0, v[22:23] op_sel_hi:[1,0,1]
 v_pk_fma_f32 v[244:245], v[32:33], -2.0, v[28:29] op_sel_hi:[1,0,1]
 v_pk_fma_f32 v[246:247], v[34:35], -2.0, v[30:31] op_sel_hi:[1,0,1]
 v_accvgpr_read_b32 v12, a0
 v_accvgpr_read_b32 v13, a1
 v_accvgpr_read_b32 v14, a2
 v_accvgpr_read_b32 v15, a3
 v_accvgpr_read_b32 v16, a4
 v_accvgpr_read_b32 v17, a5
 v_accvgpr_read_b32 v18, a6
 v_accvgpr_read_b32 v19, a7
 v_accvgpr_read_b32 v20, a8
 v_accvgpr_read_b32 v21, a9
 v_accvgpr_read_b32 v22, a10
 v_accvgpr_read_b32 v23, a11
 v_accvgpr_read_b32 v24, a12
 v_accvgpr_read_b32 v25, a13
 v_accvgpr_read_b32 v26, a14
 v_accvgpr_read_b32 v27, a15
 v_accvgpr_read_b32 v36, a16
 v_accvgpr_read_b32 v37, a17
 v_accvgpr_read_b32 v38, a18
 v_accvgpr_read_b32 v39, a19
 v_accvgpr_read_b32 v40, a20
 v_accvgpr_read_b32 v41, a21
 v_accvgpr_read_b32 v42, a22
 v_accvgpr_read_b32 v43, a23
 v_accvgpr_read_b32 v44, a24
 v_accvgpr_read_b32 v45, a25
 v_accvgpr_read_b32 v46, a26
 v_accvgpr_read_b32 v47, a27
 v_accvgpr_read_b32 v48, a28
 v_accvgpr_read_b32 v49, a29
 v_accvgpr_read_b32 v50, a30
 v_accvgpr_read_b32 v51, a31
 v_pk_add_f32 v[28:29], v[12:13], v[16:17]
 v_pk_add_f32 v[30:31], v[14:15], v[18:19]
 v_pk_add_f32 v[52:53], v[36:37], v[40:41]
 v_pk_add_f32 v[54:55], v[38:39], v[42:43]
 v_pk_add_f32 v[32:33], v[20:21], v[24:25]
 v_pk_add_f32 v[34:35], v[22:23], v[26:27]
 v_pk_add_f32 v[56:57], v[44:45], v[48:49]
 v_pk_add_f32 v[58:59], v[46:47], v[50:51]
 v_pk_add_f32 v[12:13], v[12:13], v[16:17] neg_lo:[0,1] neg_hi:[0,1]
 v_pk_add_f32 v[14:15], v[14:15], v[18:19] neg_lo:[0,1] neg_hi:[0,1]
 v_pk_add_f32 v[36:37], v[36:37], v[40:41] neg_lo:[0,1] neg_hi:[0,1]
 v_pk_add_f32 v[38:39], v[38:39], v[42:43] neg_lo:[0,1] neg_hi:[0,1]
 v_pk_add_f32 v[16:17], v[20:21], v[24:25] neg_lo:[0,1] neg_hi:[0,1]
 v_pk_add_f32 v[18:19], v[22:23], v[26:27] neg_lo:[0,1] neg_hi:[0,1]
 v_pk_add_f32 v[40:41], v[44:45], v[48:49] neg_lo:[0,1] neg_hi:[0,1]
 v_pk_add_f32 v[42:43], v[46:47], v[50:51] neg_lo:[0,1] neg_hi:[0,1]
 v_pk_fma_f32 v[20:21], v[32:33], s[72:73], v[28:29] op_sel_hi:[1,0,1]
 v_pk_fma_f32 v[22:23], v[34:35], s[72:73], v[30:31] op_sel_hi:[1,0,1]
 v_pk_fma_f32 v[44:45], v[56:57], s[72:73], v[52:53] op_sel_hi:[1,0,1]
 v_pk_fma_f32 v[46:47], v[58:59], s[72:73], v[54:55] op_sel_hi:[1,0,1]
 v_pk_fma_f32 v[24:25], v[12:13], s[78:79], v[16:17] op_sel_hi:[1,0,1] neg_lo:[0,0,1] neg_hi:[0,0,1]
 v_pk_fma_f32 v[26:27], v[14:15], s[78:79], v[18:19] op_sel_hi:[1,0,1] neg_lo:[0,0,1] neg_hi:[0,0,1]
 v_pk_fma_f32 v[48:49], v[36:37], s[78:79], v[40:41] op_sel_hi:[1,0,1] neg_lo:[0,0,1] neg_hi:[0,0,1]
 v_pk_fma_f32 v[50:51], v[38:39], s[78:79], v[42:43] op_sel_hi:[1,0,1] neg_lo:[0,0,1] neg_hi:[0,0,1]
 v_pk_fma_f32 v[28:29], v[32:33], s[74:75], v[28:29] op_sel_hi:[1,0,1]
 v_pk_fma_f32 v[30:31], v[34:35], s[74:75], v[30:31] op_sel_hi:[1,0,1]
 v_pk_fma_f32 v[52:53], v[56:57], s[74:75], v[52:53] op_sel_hi:[1,0,1]
 v_pk_fma_f32 v[54:55], v[58:59], s[74:75], v[54:55] op_sel_hi:[1,0,1]
 v_pk_fma_f32 v[32:33], v[16:17], s[76:77], v[12:13] op_sel_hi:[1,0,1]
 v_pk_fma_f32 v[34:35], v[18:19], s[76:77], v[14:15] op_sel_hi:[1,0,1]
 v_pk_fma_f32 v[56:57], v[40:41], s[76:77], v[36:37] op_sel_hi:[1,0,1]
 v_pk_fma_f32 v[58:59], v[42:43], s[76:77], v[38:39] op_sel_hi:[1,0,1]
 v_pk_fma_f32 v[12:13], v[32:33], 2.0, v[28:29] op_sel_hi:[1,0,1]
 v_pk_fma_f32 v[14:15], v[34:35], 2.0, v[30:31] op_sel_hi:[1,0,1]
 v_pk_fma_f32 v[36:37], v[56:57], 2.0, v[52:53] op_sel_hi:[1,0,1]
 v_pk_fma_f32 v[38:39], v[58:59], 2.0, v[54:55] op_sel_hi:[1,0,1]
 v_pk_fma_f32 v[16:17], v[32:33], -2.0, v[28:29] op_sel_hi:[1,0,1]
 v_pk_fma_f32 v[18:19], v[34:35], -2.0, v[30:31] op_sel_hi:[1,0,1]
 v_pk_fma_f32 v[40:41], v[56:57], -2.0, v[52:53] op_sel_hi:[1,0,1]
 v_pk_fma_f32 v[42:43], v[58:59], -2.0, v[54:55] op_sel_hi:[1,0,1]
 v_accvgpr_write_b32 a0, v12
 v_accvgpr_write_b32 a1, v13
 v_accvgpr_write_b32 a2, v14
 v_accvgpr_write_b32 a3, v15
 v_accvgpr_write_b32 a4, v16
 v_accvgpr_write_b32 a5, v17
 v_accvgpr_write_b32 a6, v18
 v_accvgpr_write_b32 a7, v19
 v_accvgpr_write_b32 a8, v20
 v_accvgpr_write_b32 a9, v21
 v_accvgpr_write_b32 a10, v22
 v_accvgpr_write_b32 a11, v23
 v_accvgpr_write_b32 a12, v24
 v_accvgpr_write_b32 a13, v25
 v_accvgpr_write_b32 a14, v26
 v_accvgpr_write_b32 a15, v27
 v_accvgpr_write_b32 a16, v36
 v_accvgpr_write_b32 a17, v37
 v_accvgpr_write_b32 a18, v38
 v_accvgpr_write_b32 a19, v39
 v_accvgpr_write_b32 a20, v40
 v_accvgpr_write_b32 a21, v41
 v_accvgpr_write_b32 a22, v42
 v_accvgpr_write_b32 a23, v43
 v_accvgpr_write_b32 a24, v44
 v_accvgpr_write_b32 a25, v45
 v_accvgpr_write_b32 a26, v46
 v_accvgpr_write_b32 a27, v47
 v_accvgpr_write_b32 a28, v48
 v_accvgpr_write_b32 a29, v49
 v_accvgpr_write_b32 a30, v50
 v_accvgpr_write_b32 a31, v51
 v_accvgpr_read_b32 v12, a32
 v_accvgpr_read_b32 v13, a33
 v_accvgpr_read_b32 v14, a34
 v_accvgpr_read_b32 v15, a35
 v_accvgpr_read_b32 v16, a36
 v_accvgpr_read_b32 v17, a37
 v_accvgpr_read_b32 v18, a38
 v_accvgpr_read_b32 v19, a39
 v_accvgpr_read_b32 v20, a40
 v_accvgpr_read_b32 v21, a41
 v_accvgpr_read_b32 v22, a42
 v_accvgpr_read_b32 v23, a43
 v_accvgpr_read_b32 v24, a44
 v_accvgpr_read_b32 v25, a45
 v_accvgpr_read_b32 v26, a46
 v_accvgpr_read_b32 v27, a47
 v_accvgpr_read_b32 v36, a48
 v_accvgpr_read_b32 v37, a49
 v_accvgpr_read_b32 v38, a50
 v_accvgpr_read_b32 v39, a51
 v_accvgpr_read_b32 v40, a52
 v_accvgpr_read_b32 v41, a53
 v_accvgpr_read_b32 v42, a54
 v_accvgpr_read_b32 v43, a55
 v_accvgpr_read_b32 v44, a56
 v_accvgpr_read_b32 v45, a57
 v_accvgpr_read_b32 v46, a58
 v_accvgpr_read_b32 v47, a59
 v_accvgpr_read_b32 v48, a60
 v_accvgpr_read_b32 v49, a61
 v_accvgpr_read_b32 v50, a62
 v_accvgpr_read_b32 v51, a63
 v_pk_add_f32 v[28:29], v[12:13], v[16:17]
 v_pk_add_f32 v[30:31], v[14:15], v[18:19]
 v_pk_add_f32 v[52:53], v[36:37], v[40:41]
 v_pk_add_f32 v[54:55], v[38:39], v[42:43]
 v_pk_add_f32 v[32:33], v[20:21], v[24:25]
 v_pk_add_f32 v[34:35], v[22:23], v[26:27]
 v_pk_add_f32 v[56:57], v[44:45], v[48:49]
 v_pk_add_f32 v[58:59], v[46:47], v[50:51]
 v_pk_add_f32 v[12:13], v[12:13], v[16:17] neg_lo:[0,1] neg_hi:[0,1]
 v_pk_add_f32 v[14:15], v[14:15], v[18:19] neg_lo:[0,1] neg_hi:[0,1]
 v_pk_add_f32 v[36:37], v[36:37], v[40:41] neg_lo:[0,1] neg_hi:[0,1]
 v_pk_add_f32 v[38:39], v[38:39], v[42:43] neg_lo:[0,1] neg_hi:[0,1]
 v_pk_add_f32 v[16:17], v[20:21], v[24:25] neg_lo:[0,1] neg_hi:[0,1]
 v_pk_add_f32 v[18:19], v[22:23], v[26:27] neg_lo:[0,1] neg_hi:[0,1]
 v_pk_add_f32 v[40:41], v[44:45], v[48:49] neg_lo:[0,1] neg_hi:[0,1]
 v_pk_add_f32 v[42:43], v[46:47], v[50:51] neg_lo:[0,1] neg_hi:[0,1]
 v_pk_fma_f32 v[20:21], v[32:33], s[72:73], v[28:29] op_sel_hi:[1,0,1]
 v_pk_fma_f32 v[22:23], v[34:35], s[72:73], v[30:31] op_sel_hi:[1,0,1]
 v_pk_fma_f32 v[44:45], v[56:57], s[72:73], v[52:53] op_sel_hi:[1,0,1]
 v_pk_fma_f32 v[46:47], v[58:59], s[72:73], v[54:55] op_sel_hi:[1,0,1]
 v_pk_fma_f32 v[24:25], v[12:13], s[78:79], v[16:17] op_sel_hi:[1,0,1] neg_lo:[0,0,1] neg_hi:[0,0,1]
 v_pk_fma_f32 v[26:27], v[14:15], s[78:79], v[18:19] op_sel_hi:[1,0,1] neg_lo:[0,0,1] neg_hi:[0,0,1]
 v_pk_fma_f32 v[48:49], v[36:37], s[78:79], v[40:41] op_sel_hi:[1,0,1] neg_lo:[0,0,1] neg_hi:[0,0,1]
 v_pk_fma_f32 v[50:51], v[38:39], s[78:79], v[42:43] op_sel_hi:[1,0,1] neg_lo:[0,0,1] neg_hi:[0,0,1]
 v_pk_fma_f32 v[28:29], v[32:33], s[74:75], v[28:29] op_sel_hi:[1,0,1]
 v_pk_fma_f32 v[30:31], v[34:35], s[74:75], v[30:31] op_sel_hi:[1,0,1]
 v_pk_fma_f32 v[52:53], v[56:57], s[74:75], v[52:53] op_sel_hi:[1,0,1]
 v_pk_fma_f32 v[54:55], v[58:59], s[74:75], v[54:55] op_sel_hi:[1,0,1]
 v_pk_fma_f32 v[32:33], v[16:17], s[76:77], v[12:13] op_sel_hi:[1,0,1]
 v_pk_fma_f32 v[34:35], v[18:19], s[76:77], v[14:15] op_sel_hi:[1,0,1]
 v_pk_fma_f32 v[56:57], v[40:41], s[76:77], v[36:37] op_sel_hi:[1,0,1]
 v_pk_fma_f32 v[58:59], v[42:43], s[76:77], v[38:39] op_sel_hi:[1,0,1]
 v_pk_fma_f32 v[12:13], v[32:33], 2.0, v[28:29] op_sel_hi:[1,0,1]
 v_pk_fma_f32 v[14:15], v[34:35], 2.0, v[30:31] op_sel_hi:[1,0,1]
 v_pk_fma_f32 v[36:37], v[56:57], 2.0, v[52:53] op_sel_hi:[1,0,1]
 v_pk_fma_f32 v[38:39], v[58:59], 2.0, v[54:55] op_sel_hi:[1,0,1]
 v_pk_fma_f32 v[16:17], v[32:33], -2.0, v[28:29] op_sel_hi:[1,0,1]
 v_pk_fma_f32 v[18:19], v[34:35], -2.0, v[30:31] op_sel_hi:[1,0,1]
 v_pk_fma_f32 v[40:41], v[56:57], -2.0, v[52:53] op_sel_hi:[1,0,1]
 v_pk_fma_f32 v[42:43], v[58:59], -2.0, v[54:55] op_sel_hi:[1,0,1]
 v_accvgpr_write_b32 a32, v12
 v_accvgpr_write_b32 a33, v13
 v_accvgpr_write_b32 a34, v14
 v_accvgpr_write_b32 a35, v15
 v_accvgpr_write_b32 a36, v16
 v_accvgpr_write_b32 a37, v17
 v_accvgpr_write_b32 a38, v18
 v_accvgpr_write_b32 a39, v19
 v_accvgpr_write_b32 a40, v20
 v_accvgpr_write_b32 a41, v21
 v_accvgpr_write_b32 a42, v22
 v_accvgpr_write_b32 a43, v23
 v_accvgpr_write_b32 a44, v24
 v_accvgpr_write_b32 a45, v25
 v_accvgpr_write_b32 a46, v26
 v_accvgpr_write_b32 a47, v27
 v_accvgpr_write_b32 a48, v36
 v_accvgpr_write_b32 a49, v37
 v_accvgpr_write_b32 a50, v38
 v_accvgpr_write_b32 a51, v39
 v_accvgpr_write_b32 a52, v40
 v_accvgpr_write_b32 a53, v41
 v_accvgpr_write_b32 a54, v42
 v_accvgpr_write_b32 a55, v43
 v_accvgpr_write_b32 a56, v44
 v_accvgpr_write_b32 a57, v45
 v_accvgpr_write_b32 a58, v46
 v_accvgpr_write_b32 a59, v47
 v_accvgpr_write_b32 a60, v48
 v_accvgpr_write_b32 a61, v49
 v_accvgpr_write_b32 a62, v50
 v_accvgpr_write_b32 a63, v51
 v_accvgpr_read_b32 v12, a64
 v_accvgpr_read_b32 v13, a65
 v_accvgpr_read_b32 v14, a66
 v_accvgpr_read_b32 v15, a67
 v_accvgpr_read_b32 v16, a68
 v_accvgpr_read_b32 v17, a69
 v_accvgpr_read_b32 v18, a70
 v_accvgpr_read_b32 v19, a71
 v_accvgpr_read_b32 v20, a72
 v_accvgpr_read_b32 v21, a73
 v_accvgpr_read_b32 v22, a74
 v_accvgpr_read_b32 v23, a75
 v_accvgpr_read_b32 v24, a76
 v_accvgpr_read_b32 v25, a77
 v_accvgpr_read_b32 v26, a78
 v_accvgpr_read_b32 v27, a79
 v_accvgpr_read_b32 v36, a80
 v_accvgpr_read_b32 v37, a81
 v_accvgpr_read_b32 v38, a82
 v_accvgpr_read_b32 v39, a83
 v_accvgpr_read_b32 v40, a84
 v_accvgpr_read_b32 v41, a85
 v_accvgpr_read_b32 v42, a86
 v_accvgpr_read_b32 v43, a87
 v_accvgpr_read_b32 v44, a88
 v_accvgpr_read_b32 v45, a89
 v_accvgpr_read_b32 v46, a90
 v_accvgpr_read_b32 v47, a91
 v_accvgpr_read_b32 v48, a92
 v_accvgpr_read_b32 v49, a93
 v_accvgpr_read_b32 v50, a94
 v_accvgpr_read_b32 v51, a95
 v_pk_add_f32 v[28:29], v[12:13], v[16:17]
 v_pk_add_f32 v[30:31], v[14:15], v[18:19]
 v_pk_add_f32 v[52:53], v[36:37], v[40:41]
 v_pk_add_f32 v[54:55], v[38:39], v[42:43]
 v_pk_add_f32 v[32:33], v[20:21], v[24:25]
 v_pk_add_f32 v[34:35], v[22:23], v[26:27]
 v_pk_add_f32 v[56:57], v[44:45], v[48:49]
 v_pk_add_f32 v[58:59], v[46:47], v[50:51]
 v_pk_add_f32 v[12:13], v[12:13], v[16:17] neg_lo:[0,1] neg_hi:[0,1]
 v_pk_add_f32 v[14:15], v[14:15], v[18:19] neg_lo:[0,1] neg_hi:[0,1]
 v_pk_add_f32 v[36:37], v[36:37], v[40:41] neg_lo:[0,1] neg_hi:[0,1]
 v_pk_add_f32 v[38:39], v[38:39], v[42:43] neg_lo:[0,1] neg_hi:[0,1]
 v_pk_add_f32 v[16:17], v[20:21], v[24:25] neg_lo:[0,1] neg_hi:[0,1]
 v_pk_add_f32 v[18:19], v[22:23], v[26:27] neg_lo:[0,1] neg_hi:[0,1]
 v_pk_add_f32 v[40:41], v[44:45], v[48:49] neg_lo:[0,1] neg_hi:[0,1]
 v_pk_add_f32 v[42:43], v[46:47], v[50:51] neg_lo:[0,1] neg_hi:[0,1]
 v_pk_fma_f32 v[20:21], v[32:33], s[72:73], v[28:29] op_sel_hi:[1,0,1]
 v_pk_fma_f32 v[22:23], v[34:35], s[72:73], v[30:31] op_sel_hi:[1,0,1]
 v_pk_fma_f32 v[44:45], v[56:57], s[72:73], v[52:53] op_sel_hi:[1,0,1]
 v_pk_fma_f32 v[46:47], v[58:59], s[72:73], v[54:55] op_sel_hi:[1,0,1]
 v_pk_fma_f32 v[24:25], v[12:13], s[78:79], v[16:17] op_sel_hi:[1,0,1] neg_lo:[0,0,1] neg_hi:[0,0,1]
 v_pk_fma_f32 v[26:27], v[14:15], s[78:79], v[18:19] op_sel_hi:[1,0,1] neg_lo:[0,0,1] neg_hi:[0,0,1]
 v_pk_fma_f32 v[48:49], v[36:37], s[78:79], v[40:41] op_sel_hi:[1,0,1] neg_lo:[0,0,1] neg_hi:[0,0,1]
 v_pk_fma_f32 v[50:51], v[38:39], s[78:79], v[42:43] op_sel_hi:[1,0,1] neg_lo:[0,0,1] neg_hi:[0,0,1]
 v_pk_fma_f32 v[28:29], v[32:33], s[74:75], v[28:29] op_sel_hi:[1,0,1]
 v_pk_fma_f32 v[30:31], v[34:35], s[74:75], v[30:31] op_sel_hi:[1,0,1]
 v_pk_fma_f32 v[52:53], v[56:57], s[74:75], v[52:53] op_sel_hi:[1,0,1]
 v_pk_fma_f32 v[54:55], v[58:59], s[74:75], v[54:55] op_sel_hi:[1,0,1]
 v_pk_fma_f32 v[32:33], v[16:17], s[76:77], v[12:13] op_sel_hi:[1,0,1]
 v_pk_fma_f32 v[34:35], v[18:19], s[76:77], v[14:15] op_sel_hi:[1,0,1]
 v_pk_fma_f32 v[56:57], v[40:41], s[76:77], v[36:37] op_sel_hi:[1,0,1]
 v_pk_fma_f32 v[58:59], v[42:43], s[76:77], v[38:39] op_sel_hi:[1,0,1]
 v_pk_fma_f32 v[12:13], v[32:33], 2.0, v[28:29] op_sel_hi:[1,0,1]
 v_pk_fma_f32 v[14:15], v[34:35], 2.0, v[30:31] op_sel_hi:[1,0,1]
 v_pk_fma_f32 v[36:37], v[56:57], 2.0, v[52:53] op_sel_hi:[1,0,1]
 v_pk_fma_f32 v[38:39], v[58:59], 2.0, v[54:55] op_sel_hi:[1,0,1]
 v_pk_fma_f32 v[16:17], v[32:33], -2.0, v[28:29] op_sel_hi:[1,0,1]
 v_pk_fma_f32 v[18:19], v[34:35], -2.0, v[30:31] op_sel_hi:[1,0,1]
 v_pk_fma_f32 v[40:41], v[56:57], -2.0, v[52:53] op_sel_hi:[1,0,1]
 v_pk_fma_f32 v[42:43], v[58:59], -2.0, v[54:55] op_sel_hi:[1,0,1]
 v_accvgpr_write_b32 a64, v12
 v_accvgpr_write_b32 a65, v13
 v_accvgpr_write_b32 a66, v14
 v_accvgpr_write_b32 a67, v15
 v_accvgpr_write_b32 a68, v16
 v_accvgpr_write_b32 a69, v17
 v_accvgpr_write_b32 a70, v18
 v_accvgpr_write_b32 a71, v19
 v_accvgpr_write_b32 a72, v20
 v_accvgpr_write_b32 a73, v21
 v_accvgpr_write_b32 a74, v22
 v_accvgpr_write_b32 a75, v23
 v_accvgpr_write_b32 a76, v24
 v_accvgpr_write_b32 a77, v25
 v_accvgpr_write_b32 a78, v26
 v_accvgpr_write_b32 a79, v27
 v_accvgpr_write_b32 a80, v36
 v_accvgpr_write_b32 a81, v37
 v_accvgpr_write_b32 a82, v38
 v_accvgpr_write_b32 a83, v39
 v_accvgpr_write_b32 a84, v40
 v_accvgpr_write_b32 a85, v41
 v_accvgpr_write_b32 a86, v42
 v_accvgpr_write_b32 a87, v43
 v_accvgpr_write_b32 a88, v44
 v_accvgpr_write_b32 a89, v45
 v_accvgpr_write_b32 a90, v46
 v_accvgpr_write_b32 a91, v47
 v_accvgpr_write_b32 a92, v48
 v_accvgpr_write_b32 a93, v49
 v_accvgpr_write_b32 a94, v50
 v_accvgpr_write_b32 a95, v51
 v_accvgpr_read_b32 v12, a96
 v_accvgpr_read_b32 v13, a97
 v_accvgpr_read_b32 v14, a98
 v_accvgpr_read_b32 v15, a99
 v_accvgpr_read_b32 v16, a100
 v_accvgpr_read_b32 v17, a101
 v_accvgpr_read_b32 v18, a102
 v_accvgpr_read_b32 v19, a103
 v_accvgpr_read_b32 v20, a104
 v_accvgpr_read_b32 v21, a105
 v_accvgpr_read_b32 v22, a106
 v_accvgpr_read_b32 v23, a107
 v_accvgpr_read_b32 v24, a108
 v_accvgpr_read_b32 v25, a109
 v_accvgpr_read_b32 v26, a110
 v_accvgpr_read_b32 v27, a111
 v_pk_add_f32 v[28:29], v[12:13], v[16:17]
 v_pk_add_f32 v[30:31], v[14:15], v[18:19]
 v_pk_add_f32 v[32:33], v[20:21], v[24:25]
 v_pk_add_f32 v[34:35], v[22:23], v[26:27]
 v_pk_add_f32 v[12:13], v[12:13], v[16:17] neg_lo:[0,1] neg_hi:[0,1]
 v_pk_add_f32 v[14:15], v[14:15], v[18:19] neg_lo:[0,1] neg_hi:[0,1]
 v_pk_add_f32 v[16:17], v[20:21], v[24:25] neg_lo:[0,1] neg_hi:[0,1]
 v_pk_add_f32 v[18:19], v[22:23], v[26:27] neg_lo:[0,1] neg_hi:[0,1]
 v_pk_fma_f32 v[20:21], v[32:33], s[72:73], v[28:29] op_sel_hi:[1,0,1]
 v_pk_fma_f32 v[22:23], v[34:35], s[72:73], v[30:31] op_sel_hi:[1,0,1]
 v_pk_fma_f32 v[24:25], v[12:13], s[78:79], v[16:17] op_sel_hi:[1,0,1] neg_lo:[0,0,1] neg_hi:[0,0,1]
 v_pk_fma_f32 v[26:27], v[14:15], s[78:79], v[18:19] op_sel_hi:[1,0,1] neg_lo:[0,0,1] neg_hi:[0,0,1]
 v_pk_fma_f32 v[28:29], v[32:33], s[74:75], v[28:29] op_sel_hi:[1,0,1]
 v_pk_fma_f32 v[30:31], v[34:35], s[74:75], v[30:31] op_sel_hi:[1,0,1]
 v_pk_fma_f32 v[32:33], v[16:17], s[76:77], v[12:13] op_sel_hi:[1,0,1]
 v_pk_fma_f32 v[34:35], v[18:19], s[76:77], v[14:15] op_sel_hi:[1,0,1]
 v_pk_fma_f32 v[12:13], v[32:33], 2.0, v[28:29] op_sel_hi:[1,0,1]
 v_pk_fma_f32 v[14:15], v[34:35], 2.0, v[30:31] op_sel_hi:[1,0,1]
 v_pk_fma_f32 v[16:17], v[32:33], -2.0, v[28:29] op_sel_hi:[1,0,1]
 v_pk_fma_f32 v[18:19], v[34:35], -2.0, v[30:31] op_sel_hi:[1,0,1]
 v_accvgpr_write_b32 a96, v12
 v_accvgpr_write_b32 a97, v13
 v_accvgpr_write_b32 a98, v14
 v_accvgpr_write_b32 a99, v15
 v_accvgpr_write_b32 a100, v16
 v_accvgpr_write_b32 a101, v17
 v_accvgpr_write_b32 a102, v18
 v_accvgpr_write_b32 a103, v19
 v_accvgpr_write_b32 a104, v20
 v_accvgpr_write_b32 a105, v21
 v_accvgpr_write_b32 a106, v22
 v_accvgpr_write_b32 a107, v23
 v_accvgpr_write_b32 a108, v24
 v_accvgpr_write_b32 a109, v25
 v_accvgpr_write_b32 a110, v26
 v_accvgpr_write_b32 a111, v27
 s_nop 1
 s_branch L_B2
.p2align 6
L_B1:
 s_waitcnt vmcnt(32) lgkmcnt(3)
 v_mfma_f32_16x16x32_bf16 v[112:115], a[112:115], a[240:243], v[112:115]
 s_waitcnt vmcnt(27)
 v_lshlrev_b32 v28, 16, v68
 v_and_b32 v29, s34, v68
 v_lshlrev_b32 v30, 16, v72
 v_and_b32 v31, s34, v72
 v_mfma_f32_16x16x32_bf16 v[128:131], a[116:119], a[240:243], v[128:131]
 buffer_load_dwordx4 a[224:227], v1, s[20:23], s55 offen offset:0
 v_lshlrev_b32 v32, 16, v69
 v_mfma_f32_16x16x32_bf16 v[144:147], a[120:123], a[240:243], v[144:147]
 v_and_b32 v33, s34, v69
 v_lshlrev_b32 v34, 16, v73
 v_and_b32 v35, s34, v73
 v_lshlrev_b32 v36, 16, v70
 v_mfma_f32_16x16x32_bf16 v[160:163], a[124:127], a[240:243], v[160:163]
 ds_read_b128 a[240:243], v7 offset:4096
 v_and_b32 v37, s34, v70
 v_lshlrev_b32 v38, 16, v74
 v_and_b32 v39, s34, v74
 s_waitcnt lgkmcnt(3)
 v_mfma_f32_16x16x32_bf16 v[176:179], a[112:115], a[244:247], v[176:179]
 v_lshlrev_b32 v40, 16, v71
 v_and_b32 v41, s34, v71
 v_lshlrev_b32 v42, 16, v75
 v_and_b32 v43, s34, v75
 v_mfma_f32_16x16x32_bf16 v[192:195], a[116:119], a[244:247], v[192:195]
 buffer_load_dwordx4 a[228:231], v1, s[20:23], s55 offen offset:1024
 v_mfma_f32_16x16x32_bf16 v[208:211], a[120:123], a[244:247], v[208:211]
 s_waitcnt vmcnt(12)
 v_lshlrev_b32 v44, 16, v76
 v_mfma_f32_16x16x32_bf16 v[224:227], a[124:127], a[244:247], v[224:227]
 ds_read_b128 a[244:247], v7 offset:5120
 buffer_load_dwordx4 v[68:71], v2, s[16:19], s53 offen offset:2048
 v_and_b32 v45, s34, v76
 v_lshlrev_b32 v46, 16, v80
 v_and_b32 v47, s34, v80
 s_waitcnt lgkmcnt(3)
 v_mfma_f32_16x16x32_bf16 v[240:243], a[112:115], a[248:251], v[240:243]
 v_lshlrev_b32 v48, 16, v84
 v_and_b32 v49, s34, v84
 v_lshlrev_b32 v50, 16, v88
 v_mfma_f32_16x16x32_bf16 a[0:3], a[116:119], a[248:251], a[0:3]
 buffer_load_dwordx4 a[232:235], v1, s[20:23], s55 offen offset:2048
 v_and_b32 v51, s34, v88
 v_fma_f32 v52, s39, v46, v50
 v_mfma_f32_16x16x32_bf16 a[16:19], a[120:123], a[248:251], a[16:19]
 v_fma_f32 v53, s39, v47, v51
 v_fma_f32 v54, s39, v44, v48
 v_fma_f32 v55, s39, v45, v49
 v_fma_f32 v46, s40, v46, v50
 v_mfma_f32_16x16x32_bf16 a[32:35], a[124:127], a[248:251], a[32:35]
 ds_read_b128 a[248:251], v7 offset:6144
 v_fma_f32 v47, s40, v47, v51
 v_fma_f32 v44, s40, v44, v48
 s_waitcnt lgkmcnt(3)
 v_mfma_f32_16x16x32_bf16 a[48:51], a[112:115], a[252:255], a[48:51]
 v_fma_f32 v45, s40, v45, v49
 v_add_f32 v52, v52, v30
 v_add_f32 v53, v53, v31
 v_add_f32 v54, v54, v28
 v_mfma_f32_16x16x32_bf16 a[64:67], a[116:119], a[252:255], a[64:67]
 buffer_load_dwordx4 a[236:239], v1, s[20:23], s55 offen offset:3072
 v_add_f32 v55, v55, v29
 v_fmac_f32 v46, 4.0, v30
 v_mfma_f32_16x16x32_bf16 a[80:83], a[120:123], a[252:255], a[80:83]
 v_fmac_f32 v47, 4.0, v31
 v_fmac_f32 v44, 4.0, v28
 v_fmac_f32 v45, 4.0, v29
 v_add_f32 v28, v52, v54
 v_mfma_f32_16x16x32_bf16 a[96:99], a[124:127], a[252:255], a[96:99]
 ds_read_b128 a[252:255], v7 offset:7168
 buffer_load_dwordx4 v[72:75], v2, s[16:19], s54 offen offset:0
 v_add_f32 v29, v53, v55
 v_sub_f32 v52, v52, v54
 s_waitcnt lgkmcnt(3)
 v_mfma_f32_16x16x32_bf16 v[116:119], a[128:131], a[240:243], v[116:119]
 v_sub_f32 v53, v53, v55
 v_fma_f32 v30, 0.5, v44, v46
 v_fma_f32 v31, 0.5, v45, v47
 v_fma_f32 v46, -0.5, v44, v46
 v_mfma_f32_16x16x32_bf16 v[132:135], a[132:135], a[240:243], v[132:135]
 s_add_u32 s20, s20, 32768
 s_addc_u32 s21, s21, 0
 buffer_load_dwordx4 a[112:115], v1, s[20:23], s48 offen offset:0
 v_mfma_f32_16x16x32_bf16 v[148:151], a[136:139], a[240:243], v[148:151]
 v_fma_f32 v47, -0.5, v45, v47
 v_cvt_pk_bf16_f32 v12, v28, v29
 v_cvt_pk_bf16_f32 v16, v52, v53
 v_cvt_pk_bf16_f32 v20, v30, v31
 v_mfma_f32_16x16x32_bf16 v[164:167], a[140:143], a[240:243], v[164:167]
 ds_read_b128 a[240:243], v7 offset:8192
 v_cvt_pk_bf16_f32 v24, v46, v47
 v_lshlrev_b32 v56, 16, v77
 v_and_b32 v57, s34, v77
 s_waitcnt lgkmcnt(3)
 v_mfma_f32_16x16x32_bf16 v[180:183], a[128:131], a[244:247], v[180:183]
 v_lshlrev_b32 v58, 16, v81
 v_and_b32 v59, s34, v81
 v_lshlrev_b32 v60, 16, v85
 v_mfma_f32_16x16x32_bf16 v[196:199], a[132:135], a[244:247], v[196:199]
 buffer_load_dwordx4 a[116:119], v1, s[20:23], s48 offen offset:1024
 v_and_b32 v61, s34, v85
 v_lshlrev_b32 v62, 16, v89
 v_mfma_f32_16x16x32_bf16 v[212:215], a[136:139], a[244:247], v[212:215]
 v_and_b32 v63, s34, v89
 v_fma_f32 v64, s39, v58, v62
 v_fma_f32 v65, s39, v59, v63
 v_fma_f32 v66, s39, v56, v60
 v_mfma_f32_16x16x32_bf16 v[228:231], a[140:143], a[244:247], v[228:231]
 ds_read_b128 a[244:247], v7 offset:9216
 v_fma_f32 v67, s39, v57, v61
 v_fma_f32 v58, s40, v58, v62
 s_waitcnt lgkmcnt(3)
 v_mfma_f32_16x16x32_bf16 v[244:247], a[128:131], a[248:251], v[244:247]
 v_fma_f32 v59, s40, v59, v63
 v_fma_f32 v56, s40, v56, v60
 v_fma_f32 v57, s40, v57, v61
 v_add_f32 v64, v64, v34
 v_mfma_f32_16x16x32_bf16 a[4:7], a[132:135], a[248:251], a[4:7]
 buffer_load_dwordx4 a[120:123], v1, s[20:23], s48 offen offset:2048
 v_add_f32 v65, v65, v35
 v_add_f32 v66, v66, v32
 v_mfma_f32_16x16x32_bf16 a[20:23], a[136:139], a[248:251], a[20:23]
 v_add_f32 v67, v67, v33
 v_fmac_f32 v58, 4.0, v34
 v_fmac_f32 v59, 4.0, v35
 v_mfma_f32_16x16x32_bf16 a[36:39], a[140:143], a[248:251], a[36:39]
 ds_read_b128 a[248:251], v7 offset:10240
 v_fmac_f32 v56, 4.0, v32
 v_fmac_f32 v57, 4.0, v33
 v_add_f32 v32, v64, v66
 s_waitcnt lgkmcnt(3)
 v_mfma_f32_16x16x32_bf16 a[52:55], a[128:131], a[252:255], a[52:55]
 v_add_f32 v33, v65, v67
 v_sub_f32 v64, v64, v66
 v_sub_f32 v65, v65, v67
 v_fma_f32 v34, 0.5, v56, v58
 v_mfma_f32_16x16x32_bf16 a[68:71], a[132:135], a[252:255], a[68:71]
 buffer_load_dwordx4 a[124:127], v1, s[20:23], s48 offen offset:3072
 v_fma_f32 v35, 0.5, v57, v59
 v_fma_f32 v58, -0.5, v56, v58
 v_mfma_f32_16x16x32_bf16 a[84:87], a[136:139], a[252:255], a[84:87]
 v_fma_f32 v59, -0.5, v57, v59
 v_cvt_pk_bf16_f32 v13, v32, v33
 v_cvt_pk_bf16_f32 v17, v64, v65
 v_mfma_f32_16x16x32_bf16 a[100:103], a[140:143], a[252:255], a[100:103]
 ds_read_b128 a[252:255], v7 offset:11264
 v_cvt_pk_bf16_f32 v21, v34, v35
 v_cvt_pk_bf16_f32 v25, v58, v59
 v_lshlrev_b32 v28, 16, v78
 s_waitcnt lgkmcnt(3)
 v_mfma_f32_16x16x32_bf16 v[120:123], a[144:147], a[240:243], v[120:123]
 v_and_b32 v29, s34, v78
 v_lshlrev_b32 v30, 16, v82
 v_and_b32 v31, s34, v82
 v_lshlrev_b32 v52, 16, v86
 v_mfma_f32_16x16x32_bf16 v[136:139], a[148:151], a[240:243], v[136:139]
 buffer_load_dwordx4 a[128:131], v1, s[20:23], s49 offen offset:0
 v_and_b32 v53, s34, v86
 v_mfma_f32_16x16x32_bf16 v[152:155], a[152:155], a[240:243], v[152:155]
 v_lshlrev_b32 v54, 16, v90
 v_and_b32 v55, s34, v90
 v_fma_f32 v44, s39, v30, v54
 v_fma_f32 v45, s39, v31, v55
 v_mfma_f32_16x16x32_bf16 v[168:171], a[156:159], a[240:243], v[168:171]
 ds_read_b128 a[240:243], v7 offset:12288
 v_fma_f32 v46, s39, v28, v52
 v_fma_f32 v47, s39, v29, v53
 v_fma_f32 v30, s40, v30, v54
 s_waitcnt lgkmcnt(3)
 v_mfma_f32_16x16x32_bf16 v[184:187], a[144:147], a[244:247], v[184:187]
 v_fma_f32 v31, s40, v31, v55
 v_fma_f32 v28, s40, v28, v52
 v_fma_f32 v29, s40, v29, v53
 v_add_f32 v44, v44, v38
 v_mfma_f32_16x16x32_bf16 v[200:203], a[148:151], a[244:247], v[200:203]
 buffer_load_dwordx4 a[132:135], v1, s[20:23], s49 offen offset:1024
 v_add_f32 v45, v45, v39
 v_mfma_f32_16x16x32_bf16 v[216:219], a[152:155], a[244:247], v[216:219]
 v_add_f32 v46, v46, v36
 v_add_f32 v47, v47, v37
 v_fmac_f32 v30, 4.0, v38
 v_fmac_f32 v31, 4.0, v39
 v_mfma_f32_16x16x32_bf16 v[232:235], a[156:159], a[244:247], v[232:235]
 ds_read_b128 a[244:247], v7 offset:13312
 v_fmac_f32 v28, 4.0, v36
 v_fmac_f32 v29, 4.0, v37
 v_add_f32 v36, v44, v46
 s_waitcnt lgkmcnt(3)
 v_mfma_f32_16x16x32_bf16 v[248:251], a[144:147], a[248:251], v[248:251]
 v_add_f32 v37, v45, v47
 v_sub_f32 v44, v44, v46
 v_sub_f32 v45, v45, v47
 v_mfma_f32_16x16x32_bf16 a[8:11], a[148:151], a[248:251], a[8:11]
 buffer_load_dwordx4 a[136:139], v1, s[20:23], s49 offen offset:2048
 v_fma_f32 v38, 0.5, v28, v30
 v_fma_f32 v39, 0.5, v29, v31
 v_mfma_f32_16x16x32_bf16 a[24:27], a[152:155], a[248:251], a[24:27]
 v_fma_f32 v30, -0.5, v28, v30
 v_fma_f32 v31, -0.5, v29, v31
 v_cvt_pk_bf16_f32 v14, v36, v37
 v_cvt_pk_bf16_f32 v18, v44, v45
 v_mfma_f32_16x16x32_bf16 a[40:43], a[156:159], a[248:251], a[40:43]
 ds_read_b128 a[248:251], v7 offset:14336
 v_cvt_pk_bf16_f32 v22, v38, v39
 v_cvt_pk_bf16_f32 v26, v30, v31
 s_waitcnt lgkmcnt(3)
 v_mfma_f32_16x16x32_bf16 a[56:59], a[144:147], a[252:255], a[56:59]
 v_lshlrev_b32 v32, 16, v79
 v_and_b32 v33, s34, v79
 v_lshlrev_b32 v34, 16, v83
 v_and_b32 v35, s34, v83
 v_mfma_f32_16x16x32_bf16 a[72:75], a[148:151], a[252:255], a[72:75]
 buffer_load_dwordx4 a[140:143], v1, s[20:23], s49 offen offset:3072
 v_lshlrev_b32 v64, 16, v87
 v_and_b32 v65, s34, v87
 v_mfma_f32_16x16x32_bf16 a[88:91], a[152:155], a[252:255], a[88:91]
 v_lshlrev_b32 v66, 16, v91
 v_and_b32 v67, s34, v91
 v_mfma_f32_16x16x32_bf16 a[104:107], a[156:159], a[252:255], a[104:107]
 ds_read_b128 a[252:255], v7 offset:15360
 buffer_load_dwordx4 v[76:79], v2, s[16:19], s54 offen offset:2048
 s_waitcnt lgkmcnt(3)
 v_mfma_f32_16x16x32_bf16 v[124:127], a[160:163], a[240:243], v[124:127]
 v_mfma_f32_16x16x32_bf16 v[140:143], a[164:167], a[240:243], v[140:143]
 buffer_load_dwordx4 a[144:147], v1, s[20:23], s50 offen offset:0
 v_fma_f32 v56, s39, v34, v66
 v_fma_f32 v57, s39, v35, v67
 v_mfma_f32_16x16x32_bf16 v[156:159], a[168:171], a[240:243], v[156:159]
 v_fma_f32 v58, s39, v32, v64
 v_fma_f32 v59, s39, v33, v65
 v_fma_f32 v34, s40, v34, v66
 v_mfma_f32_16x16x32_bf16 v[172:175], a[172:175], a[240:243], v[172:175]
 ds_read_b128 a[240:243], v7 offset:16384
 v_fma_f32 v35, s40, v35, v67
 v_fma_f32 v32, s40, v32, v64
 v_fma_f32 v33, s40, v33, v65
 s_waitcnt lgkmcnt(3)
 v_mfma_f32_16x16x32_bf16 v[188:191], a[160:163], a[244:247], v[188:191]
 v_add_f32 v56, v56, v42
 v_add_f32 v57, v57, v43
 v_add_f32 v58, v58, v40
 v_add_f32 v59, v59, v41
 v_mfma_f32_16x16x32_bf16 v[204:207], a[164:167], a[244:247], v[204:207]
 buffer_load_dwordx4 a[148:151], v1, s[20:23], s50 offen offset:1024
 v_fmac_f32 v34, 4.0, v42
 v_mfma_f32_16x16x32_bf16 v[220:223], a[168:171], a[244:247], v[220:223]
 v_fmac_f32 v35, 4.0, v43
 v_fmac_f32 v32, 4.0, v40
 v_fmac_f32 v33, 4.0, v41
 v_add_f32 v40, v56, v58
 v_mfma_f32_16x16x32_bf16 v[236:239], a[172:175], a[244:247], v[236:239]
 ds_read_b128 a[244:247], v7 offset:17408
 buffer_load_dwordx4 v[80:83], v2, s[16:19], s55 offen offset:0
 v_add_f32 v41, v57, v59
 v_sub_f32 v56, v56, v58
 v_sub_f32 v57, v57, v59
 s_waitcnt lgkmcnt(3)
 v_mfma_f32_16x16x32_bf16 v[252:255], a[160:163], a[248:251], v[252:255]
 v_fma_f32 v42, 0.5, v32, v34
 v_fma_f32 v43, 0.5, v33, v35
 v_fma_f32 v34, -0.5, v32, v34
 v_fma_f32 v35, -0.5, v33, v35
 v_mfma_f32_16x16x32_bf16 a[12:15], a[164:167], a[248:251], a[12:15]
 buffer_load_dwordx4 a[152:155], v1, s[20:23], s50 offen offset:2048
 v_cvt_pk_bf16_f32 v15, v40, v41
 v_mfma_f32_16x16x32_bf16 a[28:31], a[168:171], a[248:251], a[28:31]
 v_cvt_pk_bf16_f32 v19, v56, v57
 v_cvt_pk_bf16_f32 v23, v42, v43
 v_cvt_pk_bf16_f32 v27, v34, v35
 s_waitcnt vmcnt(19)
 v_lshlrev_b32 v36, 16, v92
 v_mfma_f32_16x16x32_bf16 a[44:47], a[172:175], a[248:251], a[44:47]
 ds_read_b128 a[248:251], v7 offset:18432
 ds_write_b128 v8, v[12:15] offset:0
 s_waitcnt lgkmcnt(4)
 v_mfma_f32_16x16x32_bf16 a[60:63], a[160:163], a[252:255], a[60:63]
 v_and_b32 v37, s34, v92
 v_lshlrev_b32 v38, 16, v96
 v_mfma_f32_16x16x32_bf16 a[76:79], a[164:167], a[252:255], a[76:79]
 buffer_load_dwordx4 a[156:159], v1, s[20:23], s50 offen offset:3072
 v_and_b32 v39, s34, v96
 v_lshlrev_b32 v44, 16, v100
 v_mfma_f32_16x16x32_bf16 a[92:95], a[168:171], a[252:255], a[92:95]
 v_and_b32 v45, s34, v100
 v_lshlrev_b32 v46, 16, v104
 v_and_b32 v47, s34, v104
 v_mfma_f32_16x16x32_bf16 a[108:111], a[172:175], a[252:255], a[108:111]
 ds_read_b128 a[252:255], v7 offset:19456
 buffer_load_dwordx4 v[84:87], v2, s[16:19], s55 offen offset:2048
 ds_write_b128 v8, v[16:19] offset:4096
 s_waitcnt lgkmcnt(5)
 v_mfma_f32_16x16x32_bf16 v[112:115], a[176:179], a[240:243], v[112:115]
 v_fma_f32 v28, s39, v38, v46
 v_fma_f32 v29, s39, v39, v47
 v_fma_f32 v30, s39, v36, v44
 v_mfma_f32_16x16x32_bf16 v[128:131], a[180:183], a[240:243], v[128:131]
 buffer_load_dwordx4 a[160:163], v1, s[20:23], s51 offen offset:0
 v_fma_f32 v31, s39, v37, v45
 v_fma_f32 v38, s40, v38, v46
 v_mfma_f32_16x16x32_bf16 v[144:147], a[184:187], a[240:243], v[144:147]
 v_fma_f32 v39, s40, v39, v47
 v_fma_f32 v36, s40, v36, v44
 v_mfma_f32_16x16x32_bf16 v[160:163], a[188:191], a[240:243], v[160:163]
 ds_read_b128 a[240:243], v7 offset:20480
 ds_write_b128 v8, v[20:23] offset:8192
 s_waitcnt lgkmcnt(6)
 v_mfma_f32_16x16x32_bf16 v[176:179], a[176:179], a[244:247], v[176:179]
 v_fma_f32 v37, s40, v37, v45
 v_add_f32 v28, v28, v50
 v_add_f32 v29, v29, v51
 v_add_f32 v30, v30, v48
 v_mfma_f32_16x16x32_bf16 v[192:195], a[180:183], a[244:247], v[192:195]
 buffer_load_dwordx4 a[164:167], v1, s[20:23], s51 offen offset:1024
 v_add_f32 v31, v31, v49
 v_fmac_f32 v38, 4.0, v50
 v_mfma_f32_16x16x32_bf16 v[208:211], a[184:187], a[244:247], v[208:211]
 v_fmac_f32 v39, 4.0, v51
 ds_write_b128 v8, v[24:27] offset:12288
 v_mfma_f32_16x16x32_bf16 v[224:227], a[188:191], a[244:247], v[224:227]
 ds_read_b128 a[244:247], v7 offset:21504
 buffer_load_dwordx4 v[88:91], v2, s[16:19], s56 offen offset:0
 v_fmac_f32 v36, 4.0, v48
 s_waitcnt lgkmcnt(7)
 v_mfma_f32_16x16x32_bf16 v[240:243], a[176:179], a[248:251], v[240:243]
 v_fmac_f32 v37, 4.0, v49
 v_add_f32 v48, v28, v30
 v_add_f32 v49, v29, v31
 v_sub_f32 v28, v28, v30
 v_mfma_f32_16x16x32_bf16 a[0:3], a[180:183], a[248:251], a[0:3]
 buffer_load_dwordx4 a[168:171], v1, s[20:23], s51 offen offset:2048
 v_sub_f32 v29, v29, v31
 v_fma_f32 v50, 0.5, v36, v38
 v_mfma_f32_16x16x32_bf16 a[16:19], a[184:187], a[248:251], a[16:19]
 v_fma_f32 v51, 0.5, v37, v39
 v_fma_f32 v38, -0.5, v36, v38
 v_fma_f32 v39, -0.5, v37, v39
 v_mfma_f32_16x16x32_bf16 a[32:35], a[188:191], a[248:251], a[32:35]
 ds_read_b128 a[248:251], v7 offset:22528
 v_cvt_pk_bf16_f32 v12, v48, v49
 v_cvt_pk_bf16_f32 v16, v28, v29
 v_cvt_pk_bf16_f32 v20, v50, v51
 s_waitcnt lgkmcnt(6)
 v_mfma_f32_16x16x32_bf16 a[48:51], a[176:179], a[252:255], a[48:51]
 v_cvt_pk_bf16_f32 v24, v38, v39
 v_lshlrev_b32 v40, 16, v93
 v_and_b32 v41, s34, v93
 v_lshlrev_b32 v42, 16, v97
 v_mfma_f32_16x16x32_bf16 a[64:67], a[180:183], a[252:255], a[64:67]
 buffer_load_dwordx4 a[172:175], v1, s[20:23], s51 offen offset:3072
 v_and_b32 v43, s34, v97
 v_mfma_f32_16x16x32_bf16 a[80:83], a[184:187], a[252:255], a[80:83]
 v_lshlrev_b32 v56, 16, v101
 v_and_b32 v57, s34, v101
 v_lshlrev_b32 v58, 16, v105
 v_and_b32 v59, s34, v105
 v_mfma_f32_16x16x32_bf16 a[96:99], a[188:191], a[252:255], a[96:99]
 ds_read_b128 a[252:255], v7 offset:23552
 v_fma_f32 v32, s39, v42, v58
 v_fma_f32 v33, s39, v43, v59
 v_fma_f32 v34, s39, v40, v56
 s_waitcnt lgkmcnt(5)
 v_mfma_f32_16x16x32_bf16 v[116:119], a[192:195], a[240:243], v[116:119]
 v_fma_f32 v35, s39, v41, v57
 v_fma_f32 v42, s40, v42, v58
 v_fma_f32 v43, s40, v43, v59
 v_mfma_f32_16x16x32_bf16 v[132:135], a[196:199], a[240:243], v[132:135]
 buffer_load_dwordx4 a[176:179], v1, s[20:23], s52 offen offset:0
 v_fma_f32 v40, s40, v40, v56
 v_fma_f32 v41, s40, v41, v57
 v_mfma_f32_16x16x32_bf16 v[148:151], a[200:203], a[240:243], v[148:151]
 v_add_f32 v32, v32, v62
 v_add_f32 v33, v33, v63
 v_add_f32 v34, v34, v60
 v_add_f32 v35, v35, v61
 v_mfma_f32_16x16x32_bf16 v[164:167], a[204:207], a[240:243], v[164:167]
 ds_read_b128 a[240:243], v7 offset:24576
 v_fmac_f32 v42, 4.0, v62
 v_fmac_f32 v43, 4.0, v63
 v_fmac_f32 v40, 4.0, v60
 s_waitcnt lgkmcnt(3)
 v_mfma_f32_16x16x32_bf16 v[180:183], a[192:195], a[244:247], v[180:183]
 v_fmac_f32 v41, 4.0, v61
 v_add_f32 v60, v32, v34
 v_add_f32 v61, v33, v35
 v_mfma_f32_16x16x32_bf16 v[196:199], a[196:199], a[244:247], v[196:199]
 buffer_load_dwordx4 a[180:183], v1, s[20:23], s52 offen offset:1024
 v_sub_f32 v32, v32, v34
 v_sub_f32 v33, v33, v35
 v_mfma_f32_16x16x32_bf16 v[212:215], a[200:203], a[244:247], v[212:215]
 v_fma_f32 v62, 0.5, v40, v42
 v_fma_f32 v63, 0.5, v41, v43
 v_fma_f32 v42, -0.5, v40, v42
 v_fma_f32 v43, -0.5, v41, v43
 v_mfma_f32_16x16x32_bf16 v[228:231], a[204:207], a[244:247], v[228:231]
 ds_read_b128 a[244:247], v7 offset:25600
 v_cvt_pk_bf16_f32 v13, v60, v61
 v_cvt_pk_bf16_f32 v17, v32, v33
 s_waitcnt lgkmcnt(3)
 v_mfma_f32_16x16x32_bf16 v[244:247], a[192:195], a[248:251], v[244:247]
 v_cvt_pk_bf16_f32 v21, v62, v63
 v_cvt_pk_bf16_f32 v25, v42, v43
 v_lshlrev_b32 v48, 16, v94
 v_and_b32 v49, s34, v94
 v_mfma_f32_16x16x32_bf16 a[4:7], a[196:199], a[248:251], a[4:7]
 buffer_load_dwordx4 a[184:187], v1, s[20:23], s52 offen offset:2048
 v_lshlrev_b32 v50, 16, v98
 v_and_b32 v51, s34, v98
 v_mfma_f32_16x16x32_bf16 a[20:23], a[200:203], a[248:251], a[20:23]
 v_lshlrev_b32 v28, 16, v102
 v_and_b32 v29, s34, v102
 v_lshlrev_b32 v30, 16, v106
 v_mfma_f32_16x16x32_bf16 a[36:39], a[204:207], a[248:251], a[36:39]
 ds_read_b128 a[248:251], v7 offset:26624
 v_and_b32 v31, s34, v106
 v_fma_f32 v36, s39, v50, v30
 v_fma_f32 v37, s39, v51, v31
 s_waitcnt lgkmcnt(3)
 v_mfma_f32_16x16x32_bf16 a[52:55], a[192:195], a[252:255], a[52:55]
 v_fma_f32 v38, s39, v48, v28
 v_fma_f32 v39, s39, v49, v29
 v_fma_f32 v50, s40, v50, v30
 v_fma_f32 v51, s40, v51, v31
 v_mfma_f32_16x16x32_bf16 a[68:71], a[196:199], a[252:255], a[68:71]
 buffer_load_dwordx4 a[188:191], v1, s[20:23], s52 offen offset:3072
 v_fma_f32 v48, s40, v48, v28
 v_fma_f32 v49, s40, v49, v29
 v_mfma_f32_16x16x32_bf16 a[84:87], a[200:203], a[252:255], a[84:87]
 v_add_f32 v36, v36, v54
 v_add_f32 v37, v37, v55
 v_add_f32 v38, v38, v52
 v_mfma_f32_16x16x32_bf16 a[100:103], a[204:207], a[252:255], a[100:103]
 ds_read_b128 a[252:255], v7 offset:27648
 v_add_f32 v39, v39, v53
 v_fmac_f32 v50, 4.0, v54
 v_fmac_f32 v51, 4.0, v55
 s_waitcnt lgkmcnt(3)
 v_mfma_f32_16x16x32_bf16 v[120:123], a[208:211], a[240:243], v[120:123]
 v_fmac_f32 v48, 4.0, v52
 v_fmac_f32 v49, 4.0, v53
 v_add_f32 v52, v36, v38
 v_add_f32 v53, v37, v39
 v_mfma_f32_16x16x32_bf16 v[136:139], a[212:215], a[240:243], v[136:139]
 buffer_load_dwordx4 a[192:195], v1, s[20:23], s53 offen offset:0
 v_sub_f32 v36, v36, v38
 v_mfma_f32_16x16x32_bf16 v[152:155], a[216:219], a[240:243], v[152:155]
 v_sub_f32 v37, v37, v39
 v_fma_f32 v54, 0.5, v48, v50
 v_fma_f32 v55, 0.5, v49, v51
 v_fma_f32 v50, -0.5, v48, v50
 v_mfma_f32_16x16x32_bf16 v[168:171], a[220:223], a[240:243], v[168:171]
 ds_read_b128 a[240:243], v7 offset:28672
 v_fma_f32 v51, -0.5, v49, v51
 v_cvt_pk_bf16_f32 v14, v52, v53
 v_cvt_pk_bf16_f32 v18, v36, v37
 s_waitcnt lgkmcnt(3)
 v_mfma_f32_16x16x32_bf16 v[184:187], a[208:211], a[244:247], v[184:187]
 v_cvt_pk_bf16_f32 v22, v54, v55
 v_cvt_pk_bf16_f32 v26, v50, v51
 v_lshlrev_b32 v60, 16, v95
 v_and_b32 v61, s34, v95
 v_mfma_f32_16x16x32_bf16 v[200:203], a[212:215], a[244:247], v[200:203]
 buffer_load_dwordx4 a[196:199], v1, s[20:23], s53 offen offset:1024
 v_lshlrev_b32 v62, 16, v99
 v_mfma_f32_16x16x32_bf16 v[216:219], a[216:219], a[244:247], v[216:219]
 v_and_b32 v63, s34, v99
 v_lshlrev_b32 v32, 16, v103
 v_and_b32 v33, s34, v103
 v_lshlrev_b32 v34, 16, v107
 v_mfma_f32_16x16x32_bf16 v[232:235], a[220:223], a[244:247], v[232:235]
 ds_read_b128 a[244:247], v7 offset:29696
 v_and_b32 v35, s34, v107
 s_waitcnt lgkmcnt(3)
 v_mfma_f32_16x16x32_bf16 v[248:251], a[208:211], a[248:251], v[248:251]
 v_fma_f32 v40, s39, v62, v34
 v_mfma_f32_16x16x32_bf16 a[8:11], a[212:215], a[248:251], a[8:11]
 buffer_load_dwordx4 a[200:203], v1, s[20:23], s53 offen offset:2048
 v_fma_f32 v41, s39, v63, v35
 v_fma_f32 v42, s39, v60, v32
 v_mfma_f32_16x16x32_bf16 a[24:27], a[216:219], a[248:251], a[24:27]
 v_fma_f32 v43, s39, v61, v33
 v_fma_f32 v62, s40, v62, v34
 v_fma_f32 v63, s40, v63, v35
 v_fma_f32 v60, s40, v60, v32
 v_mfma_f32_16x16x32_bf16 a[40:43], a[220:223], a[248:251], a[40:43]
 ds_read_b128 a[248:251], v7 offset:30720
 buffer_load_dwordx4 v[92:95], v2, s[16:19], s56 offen offset:2048
 v_fma_f32 v61, s40, v61, v33
 v_add_f32 v40, v40, v66
 s_waitcnt lgkmcnt(3)
 v_mfma_f32_16x16x32_bf16 a[56:59], a[208:211], a[252:255], a[56:59]
 v_add_f32 v41, v41, v67
 v_add_f32 v42, v42, v64
 v_add_f32 v43, v43, v65
 v_fmac_f32 v62, 4.0, v66
 v_mfma_f32_16x16x32_bf16 a[72:75], a[212:215], a[252:255], a[72:75]
 buffer_load_dwordx4 a[204:207], v1, s[20:23], s53 offen offset:3072
 v_fmac_f32 v63, 4.0, v67
 v_fmac_f32 v60, 4.0, v64
 v_mfma_f32_16x16x32_bf16 a[88:91], a[216:219], a[252:255], a[88:91]
 v_fmac_f32 v61, 4.0, v65
 v_add_f32 v64, v40, v42
 v_add_f32 v65, v41, v43
 v_sub_f32 v40, v40, v42
 v_mfma_f32_16x16x32_bf16 a[104:107], a[220:223], a[252:255], a[104:107]
 ds_read_b128 a[252:255], v7 offset:31744
 v_sub_f32 v41, v41, v43
 v_fma_f32 v66, 0.5, v60, v62
 s_waitcnt vmcnt(30) lgkmcnt(3)
 v_mfma_f32_16x16x32_bf16 v[124:127], a[224:227], a[240:243], v[124:127]
 v_fma_f32 v67, 0.5, v61, v63
 v_fma_f32 v62, -0.5, v60, v62
 v_fma_f32 v63, -0.5, v61, v63
 v_cvt_pk_bf16_f32 v15, v64, v65
 v_mfma_f32_16x16x32_bf16 v[140:143], a[228:231], a[240:243], v[140:143]
 buffer_load_dwordx4 a[208:211], v1, s[20:23], s54 offen offset:0
 v_cvt_pk_bf16_f32 v19, v40, v41
 v_cvt_pk_bf16_f32 v23, v66, v67
 v_mfma_f32_16x16x32_bf16 v[156:159], a[232:235], a[240:243], v[156:159]
 v_cvt_pk_bf16_f32 v27, v62, v63
 s_waitcnt vmcnt(18)
 v_lshlrev_b32 v52, 16, v68
 v_and_b32 v53, s34, v68
 v_mfma_f32_16x16x32_bf16 v[172:175], a[236:239], a[240:243], v[172:175]
 ds_read_b128 a[240:243], v7 offset:32768
 buffer_load_dwordx4 v[96:99], v2, s[16:19], s57 offen offset:0
 v_lshlrev_b32 v54, 16, v72
 v_and_b32 v55, s34, v72
 s_waitcnt lgkmcnt(3)
 v_mfma_f32_16x16x32_bf16 v[188:191], a[224:227], a[244:247], v[188:191]
 ds_write_b128 v8, v[12:15] offset:1024
 v_lshlrev_b32 v36, 16, v76
 v_mfma_f32_16x16x32_bf16 v[204:207], a[228:231], a[244:247], v[204:207]
 buffer_load_dwordx4 a[212:215], v1, s[20:23], s54 offen offset:1024
 v_and_b32 v37, s34, v76
 v_mfma_f32_16x16x32_bf16 v[220:223], a[232:235], a[244:247], v[220:223]
 v_lshlrev_b32 v38, 16, v80
 v_and_b32 v39, s34, v80
 v_fma_f32 v48, s39, v54, v38
 v_fma_f32 v49, s39, v55, v39
 v_mfma_f32_16x16x32_bf16 v[236:239], a[236:239], a[244:247], v[236:239]
 ds_read_b128 a[244:247], v7 offset:33792
 v_fma_f32 v50, s39, v52, v36
 s_waitcnt lgkmcnt(4)
 v_mfma_f32_16x16x32_bf16 v[252:255], a[224:227], a[248:251], v[252:255]
 ds_write_b128 v8, v[16:19] offset:5120
 v_fma_f32 v51, s39, v53, v37
 v_fma_f32 v54, s40, v54, v38
 v_mfma_f32_16x16x32_bf16 a[12:15], a[228:231], a[248:251], a[12:15]
 buffer_load_dwordx4 a[216:219], v1, s[20:23], s54 offen offset:2048
 v_fma_f32 v55, s40, v55, v39
 v_mfma_f32_16x16x32_bf16 a[28:31], a[232:235], a[248:251], a[28:31]
 v_fma_f32 v52, s40, v52, v36
 v_fma_f32 v53, s40, v53, v37
 v_add_f32 v48, v48, v46
 v_add_f32 v49, v49, v47
 v_mfma_f32_16x16x32_bf16 a[44:47], a[236:239], a[248:251], a[44:47]
 ds_read_b128 a[248:251], v7 offset:34816
 ds_write_b128 v8, v[20:23] offset:9216
 s_waitcnt lgkmcnt(6)
 v_mfma_f32_16x16x32_bf16 a[60:63], a[224:227], a[252:255], a[60:63]
 v_add_f32 v50, v50, v44
 v_add_f32 v51, v51, v45
 v_mfma_f32_16x16x32_bf16 a[76:79], a[228:231], a[252:255], a[76:79]
 buffer_load_dwordx4 a[220:223], v1, s[20:23], s54 offen offset:3072
 v_fmac_f32 v54, 4.0, v46
 v_fmac_f32 v55, 4.0, v47
 v_mfma_f32_16x16x32_bf16 a[92:95], a[232:235], a[252:255], a[92:95]
 v_fmac_f32 v52, 4.0, v44
 v_fmac_f32 v53, 4.0, v45
 v_add_f32 v44, v48, v50
 v_mfma_f32_16x16x32_bf16 a[108:111], a[236:239], a[252:255], a[108:111]
 ds_read_b128 a[252:255], v7 offset:35840
 ds_write_b128 v8, v[24:27] offset:13312
 s_waitcnt lgkmcnt(7)
 v_mfma_f32_16x16x32_bf16 v[112:115], a[112:115], a[240:243], v[112:115]
 v_add_f32 v45, v49, v51
 v_sub_f32 v48, v48, v50
 v_sub_f32 v49, v49, v51
 v_mfma_f32_16x16x32_bf16 v[128:131], a[116:119], a[240:243], v[128:131]
 buffer_load_dwordx4 a[224:227], v1, s[20:23], s55 offen offset:0
 v_fma_f32 v46, 0.5, v52, v54
 v_fma_f32 v47, 0.5, v53, v55
 v_mfma_f32_16x16x32_bf16 v[144:147], a[120:123], a[240:243], v[144:147]
 v_fma_f32 v54, -0.5, v52, v54
 v_fma_f32 v55, -0.5, v53, v55
 v_cvt_pk_bf16_f32 v12, v44, v45
 v_cvt_pk_bf16_f32 v16, v48, v49
 v_mfma_f32_16x16x32_bf16 v[160:163], a[124:127], a[240:243], v[160:163]
 ds_read_b128 a[240:243], v7 offset:36864
 v_cvt_pk_bf16_f32 v20, v46, v47
 v_cvt_pk_bf16_f32 v24, v54, v55
 s_waitcnt lgkmcnt(6)
 v_mfma_f32_16x16x32_bf16 v[176:179], a[112:115], a[244:247], v[176:179]
 v_lshlrev_b32 v64, 16, v69
 v_and_b32 v65, s34, v69
 v_lshlrev_b32 v66, 16, v73
 v_and_b32 v67, s34, v73
 v_mfma_f32_16x16x32_bf16 v[192:195], a[116:119], a[244:247], v[192:195]
 buffer_load_dwordx4 a[228:231], v1, s[20:23], s55 offen offset:1024
 v_lshlrev_b32 v40, 16, v77
 v_and_b32 v41, s34, v77
 v_mfma_f32_16x16x32_bf16 v[208:211], a[120:123], a[244:247], v[208:211]
 v_lshlrev_b32 v42, 16, v81
 v_and_b32 v43, s34, v81
 v_fma_f32 v60, s39, v66, v42
 v_mfma_f32_16x16x32_bf16 v[224:227], a[124:127], a[244:247], v[224:227]
 ds_read_b128 a[244:247], v7 offset:37888
 v_fma_f32 v61, s39, v67, v43
 v_fma_f32 v62, s39, v64, v40
 v_fma_f32 v63, s39, v65, v41
 s_waitcnt lgkmcnt(5)
 v_mfma_f32_16x16x32_bf16 v[240:243], a[112:115], a[248:251], v[240:243]
 v_fma_f32 v66, s40, v66, v42
 v_fma_f32 v67, s40, v67, v43
 v_fma_f32 v64, s40, v64, v40
 v_fma_f32 v65, s40, v65, v41
 v_mfma_f32_16x16x32_bf16 a[0:3], a[116:119], a[248:251], a[0:3]
 buffer_load_dwordx4 a[232:235], v1, s[20:23], s55 offen offset:2048
 v_add_f32 v60, v60, v58
 v_add_f32 v61, v61, v59
 v_mfma_f32_16x16x32_bf16 a[16:19], a[120:123], a[248:251], a[16:19]
 v_add_f32 v62, v62, v56
 v_add_f32 v63, v63, v57
 v_fmac_f32 v66, 4.0, v58
 v_mfma_f32_16x16x32_bf16 a[32:35], a[124:127], a[248:251], a[32:35]
 ds_read_b128 a[248:251], v7 offset:38912
 v_fmac_f32 v67, 4.0, v59
 v_fmac_f32 v64, 4.0, v56
 v_fmac_f32 v65, 4.0, v57
 s_waitcnt lgkmcnt(4)
 v_mfma_f32_16x16x32_bf16 a[48:51], a[112:115], a[252:255], a[48:51]
 v_add_f32 v56, v60, v62
 v_add_f32 v57, v61, v63
 v_sub_f32 v60, v60, v62
 v_sub_f32 v61, v61, v63
 v_mfma_f32_16x16x32_bf16 a[64:67], a[116:119], a[252:255], a[64:67]
 buffer_load_dwordx4 a[236:239], v1, s[20:23], s55 offen offset:3072
 v_fma_f32 v58, 0.5, v64, v66
 v_mfma_f32_16x16x32_bf16 a[80:83], a[120:123], a[252:255], a[80:83]
 v_fma_f32 v59, 0.5, v65, v67
 v_fma_f32 v66, -0.5, v64, v66
 v_fma_f32 v67, -0.5, v65, v67
 v_cvt_pk_bf16_f32 v13, v56, v57
 v_mfma_f32_16x16x32_bf16 a[96:99], a[124:127], a[252:255], a[96:99]
 ds_read_b128 a[252:255], v7 offset:39936
 v_cvt_pk_bf16_f32 v17, v60, v61
 v_cvt_pk_bf16_f32 v21, v58, v59
 v_cvt_pk_bf16_f32 v25, v66, v67
 s_waitcnt lgkmcnt(3)
 v_mfma_f32_16x16x32_bf16 v[116:119], a[128:131], a[240:243], v[116:119]
 v_lshlrev_b32 v44, 16, v70
 v_and_b32 v45, s34, v70
 v_lshlrev_b32 v46, 16, v74
 v_mfma_f32_16x16x32_bf16 v[132:135], a[132:135], a[240:243], v[132:135]
 s_cmp_eq_u32 s31, 7
 s_cselect_b32 s36, s84, s56
 s_cselect_b32 s37, -1, 0
 s_add_u32 s20, s20, s36
 s_addc_u32 s21, s21, s37
 buffer_load_dwordx4 a[112:115], v1, s[20:23], s48 offen offset:0
 v_mfma_f32_16x16x32_bf16 v[148:151], a[136:139], a[240:243], v[148:151]
 v_and_b32 v47, s34, v74
 v_lshlrev_b32 v48, 16, v78
 v_and_b32 v49, s34, v78
 v_lshlrev_b32 v50, 16, v82
 v_mfma_f32_16x16x32_bf16 v[164:167], a[140:143], a[240:243], v[164:167]
 ds_read_b128 a[240:243], v7 offset:40960
 v_and_b32 v51, s34, v82
 v_fma_f32 v52, s39, v46, v50
 v_fma_f32 v53, s39, v47, v51
 s_waitcnt lgkmcnt(3)
 v_mfma_f32_16x16x32_bf16 v[180:183], a[128:131], a[244:247], v[180:183]
 v_fma_f32 v54, s39, v44, v48
 v_fma_f32 v55, s39, v45, v49
 v_fma_f32 v46, s40, v46, v50
 v_fma_f32 v47, s40, v47, v51
 v_mfma_f32_16x16x32_bf16 v[196:199], a[132:135], a[244:247], v[196:199]
 buffer_load_dwordx4 a[116:119], v1, s[20:23], s48 offen offset:1024
 v_fma_f32 v44, s40, v44, v48
 v_mfma_f32_16x16x32_bf16 v[212:215], a[136:139], a[244:247], v[212:215]
 v_fma_f32 v45, s40, v45, v49
 v_add_f32 v52, v52, v30
 v_add_f32 v53, v53, v31
 v_add_f32 v54, v54, v28
 v_mfma_f32_16x16x32_bf16 v[228:231], a[140:143], a[244:247], v[228:231]
 ds_read_b128 a[244:247], v7 offset:41984
 v_add_f32 v55, v55, v29
 v_fmac_f32 v46, 4.0, v30
 v_fmac_f32 v47, 4.0, v31
 s_waitcnt lgkmcnt(3)
 v_mfma_f32_16x16x32_bf16 v[244:247], a[128:131], a[248:251], v[244:247]
 v_fmac_f32 v44, 4.0, v28
 v_fmac_f32 v45, 4.0, v29
 v_add_f32 v28, v52, v54
 v_mfma_f32_16x16x32_bf16 a[4:7], a[132:135], a[248:251], a[4:7]
 buffer_load_dwordx4 a[120:123], v1, s[20:23], s48 offen offset:2048
 v_add_f32 v29, v53, v55
 v_sub_f32 v52, v52, v54
 v_mfma_f32_16x16x32_bf16 a[20:23], a[136:139], a[248:251], a[20:23]
 v_sub_f32 v53, v53, v55
 v_fma_f32 v30, 0.5, v44, v46
 v_fma_f32 v31, 0.5, v45, v47
 v_fma_f32 v46, -0.5, v44, v46
 v_mfma_f32_16x16x32_bf16 a[36:39], a[140:143], a[248:251], a[36:39]
 ds_read_b128 a[248:251], v7 offset:43008
 v_fma_f32 v47, -0.5, v45, v47
 v_cvt_pk_bf16_f32 v14, v28, v29
 s_waitcnt lgkmcnt(3)
 v_mfma_f32_16x16x32_bf16 a[52:55], a[128:131], a[252:255], a[52:55]
 v_cvt_pk_bf16_f32 v18, v52, v53
 v_cvt_pk_bf16_f32 v22, v30, v31
 v_cvt_pk_bf16_f32 v26, v46, v47
 v_lshlrev_b32 v56, 16, v71
 v_mfma_f32_16x16x32_bf16 a[68:71], a[132:135], a[252:255], a[68:71]
 buffer_load_dwordx4 a[124:127], v1, s[20:23], s48 offen offset:3072
 v_and_b32 v57, s34, v71
 v_lshlrev_b32 v58, 16, v75
 v_mfma_f32_16x16x32_bf16 a[84:87], a[136:139], a[252:255], a[84:87]
 v_and_b32 v59, s34, v75
 v_lshlrev_b32 v60, 16, v79
 v_and_b32 v61, s34, v79
 v_lshlrev_b32 v62, 16, v83
 v_mfma_f32_16x16x32_bf16 a[100:103], a[140:143], a[252:255], a[100:103]
 ds_read_b128 a[252:255], v7 offset:44032
 v_and_b32 v63, s34, v83
 s_waitcnt vmcnt(28) lgkmcnt(3)
 v_mfma_f32_16x16x32_bf16 v[120:123], a[144:147], a[240:243], v[120:123]
 v_mfma_f32_16x16x32_bf16 v[136:139], a[148:151], a[240:243], v[136:139]
 buffer_load_dwordx4 a[128:131], v1, s[20:23], s49 offen offset:0
 v_mfma_f32_16x16x32_bf16 v[152:155], a[152:155], a[240:243], v[152:155]
 v_mfma_f32_16x16x32_bf16 v[168:171], a[156:159], a[240:243], v[168:171]
 ds_read_b128 a[240:243], v7 offset:45056
 s_add_u32 s32, s32, 1
 s_and_b32 s44, s32, 3
 s_cmp_eq_u32 s44, 0
 s_cselect_b32 s38, s47, s58
 v_add_u32 v2, s38, v2
 v_add_u32 v3, s38, v3
 s_cmp_lg_u32 s32, 8
 s_cbranch_scc1 LS3_a
 s_mov_b32 s32, 0
 v_mov_b32 v2, v5
 v_mov_b32 v3, v6
LS3_a:
 s_cmp_lt_u32 s32, 4
 s_cselect_b32 s33, s59, 0
 v_mov_b32 v4, v2
 s_cbranch_scc1 LS3_b
 v_mov_b32 v4, v3
LS3_b:
 s_waitcnt lgkmcnt(3)
 v_mfma_f32_16x16x32_bf16 v[184:187], a[144:147], a[244:247], v[184:187]
 v_mfma_f32_16x16x32_bf16 v[200:203], a[148:151], a[244:247], v[200:203]
 buffer_load_dwordx4 a[132:135], v1, s[20:23], s49 offen offset:1024
 v_mfma_f32_16x16x32_bf16 v[216:219], a[152:155], a[244:247], v[216:219]
 v_mfma_f32_16x16x32_bf16 v[232:235], a[156:159], a[244:247], v[232:235]
 ds_read_b128 a[244:247], v7 offset:46080
 v_fma_f32 v64, s39, v58, v62
 v_fma_f32 v65, s39, v59, v63
 s_waitcnt lgkmcnt(3)
 v_mfma_f32_16x16x32_bf16 v[248:251], a[144:147], a[248:251], v[248:251]
 v_fma_f32 v66, s39, v56, v60
 v_fma_f32 v67, s39, v57, v61
 v_fma_f32 v58, s40, v58, v62
 v_fma_f32 v59, s40, v59, v63
 v_mfma_f32_16x16x32_bf16 a[8:11], a[148:151], a[248:251], a[8:11]
 buffer_load_dwordx4 a[136:139], v1, s[20:23], s49 offen offset:2048
 v_fma_f32 v56, s40, v56, v60
 v_mfma_f32_16x16x32_bf16 a[24:27], a[152:155], a[248:251], a[24:27]
 v_fma_f32 v57, s40, v57, v61
 v_add_f32 v64, v64, v34
 v_add_f32 v65, v65, v35
 v_add_f32 v66, v66, v32
 v_mfma_f32_16x16x32_bf16 a[40:43], a[156:159], a[248:251], a[40:43]
 ds_read_b128 a[248:251], v7 offset:47104
 buffer_load_dwordx4 v[68:71], v3, s[16:19], s33 offen offset:0
 v_add_f32 v67, v67, v33
 v_fmac_f32 v58, 4.0, v34
 v_fmac_f32 v59, 4.0, v35
 s_waitcnt lgkmcnt(3)
 v_mfma_f32_16x16x32_bf16 a[56:59], a[144:147], a[252:255], a[56:59]
 v_fmac_f32 v56, 4.0, v32
 v_fmac_f32 v57, 4.0, v33
 v_add_f32 v32, v64, v66
 v_mfma_f32_16x16x32_bf16 a[72:75], a[148:151], a[252:255], a[72:75]
 buffer_load_dwordx4 a[140:143], v1, s[20:23], s49 offen offset:3072
 v_add_f32 v33, v65, v67
 v_sub_f32 v64, v64, v66
 v_mfma_f32_16x16x32_bf16 a[88:91], a[152:155], a[252:255], a[88:91]
 v_sub_f32 v65, v65, v67
 v_fma_f32 v34, 0.5, v56, v58
 v_fma_f32 v35, 0.5, v57, v59
 v_fma_f32 v58, -0.5, v56, v58
 v_mfma_f32_16x16x32_bf16 a[104:107], a[156:159], a[252:255], a[104:107]
 ds_read_b128 a[252:255], v7 offset:48128
 v_fma_f32 v59, -0.5, v57, v59
 v_cvt_pk_bf16_f32 v15, v32, v33
 v_cvt_pk_bf16_f32 v19, v64, v65
 s_waitcnt vmcnt(27) lgkmcnt(3)
 v_mfma_f32_16x16x32_bf16 v[124:127], a[160:163], a[240:243], v[124:127]
 v_cvt_pk_bf16_f32 v23, v34, v35
 v_cvt_pk_bf16_f32 v27, v58, v59
 s_waitcnt vmcnt(16)
 v_lshlrev_b32 v28, 16, v84
 v_mfma_f32_16x16x32_bf16 v[140:143], a[164:167], a[240:243], v[140:143]
 buffer_load_dwordx4 a[144:147], v1, s[20:23], s50 offen offset:0
 v_and_b32 v29, s34, v84
 v_lshlrev_b32 v30, 16, v88
 v_mfma_f32_16x16x32_bf16 v[156:159], a[168:171], a[240:243], v[156:159]
 v_and_b32 v31, s34, v88
 v_lshlrev_b32 v52, 16, v92
 v_and_b32 v53, s34, v92
 v_lshlrev_b32 v54, 16, v96
 v_mfma_f32_16x16x32_bf16 v[172:175], a[172:175], a[240:243], v[172:175]
 ds_read_b128 a[240:243], v7 offset:49152
 buffer_load_dwordx4 v[72:75], v3, s[16:19], s33 offen offset:2048
 s_add_u32 s33, s33, 4096
 ds_write_b128 v8, v[12:15] offset:2048
 s_waitcnt lgkmcnt(4)
 v_mfma_f32_16x16x32_bf16 v[188:191], a[160:163], a[244:247], v[188:191]
 v_and_b32 v55, s34, v96
 v_fma_f32 v44, s39, v30, v54
 v_mfma_f32_16x16x32_bf16 v[204:207], a[164:167], a[244:247], v[204:207]
 buffer_load_dwordx4 a[148:151], v1, s[20:23], s50 offen offset:1024
 v_fma_f32 v45, s39, v31, v55
 v_fma_f32 v46, s39, v28, v52
 v_mfma_f32_16x16x32_bf16 v[220:223], a[168:171], a[244:247], v[220:223]
 v_fma_f32 v47, s39, v29, v53
 v_fma_f32 v30, s40, v30, v54
 v_fma_f32 v31, s40, v31, v55
 v_mfma_f32_16x16x32_bf16 v[236:239], a[172:175], a[244:247], v[236:239]
 ds_read_b128 a[244:247], v7 offset:50176
 ds_write_b128 v8, v[16:19] offset:6144
 s_waitcnt lgkmcnt(5)
 v_mfma_f32_16x16x32_bf16 v[252:255], a[160:163], a[248:251], v[252:255]
 v_fma_f32 v28, s40, v28, v52
 v_fma_f32 v29, s40, v29, v53
 v_add_f32 v44, v44, v38
 v_mfma_f32_16x16x32_bf16 a[12:15], a[164:167], a[248:251], a[12:15]
 buffer_load_dwordx4 a[152:155], v1, s[20:23], s50 offen offset:2048
 v_add_f32 v45, v45, v39
 v_add_f32 v46, v46, v36
 v_mfma_f32_16x16x32_bf16 a[28:31], a[168:171], a[248:251], a[28:31]
 v_add_f32 v47, v47, v37
 v_fmac_f32 v30, 4.0, v38
 v_mfma_f32_16x16x32_bf16 a[44:47], a[172:175], a[248:251], a[44:47]
 ds_read_b128 a[248:251], v7 offset:51200
 buffer_load_dwordx4 v[76:79], v3, s[16:19], s33 offen offset:0
 ds_write_b128 v8, v[20:23] offset:10240
 s_waitcnt lgkmcnt(6)
 v_mfma_f32_16x16x32_bf16 a[60:63], a[160:163], a[252:255], a[60:63]
 v_fmac_f32 v31, 4.0, v39
 v_fmac_f32 v28, 4.0, v36
 v_fmac_f32 v29, 4.0, v37
 v_add_f32 v36, v44, v46
 v_mfma_f32_16x16x32_bf16 a[76:79], a[164:167], a[252:255], a[76:79]
 buffer_load_dwordx4 a[156:159], v1, s[20:23], s50 offen offset:3072
 v_add_f32 v37, v45, v47
 v_mfma_f32_16x16x32_bf16 a[92:95], a[168:171], a[252:255], a[92:95]
 v_sub_f32 v44, v44, v46
 v_sub_f32 v45, v45, v47
 ds_write_b128 v8, v[24:27] offset:14336
 v_mfma_f32_16x16x32_bf16 a[108:111], a[172:175], a[252:255], a[108:111]
 ds_read_b128 a[252:255], v7 offset:52224
 v_fma_f32 v38, 0.5, v28, v30
 s_waitcnt lgkmcnt(7)
 v_mfma_f32_16x16x32_bf16 v[112:115], a[176:179], a[240:243], v[112:115]
 v_fma_f32 v39, 0.5, v29, v31
 v_fma_f32 v30, -0.5, v28, v30
 v_fma_f32 v31, -0.5, v29, v31
 v_cvt_pk_bf16_f32 v12, v36, v37
 v_mfma_f32_16x16x32_bf16 v[128:131], a[180:183], a[240:243], v[128:131]
 buffer_load_dwordx4 a[160:163], v1, s[20:23], s51 offen offset:0
 v_cvt_pk_bf16_f32 v16, v44, v45
 v_mfma_f32_16x16x32_bf16 v[144:147], a[184:187], a[240:243], v[144:147]
 v_cvt_pk_bf16_f32 v20, v38, v39
 v_cvt_pk_bf16_f32 v24, v30, v31
 v_lshlrev_b32 v32, 16, v85
 v_and_b32 v33, s34, v85
 v_mfma_f32_16x16x32_bf16 v[160:163], a[188:191], a[240:243], v[160:163]
 ds_read_b128 a[240:243], v7 offset:53248
 buffer_load_dwordx4 v[80:83], v4, s[16:19], s33 offen offset:2048
 s_add_u32 s33, s33, 4096
 v_lshlrev_b32 v34, 16, v89
 v_and_b32 v35, s34, v89
 v_lshlrev_b32 v64, 16, v93
 s_waitcnt lgkmcnt(6)
 v_mfma_f32_16x16x32_bf16 v[176:179], a[176:179], a[244:247], v[176:179]
 v_and_b32 v65, s34, v93
 v_lshlrev_b32 v66, 16, v97
 v_and_b32 v67, s34, v97
 v_mfma_f32_16x16x32_bf16 v[192:195], a[180:183], a[244:247], v[192:195]
 buffer_load_dwordx4 a[164:167], v1, s[20:23], s51 offen offset:1024
 v_fma_f32 v56, s39, v34, v66
 v_fma_f32 v57, s39, v35, v67
 v_mfma_f32_16x16x32_bf16 v[208:211], a[184:187], a[244:247], v[208:211]
 v_fma_f32 v58, s39, v32, v64
 v_fma_f32 v59, s39, v33, v65
 v_fma_f32 v34, s40, v34, v66
 v_fma_f32 v35, s40, v35, v67
 v_mfma_f32_16x16x32_bf16 v[224:227], a[188:191], a[244:247], v[224:227]
 ds_read_b128 a[244:247], v7 offset:54272
 v_fma_f32 v32, s40, v32, v64
 v_fma_f32 v33, s40, v33, v65
 s_waitcnt lgkmcnt(5)
 v_mfma_f32_16x16x32_bf16 v[240:243], a[176:179], a[248:251], v[240:243]
 v_add_f32 v56, v56, v42
 v_add_f32 v57, v57, v43
 v_add_f32 v58, v58, v40
 v_add_f32 v59, v59, v41
 v_mfma_f32_16x16x32_bf16 a[0:3], a[180:183], a[248:251], a[0:3]
 buffer_load_dwordx4 a[168:171], v1, s[20:23], s51 offen offset:2048
 v_fmac_f32 v34, 4.0, v42
 v_fmac_f32 v35, 4.0, v43
 v_mfma_f32_16x16x32_bf16 a[16:19], a[184:187], a[248:251], a[16:19]
 v_fmac_f32 v32, 4.0, v40
 v_fmac_f32 v33, 4.0, v41
 v_add_f32 v40, v56, v58
 v_add_f32 v41, v57, v59
 v_mfma_f32_16x16x32_bf16 a[32:35], a[188:191], a[248:251], a[32:35]
 ds_read_b128 a[248:251], v7 offset:55296
 v_sub_f32 v56, v56, v58
 v_sub_f32 v57, v57, v59
 s_waitcnt lgkmcnt(3)
 v_mfma_f32_16x16x32_bf16 a[48:51], a[176:179], a[252:255], a[48:51]
 v_fma_f32 v42, 0.5, v32, v34
 v_fma_f32 v43, 0.5, v33, v35
 v_fma_f32 v34, -0.5, v32, v34
 v_fma_f32 v35, -0.5, v33, v35
 v_mfma_f32_16x16x32_bf16 a[64:67], a[180:183], a[252:255], a[64:67]
 buffer_load_dwordx4 a[172:175], v1, s[20:23], s51 offen offset:3072
 v_cvt_pk_bf16_f32 v13, v40, v41
 v_cvt_pk_bf16_f32 v17, v56, v57
 v_mfma_f32_16x16x32_bf16 a[80:83], a[184:187], a[252:255], a[80:83]
 v_cvt_pk_bf16_f32 v21, v42, v43
 v_cvt_pk_bf16_f32 v25, v34, v35
 v_lshlrev_b32 v36, 16, v86
 v_mfma_f32_16x16x32_bf16 a[96:99], a[188:191], a[252:255], a[96:99]
 ds_read_b128 a[252:255], v7 offset:56320
 v_and_b32 v37, s34, v86
 v_lshlrev_b32 v38, 16, v90
 v_and_b32 v39, s34, v90
 s_waitcnt lgkmcnt(3)
 v_mfma_f32_16x16x32_bf16 v[116:119], a[192:195], a[240:243], v[116:119]
 v_lshlrev_b32 v44, 16, v94
 v_and_b32 v45, s34, v94
 v_lshlrev_b32 v46, 16, v98
 v_and_b32 v47, s34, v98
 v_mfma_f32_16x16x32_bf16 v[132:135], a[196:199], a[240:243], v[132:135]
 buffer_load_dwordx4 a[176:179], v1, s[20:23], s52 offen offset:0
 v_fma_f32 v28, s39, v38, v46
 v_mfma_f32_16x16x32_bf16 v[148:151], a[200:203], a[240:243], v[148:151]
 v_fma_f32 v29, s39, v39, v47
 v_fma_f32 v30, s39, v36, v44
 v_fma_f32 v31, s39, v37, v45
 v_fma_f32 v38, s40, v38, v46
 v_mfma_f32_16x16x32_bf16 v[164:167], a[204:207], a[240:243], v[164:167]
 ds_read_b128 a[240:243], v7 offset:57344
 v_fma_f32 v39, s40, v39, v47
 v_fma_f32 v36, s40, v36, v44
 v_fma_f32 v37, s40, v37, v45
 s_waitcnt lgkmcnt(3)
 v_mfma_f32_16x16x32_bf16 v[180:183], a[192:195], a[244:247], v[180:183]
 v_add_f32 v28, v28, v50
 v_add_f32 v29, v29, v51
 v_add_f32 v30, v30, v48
 v_add_f32 v31, v31, v49
 v_mfma_f32_16x16x32_bf16 v[196:199], a[196:199], a[244:247], v[196:199]
 buffer_load_dwordx4 a[180:183], v1, s[20:23], s52 offen offset:1024
 v_fmac_f32 v38, 4.0, v50
 v_mfma_f32_16x16x32_bf16 v[212:215], a[200:203], a[244:247], v[212:215]
 v_fmac_f32 v39, 4.0, v51
 v_fmac_f32 v36, 4.0, v48
 v_fmac_f32 v37, 4.0, v49
 v_add_f32 v48, v28, v30
 v_mfma_f32_16x16x32_bf16 v[228:231], a[204:207], a[244:247], v[228:231]
 ds_read_b128 a[244:247], v7 offset:58368
 v_add_f32 v49, v29, v31
 v_sub_f32 v28, v28, v30
 v_sub_f32 v29, v29, v31
 s_waitcnt lgkmcnt(3)
 v_mfma_f32_16x16x32_bf16 v[244:247], a[192:195], a[248:251], v[244:247]
 v_fma_f32 v50, 0.5, v36, v38
 v_fma_f32 v51, 0.5, v37, v39
 v_fma_f32 v38, -0.5, v36, v38
 v_mfma_f32_16x16x32_bf16 a[4:7], a[196:199], a[248:251], a[4:7]
 buffer_load_dwordx4 a[184:187], v1, s[20:23], s52 offen offset:2048
 v_fma_f32 v39, -0.5, v37, v39
 v_cvt_pk_bf16_f32 v14, v48, v49
 v_mfma_f32_16x16x32_bf16 a[20:23], a[200:203], a[248:251], a[20:23]
 v_cvt_pk_bf16_f32 v18, v28, v29
 v_cvt_pk_bf16_f32 v22, v50, v51
 v_cvt_pk_bf16_f32 v26, v38, v39
 v_lshlrev_b32 v40, 16, v87
 v_mfma_f32_16x16x32_bf16 a[36:39], a[204:207], a[248:251], a[36:39]
 ds_read_b128 a[248:251], v7 offset:59392
 v_and_b32 v41, s34, v87
 v_lshlrev_b32 v42, 16, v91
 s_waitcnt lgkmcnt(3)
 v_mfma_f32_16x16x32_bf16 a[52:55], a[192:195], a[252:255], a[52:55]
 v_and_b32 v43, s34, v91
 v_lshlrev_b32 v56, 16, v95
 v_and_b32 v57, s34, v95
 v_lshlrev_b32 v58, 16, v99
 v_mfma_f32_16x16x32_bf16 a[68:71], a[196:199], a[252:255], a[68:71]
 buffer_load_dwordx4 a[188:191], v1, s[20:23], s52 offen offset:3072
 v_and_b32 v59, s34, v99
 v_mfma_f32_16x16x32_bf16 a[84:87], a[200:203], a[252:255], a[84:87]
 v_mfma_f32_16x16x32_bf16 a[100:103], a[204:207], a[252:255], a[100:103]
 ds_read_b128 a[252:255], v7 offset:60416
 buffer_load_dwordx4 v[84:87], v2, s[16:19], s33 offen offset:0
 s_waitcnt vmcnt(29) lgkmcnt(3)
 v_mfma_f32_16x16x32_bf16 v[120:123], a[208:211], a[240:243], v[120:123]
 v_mfma_f32_16x16x32_bf16 v[136:139], a[212:215], a[240:243], v[136:139]
 buffer_load_dwordx4 a[192:195], v1, s[20:23], s53 offen offset:0
 v_mfma_f32_16x16x32_bf16 v[152:155], a[216:219], a[240:243], v[152:155]
 v_fma_f32 v32, s39, v42, v58
 v_fma_f32 v33, s39, v43, v59
 v_mfma_f32_16x16x32_bf16 v[168:171], a[220:223], a[240:243], v[168:171]
 ds_read_b128 a[240:243], v7 offset:61440
 v_fma_f32 v34, s39, v40, v56
 v_fma_f32 v35, s39, v41, v57
 v_fma_f32 v42, s40, v42, v58
 s_waitcnt lgkmcnt(3)
 v_mfma_f32_16x16x32_bf16 v[184:187], a[208:211], a[244:247], v[184:187]
 v_fma_f32 v43, s40, v43, v59
 v_fma_f32 v40, s40, v40, v56
 v_fma_f32 v41, s40, v41, v57
 v_add_f32 v32, v32, v62
 v_mfma_f32_16x16x32_bf16 v[200:203], a[212:215], a[244:247], v[200:203]
 buffer_load_dwordx4 a[196:199], v1, s[20:23], s53 offen offset:1024
 v_add_f32 v33, v33, v63
 v_mfma_f32_16x16x32_bf16 v[216:219], a[216:219], a[244:247], v[216:219]
 v_add_f32 v34, v34, v60
 v_add_f32 v35, v35, v61
 v_fmac_f32 v42, 4.0, v62
 v_fmac_f32 v43, 4.0, v63
 v_mfma_f32_16x16x32_bf16 v[232:235], a[220:223], a[244:247], v[232:235]
 ds_read_b128 a[244:247], v7 offset:62464
 buffer_load_dwordx4 v[88:91], v2, s[16:19], s33 offen offset:2048
 s_add_u32 s33, s33, 4096
 v_fmac_f32 v40, 4.0, v60
 v_fmac_f32 v41, 4.0, v61
 v_add_f32 v60, v32, v34
 s_waitcnt lgkmcnt(3)
 v_mfma_f32_16x16x32_bf16 v[248:251], a[208:211], a[248:251], v[248:251]
 v_add_f32 v61, v33, v35
 v_sub_f32 v32, v32, v34
 v_sub_f32 v33, v33, v35
 v_mfma_f32_16x16x32_bf16 a[8:11], a[212:215], a[248:251], a[8:11]
 buffer_load_dwordx4 a[200:203], v1, s[20:23], s53 offen offset:2048
 v_fma_f32 v62, 0.5, v40, v42
 v_fma_f32 v63, 0.5, v41, v43
 v_mfma_f32_16x16x32_bf16 a[24:27], a[216:219], a[248:251], a[24:27]
 v_fma_f32 v42, -0.5, v40, v42
 v_fma_f32 v43, -0.5, v41, v43
 v_cvt_pk_bf16_f32 v15, v60, v61
 v_cvt_pk_bf16_f32 v19, v32, v33
 v_mfma_f32_16x16x32_bf16 a[40:43], a[220:223], a[248:251], a[40:43]
 ds_read_b128 a[248:251], v7 offset:63488
 v_cvt_pk_bf16_f32 v23, v62, v63
 v_cvt_pk_bf16_f32 v27, v42, v43
 s_waitcnt lgkmcnt(3)
 v_mfma_f32_16x16x32_bf16 a[56:59], a[208:211], a[252:255], a[56:59]
 ds_write_b128 v8, v[12:15] offset:3072
 v_mfma_f32_16x16x32_bf16 a[72:75], a[212:215], a[252:255], a[72:75]
 buffer_load_dwordx4 a[204:207], v1, s[20:23], s53 offen offset:3072
 v_mfma_f32_16x16x32_bf16 a[88:91], a[216:219], a[252:255], a[88:91]
 ds_write_b128 v8, v[16:19] offset:7168
 v_mfma_f32_16x16x32_bf16 a[104:107], a[220:223], a[252:255], a[104:107]
 ds_read_b128 a[252:255], v7 offset:64512
 buffer_load_dwordx4 v[92:95], v2, s[16:19], s33 offen offset:0
 ds_write_b128 v8, v[20:23] offset:11264
 s_waitcnt vmcnt(31) lgkmcnt(6)
 v_mfma_f32_16x16x32_bf16 v[124:127], a[224:227], a[240:243], v[124:127]
 ds_write_b128 v8, v[24:27] offset:15360
 v_mfma_f32_16x16x32_bf16 v[140:143], a[228:231], a[240:243], v[140:143]
 buffer_load_dwordx4 a[208:211], v1, s[20:23], s54 offen offset:0
 v_mfma_f32_16x16x32_bf16 v[156:159], a[232:235], a[240:243], v[156:159]
 v_mfma_f32_16x16x32_bf16 v[172:175], a[236:239], a[240:243], v[172:175]
 s_waitcnt lgkmcnt(0)
 s_barrier
 v_xor_b32 v7, 0x10000, v7
 v_xor_b32 v8, 0x10000, v8
 ds_read_b128 a[240:243], v7 offset:0
 v_mfma_f32_16x16x32_bf16 v[188:191], a[224:227], a[244:247], v[188:191]
 v_mfma_f32_16x16x32_bf16 v[204:207], a[228:231], a[244:247], v[204:207]
 buffer_load_dwordx4 a[212:215], v1, s[20:23], s54 offen offset:1024
 v_mfma_f32_16x16x32_bf16 v[220:223], a[232:235], a[244:247], v[220:223]
 v_mfma_f32_16x16x32_bf16 v[236:239], a[236:239], a[244:247], v[236:239]
 ds_read_b128 a[244:247], v7 offset:1024
 buffer_load_dwordx4 v[96:99], v2, s[16:19], s33 offen offset:2048
 s_add_u32 s33, s33, 4096
 v_mfma_f32_16x16x32_bf16 v[252:255], a[224:227], a[248:251], v[252:255]
 v_mfma_f32_16x16x32_bf16 a[12:15], a[228:231], a[248:251], a[12:15]
 buffer_load_dwordx4 a[216:219], v1, s[20:23], s54 offen offset:2048
 v_mfma_f32_16x16x32_bf16 a[28:31], a[232:235], a[248:251], a[28:31]
 v_mfma_f32_16x16x32_bf16 a[44:47], a[236:239], a[248:251], a[44:47]
 ds_read_b128 a[248:251], v7 offset:2048
 v_mfma_f32_16x16x32_bf16 a[60:63], a[224:227], a[252:255], a[60:63]
 v_mfma_f32_16x16x32_bf16 a[76:79], a[228:231], a[252:255], a[76:79]
 buffer_load_dwordx4 a[220:223], v1, s[20:23], s54 offen offset:3072
 v_mfma_f32_16x16x32_bf16 a[92:95], a[232:235], a[252:255], a[92:95]
 v_mfma_f32_16x16x32_bf16 a[108:111], a[236:239], a[252:255], a[108:111]
 ds_read_b128 a[252:255], v7 offset:3072
 buffer_load_dwordx4 v[100:103], v2, s[16:19], s33 offen offset:0
 buffer_load_dwordx4 v[104:107], v2, s[16:19], s33 offen offset:2048
 s_add_u32 s33, s33, 4096
 s_add_u32 s31, s31, 1
 s_cmp_eq_u32 s31, 3
 s_cbranch_scc1 L_B2
 s_cmp_lg_u32 s31, 8
 s_cbranch_scc1 L_B1
 s_nop 7
 v_pk_add_f32 v[112:113], v[112:113], v[116:117]
 v_pk_add_f32 v[114:115], v[114:115], v[118:119]
 v_pk_add_f32 v[128:129], v[128:129], v[132:133]
 v_pk_add_f32 v[130:131], v[130:131], v[134:135]
 v_pk_add_f32 v[144:145], v[144:145], v[148:149]
 v_pk_add_f32 v[146:147], v[146:147], v[150:151]
 v_pk_add_f32 v[160:161], v[160:161], v[164:165]
 v_pk_add_f32 v[162:163], v[162:163], v[166:167]
 v_pk_fma_f32 v[116:117], v[116:117], -2.0, v[112:113] op_sel_hi:[1,0,1]
 v_pk_fma_f32 v[118:119], v[118:119], -2.0, v[114:115] op_sel_hi:[1,0,1]
 v_pk_fma_f32 v[132:133], v[132:133], -2.0, v[128:129] op_sel_hi:[1,0,1]
 v_pk_fma_f32 v[134:135], v[134:135], -2.0, v[130:131] op_sel_hi:[1,0,1]
 v_pk_fma_f32 v[148:149], v[148:149], -2.0, v[144:145] op_sel_hi:[1,0,1]
 v_pk_fma_f32 v[150:151], v[150:151], -2.0, v[146:147] op_sel_hi:[1,0,1]
 v_pk_fma_f32 v[164:165], v[164:165], -2.0, v[160:161] op_sel_hi:[1,0,1]
 v_pk_fma_f32 v[166:167], v[166:167], -2.0, v[162:163] op_sel_hi:[1,0,1]
 v_pk_fma_f32 v[120:121], v[112:113], s[80:81], v[120:121] op_sel_hi:[1,0,1]
 v_pk_fma_f32 v[122:123], v[114:115], s[80:81], v[122:123] op_sel_hi:[1,0,1]
 v_pk_fma_f32 v[136:137], v[128:129], s[80:81], v[136:137] op_sel_hi:[1,0,1]
 v_pk_fma_f32 v[138:139], v[130:131], s[80:81], v[138:139] op_sel_hi:[1,0,1]
 v_pk_fma_f32 v[152:153], v[144:145], s[80:81], v[152:153] op_sel_hi:[1,0,1]
 v_pk_fma_f32 v[154:155], v[146:147], s[80:81], v[154:155] op_sel_hi:[1,0,1]
 v_pk_fma_f32 v[168:169], v[160:161], s[80:81], v[168:169] op_sel_hi:[1,0,1]
 v_pk_fma_f32 v[170:171], v[162:163], s[80:81], v[170:171] op_sel_hi:[1,0,1]
 v_pk_fma_f32 v[124:125], v[116:117], s[82:83], v[124:125] op_sel_hi:[1,0,1]
 v_pk_fma_f32 v[126:127], v[118:119], s[82:83], v[126:127] op_sel_hi:[1,0,1]
 v_pk_fma_f32 v[140:141], v[132:133], s[82:83], v[140:141] op_sel_hi:[1,0,1]
 v_pk_fma_f32 v[142:143], v[134:135], s[82:83], v[142:143] op_sel_hi:[1,0,1]
 v_pk_fma_f32 v[156:157], v[148:149], s[82:83], v[156:157] op_sel_hi:[1,0,1]
 v_pk_fma_f32 v[158:159], v[150:151], s[82:83], v[158:159] op_sel_hi:[1,0,1]
 v_pk_fma_f32 v[172:173], v[164:165], s[82:83], v[172:173] op_sel_hi:[1,0,1]
 v_pk_fma_f32 v[174:175], v[166:167], s[82:83], v[174:175] op_sel_hi:[1,0,1]
 v_pk_mul_f32 v[120:121], v[120:121], s[60:61] op_sel_hi:[1,0]
 v_pk_mul_f32 v[122:123], v[122:123], s[60:61] op_sel_hi:[1,0]
 v_pk_mul_f32 v[136:137], v[136:137], s[60:61] op_sel_hi:[1,0]
 v_pk_mul_f32 v[138:139], v[138:139], s[60:61] op_sel_hi:[1,0]
 v_pk_mul_f32 v[152:153], v[152:153], s[62:63] op_sel_hi:[1,0]
 v_pk_mul_f32 v[154:155], v[154:155], s[62:63] op_sel_hi:[1,0]
 v_pk_mul_f32 v[168:169], v[168:169], s[62:63] op_sel_hi:[1,0]
 v_pk_mul_f32 v[170:171], v[170:171], s[62:63] op_sel_hi:[1,0]
 v_min_f32 v120, s35, v120
 v_min_f32 v121, s35, v121
 v_min_f32 v122, s35, v122
 v_min_f32 v123, s35, v123
 v_min_f32 v136, s35, v136
 v_min_f32 v137, s35, v137
 v_min_f32 v138, s35, v138
 v_min_f32 v139, s35, v139
 v_exp_f32 v152, v152
 v_exp_f32 v153, v153
 v_exp_f32 v154, v154
 v_exp_f32 v155, v155
 v_exp_f32 v168, v168
 v_exp_f32 v169, v169
 v_exp_f32 v170, v170
 v_exp_f32 v171, v171
 v_exp_f32 v120, v120
 v_exp_f32 v121, v121
 v_exp_f32 v122, v122
 v_exp_f32 v123, v123
 v_exp_f32 v136, v136
 v_exp_f32 v137, v137
 v_exp_f32 v138, v138
 v_exp_f32 v139, v139
 v_pk_fma_f32 v[120:121], v[120:121], s[72:73], s[72:73] op_sel_hi:[1,0,0]
 v_pk_fma_f32 v[122:123], v[122:123], s[72:73], s[72:73] op_sel_hi:[1,0,0]
 v_pk_fma_f32 v[136:137], v[136:137], s[72:73], s[72:73] op_sel_hi:[1,0,0]
 v_pk_fma_f32 v[138:139], v[138:139], s[72:73], s[72:73] op_sel_hi:[1,0,0]
 v_pk_fma_f32 v[152:153], v[120:121], v[152:153], v[120:121]
 v_pk_fma_f32 v[154:155], v[122:123], v[154:155], v[122:123]
 v_pk_fma_f32 v[168:169], v[136:137], v[168:169], v[136:137]
 v_pk_fma_f32 v[170:171], v[138:139], v[170:171], v[138:139]
 v_rcp_f32 v152, v152
 v_rcp_f32 v153, v153
 v_rcp_f32 v154, v154
 v_rcp_f32 v155, v155
 v_rcp_f32 v168, v168
 v_rcp_f32 v169, v169
 v_rcp_f32 v170, v170
 v_rcp_f32 v171, v171
 s_nop 0
 v_pk_fma_f32 v[120:121], v[120:121], v[152:153], v[152:153] neg_lo:[0,0,1] neg_hi:[0,0,1]
 v_pk_fma_f32 v[122:123], v[122:123], v[154:155], v[154:155] neg_lo:[0,0,1] neg_hi:[0,0,1]
 v_pk_fma_f32 v[136:137], v[136:137], v[168:169], v[168:169] neg_lo:[0,0,1] neg_hi:[0,0,1]
 v_pk_fma_f32 v[138:139], v[138:139], v[170:171], v[170:171] neg_lo:[0,0,1] neg_hi:[0,0,1]
 v_cvt_pk_bf16_f32 v152, v120, v136
 v_cvt_pk_bf16_f32 v153, v121, v137
 v_cvt_pk_bf16_f32 v154, v122, v138
 v_cvt_pk_bf16_f32 v155, v123, v139
 buffer_store_dwordx4 v[152:155], v9, s[24:27], s48 offen offset:0 nt
 v_pk_mul_f32 v[116:117], v[116:117], s[64:65] op_sel_hi:[1,0]
 v_pk_mul_f32 v[118:119], v[118:119], s[64:65] op_sel_hi:[1,0]
 v_pk_mul_f32 v[132:133], v[132:133], s[64:65] op_sel_hi:[1,0]
 v_pk_mul_f32 v[134:135], v[134:135], s[64:65] op_sel_hi:[1,0]
 v_pk_mul_f32 v[148:149], v[148:149], s[66:67] op_sel_hi:[1,0]
 v_pk_mul_f32 v[150:151], v[150:151], s[66:67] op_sel_hi:[1,0]
 v_pk_mul_f32 v[164:165], v[164:165], s[66:67] op_sel_hi:[1,0]
 v_pk_mul_f32 v[166:167], v[166:167], s[66:67] op_sel_hi:[1,0]
 v_min_f32 v116, s35, v116
 v_min_f32 v117, s35, v117
 v_min_f32 v118, s35, v118
 v_min_f32 v119, s35, v119
 v_min_f32 v132, s35, v132
 v_min_f32 v133, s35, v133
 v_min_f32 v134, s35, v134
 v_min_f32 v135, s35, v135
 v_exp_f32 v148, v148
 v_exp_f32 v149, v149
 v_exp_f32 v150, v150
 v_exp_f32 v151, v151
 v_exp_f32 v164, v164
 v_exp_f32 v165, v165
 v_exp_f32 v166, v166
 v_exp_f32 v167, v167
 v_exp_f32 v116, v116
 v_exp_f32 v117, v117
 v_exp_f32 v118, v118
 v_exp_f32 v119, v119
 v_exp_f32 v132, v132
 v_exp_f32 v133, v133
 v_exp_f32 v134, v134
 v_exp_f32 v135, v135
 v_pk_fma_f32 v[116:117], v[116:117], s[72:73], s[72:73] op_sel_hi:[1,0,0]
 v_pk_fma_f32 v[118:119], v[118:119], s[72:73], s[72:73] op_sel_hi:[1,0,0]
 v_pk_fma_f32 v[132:133], v[132:133], s[72:73], s[72:73] op_sel_hi:[1,0,0]
 v_pk_fma_f32 v[134:135], v[134:135], s[72:73], s[72:73] op_sel_hi:[1,0,0]
 v_pk_fma_f32 v[148:149], v[116:117], v[148:149], v[116:117]
 v_pk_fma_f32 v[150:151], v[118:119], v[150:151], v[118:119]
 v_pk_fma_f32 v[164:165], v[132:133], v[164:165], v[132:133]
 v_pk_fma_f32 v[166:167], v[134:135], v[166:167], v[134:135]
 v_rcp_f32 v148, v148
 v_rcp_f32 v149, v149
 v_rcp_f32 v150, v150
 v_rcp_f32 v151, v151
 v_rcp_f32 v164, v164
 v_rcp_f32 v165, v165
 v_rcp_f32 v166, v166
 v_rcp_f32 v167, v167
 s_nop 0
 v_pk_fma_f32 v[116:117], v[116:117], v[148:149], v[148:149] neg_lo:[0,0,1] neg_hi:[0,0,1]
 v_pk_fma_f32 v[118:119], v[118:119], v[150:151], v[150:151] neg_lo:[0,0,1] neg_hi:[0,0,1]
 v_pk_fma_f32 v[132:133], v[132:133], v[164:165], v[164:165] neg_lo:[0,0,1] neg_hi:[0,0,1]
 v_pk_fma_f32 v[134:135], v[134:135], v[166:167], v[166:167] neg_lo:[0,0,1] neg_hi:[0,0,1]
 v_cvt_pk_bf16_f32 v148, v116, v132
 v_cvt_pk_bf16_f32 v149, v117, v133
 v_cvt_pk_bf16_f32 v150, v118, v134
 v_cvt_pk_bf16_f32 v151, v119, v135
 buffer_store_dwordx4 v[148:151], v9, s[24:27], s48 offen offset:2048 nt
 v_pk_mul_f32 v[112:113], v[112:113], s[68:69] op_sel_hi:[1,0]
 v_pk_mul_f32 v[114:115], v[114:115], s[68:69] op_sel_hi:[1,0]
 v_pk_mul_f32 v[128:129], v[128:129], s[68:69] op_sel_hi:[1,0]
 v_pk_mul_f32 v[130:131], v[130:131], s[68:69] op_sel_hi:[1,0]
 v_pk_mul_f32 v[144:145], v[144:145], s[70:71] op_sel_hi:[1,0]
 v_pk_mul_f32 v[146:147], v[146:147], s[70:71] op_sel_hi:[1,0]
 v_pk_mul_f32 v[160:161], v[160:161], s[70:71] op_sel_hi:[1,0]
 v_pk_mul_f32 v[162:163], v[162:163], s[70:71] op_sel_hi:[1,0]
 v_min_f32 v112, s35, v112
 v_min_f32 v113, s35, v113
 v_min_f32 v114, s35, v114
 v_min_f32 v115, s35, v115
 v_min_f32 v128, s35, v128
 v_min_f32 v129, s35, v129
 v_min_f32 v130, s35, v130
 v_min_f32 v131, s35, v131
 v_exp_f32 v144, v144
 v_exp_f32 v145, v145
 v_exp_f32 v146, v146
 v_exp_f32 v147, v147
 v_exp_f32 v160, v160
 v_exp_f32 v161, v161
 v_exp_f32 v162, v162
 v_exp_f32 v163, v163
 v_exp_f32 v112, v112
 v_exp_f32 v113, v113
 v_exp_f32 v114, v114
 v_exp_f32 v115, v115
 v_exp_f32 v128, v128
 v_exp_f32 v129, v129
 v_exp_f32 v130, v130
 v_exp_f32 v131, v131
 v_pk_fma_f32 v[112:113], v[112:113], s[72:73], s[72:73] op_sel_hi:[1,0,0]
 v_pk_fma_f32 v[114:115], v[114:115], s[72:73], s[72:73] op_sel_hi:[1,0,0]
 v_pk_fma_f32 v[128:129], v[128:129], s[72:73], s[72:73] op_sel_hi:[1,0,0]
 v_pk_fma_f32 v[130:131], v[130:131], s[72:73], s[72:73] op_sel_hi:[1,0,0]
 v_pk_fma_f32 v[144:145], v[112:113], v[144:145], v[112:113]
 v_pk_fma_f32 v[146:147], v[114:115], v[146:147], v[114:115]
 v_pk_fma_f32 v[160:161], v[128:129], v[160:161], v[128:129]
 v_pk_fma_f32 v[162:163], v[130:131], v[162:163], v[130:131]
 v_rcp_f32 v144, v144
 v_rcp_f32 v145, v145
 v_rcp_f32 v146, v146
 v_rcp_f32 v147, v147
 v_rcp_f32 v160, v160
 v_rcp_f32 v161, v161
 v_rcp_f32 v162, v162
 v_rcp_f32 v163, v163
 s_nop 0
 v_pk_fma_f32 v[112:113], v[112:113], v[144:145], v[144:145] neg_lo:[0,0,1] neg_hi:[0,0,1]
 v_pk_fma_f32 v[114:115], v[114:115], v[146:147], v[146:147] neg_lo:[0,0,1] neg_hi:[0,0,1]
 v_pk_fma_f32 v[128:129], v[128:129], v[160:161], v[160:161] neg_lo:[0,0,1] neg_hi:[0,0,1]
 v_pk_fma_f32 v[130:131], v[130:131], v[162:163], v[162:163] neg_lo:[0,0,1] neg_hi:[0,0,1]
 v_cvt_pk_bf16_f32 v144, v112, v128
 v_cvt_pk_bf16_f32 v145, v113, v129
 v_cvt_pk_bf16_f32 v146, v114, v130
 v_cvt_pk_bf16_f32 v147, v115, v131
 buffer_store_dwordx4 v[144:147], v9, s[24:27], s49 offen offset:0 nt
 v_pk_mul_f32 v[124:125], v[124:125], s[60:61] op_sel_hi:[1,0]
 v_pk_mul_f32 v[126:127], v[126:127], s[60:61] op_sel_hi:[1,0]
 v_pk_mul_f32 v[140:141], v[140:141], s[60:61] op_sel_hi:[1,0]
 v_pk_mul_f32 v[142:143], v[142:143], s[60:61] op_sel_hi:[1,0]
 v_pk_mul_f32 v[156:157], v[156:157], s[62:63] op_sel_hi:[1,0]
 v_pk_mul_f32 v[158:159], v[158:159], s[62:63] op_sel_hi:[1,0]
 v_pk_mul_f32 v[172:173], v[172:173], s[62:63] op_sel_hi:[1,0]
 v_pk_mul_f32 v[174:175], v[174:175], s[62:63] op_sel_hi:[1,0]
 v_min_f32 v124, s35, v124
 v_min_f32 v125, s35, v125
 v_min_f32 v126, s35, v126
 v_min_f32 v127, s35, v127
 v_min_f32 v140, s35, v140
 v_min_f32 v141, s35, v141
 v_min_f32 v142, s35, v142
 v_min_f32 v143, s35, v143
 v_exp_f32 v156, v156
 v_exp_f32 v157, v157
 v_exp_f32 v158, v158
 v_exp_f32 v159, v159
 v_exp_f32 v172, v172
 v_exp_f32 v173, v173
 v_exp_f32 v174, v174
 v_exp_f32 v175, v175
 v_exp_f32 v124, v124
 v_exp_f32 v125, v125
 v_exp_f32 v126, v126
 v_exp_f32 v127, v127
 v_exp_f32 v140, v140
 v_exp_f32 v141, v141
 v_exp_f32 v142, v142
 v_exp_f32 v143, v143
 v_pk_fma_f32 v[124:125], v[124:125], s[72:73], s[72:73] op_sel_hi:[1,0,0]
 v_pk_fma_f32 v[126:127], v[126:127], s[72:73], s[72:73] op_sel_hi:[1,0,0]
 v_pk_fma_f32 v[140:141], v[140:141], s[72:73], s[72:73] op_sel_hi:[1,0,0]
 v_pk_fma_f32 v[142:143], v[142:143], s[72:73], s[72:73] op_sel_hi:[1,0,0]
 v_pk_fma_f32 v[156:157], v[124:125], v[156:157], v[124:125]
 v_pk_fma_f32 v[158:159], v[126:127], v[158:159], v[126:127]
 v_pk_fma_f32 v[172:173], v[140:141], v[172:173], v[140:141]
 v_pk_fma_f32 v[174:175], v[142:143], v[174:175], v[142:143]
 v_rcp_f32 v156, v156
 v_rcp_f32 v157, v157
 v_rcp_f32 v158, v158
 v_rcp_f32 v159, v159
 v_rcp_f32 v172, v172
 v_rcp_f32 v173, v173
 v_rcp_f32 v174, v174
 v_rcp_f32 v175, v175
 s_nop 0
 v_pk_fma_f32 v[124:125], v[124:125], v[156:157], v[156:157] neg_lo:[0,0,1] neg_hi:[0,0,1]
 v_pk_fma_f32 v[126:127], v[126:127], v[158:159], v[158:159] neg_lo:[0,0,1] neg_hi:[0,0,1]
 v_pk_fma_f32 v[140:141], v[140:141], v[172:173], v[172:173] neg_lo:[0,0,1] neg_hi:[0,0,1]
 v_pk_fma_f32 v[142:143], v[142:143], v[174:175], v[174:175] neg_lo:[0,0,1] neg_hi:[0,0,1]
 v_cvt_pk_bf16_f32 v156, v124, v140
 v_cvt_pk_bf16_f32 v157, v125, v141
 v_cvt_pk_bf16_f32 v158, v126, v142
 v_cvt_pk_bf16_f32 v159, v127, v143
 buffer_store_dwordx4 v[156:159], v9, s[24:27], s49 offen offset:2048 nt
 v_pk_add_f32 v[176:177], v[176:177], v[180:181]
 v_pk_add_f32 v[178:179], v[178:179], v[182:183]
 v_pk_add_f32 v[192:193], v[192:193], v[196:197]
 v_pk_add_f32 v[194:195], v[194:195], v[198:199]
 v_pk_add_f32 v[208:209], v[208:209], v[212:213]
 v_pk_add_f32 v[210:211], v[210:211], v[214:215]
 v_pk_add_f32 v[224:225], v[224:225], v[228:229]
 v_pk_add_f32 v[226:227], v[226:227], v[230:231]
 v_pk_fma_f32 v[180:181], v[180:181], -2.0, v[176:177] op_sel_hi:[1,0,1]
 v_pk_fma_f32 v[182:183], v[182:183], -2.0, v[178:179] op_sel_hi:[1,0,1]
 v_pk_fma_f32 v[196:197], v[196:197], -2.0, v[192:193] op_sel_hi:[1,0,1]
 v_pk_fma_f32 v[198:199], v[198:199], -2.0, v[194:195] op_sel_hi:[1,0,1]
 v_pk_fma_f32 v[212:213], v[212:213], -2.0, v[208:209] op_sel_hi:[1,0,1]
 v_pk_fma_f32 v[214:215], v[214:215], -2.0, v[210:211] op_sel_hi:[1,0,1]
 v_pk_fma_f32 v[228:229], v[228:229], -2.0, v[224:225] op_sel_hi:[1,0,1]
 v_pk_fma_f32 v[230:231], v[230:231], -2.0, v[226:227] op_sel_hi:[1,0,1]
 v_pk_fma_f32 v[184:185], v[176:177], s[80:81], v[184:185] op_sel_hi:[1,0,1]
 v_pk_fma_f32 v[186:187], v[178:179], s[80:81], v[186:187] op_sel_hi:[1,0,1]
 v_pk_fma_f32 v[200:201], v[192:193], s[80:81], v[200:201] op_sel_hi:[1,0,1]
 v_pk_fma_f32 v[202:203], v[194:195], s[80:81], v[202:203] op_sel_hi:[1,0,1]
 v_pk_fma_f32 v[216:217], v[208:209], s[80:81], v[216:217] op_sel_hi:[1,0,1]
 v_pk_fma_f32 v[218:219], v[210:211], s[80:81], v[218:219] op_sel_hi:[1,0,1]
 v_pk_fma_f32 v[232:233], v[224:225], s[80:81], v[232:233] op_sel_hi:[1,0,1]
 v_pk_fma_f32 v[234:235], v[226:227], s[80:81], v[234:235] op_sel_hi:[1,0,1]
 v_pk_fma_f32 v[188:189], v[180:181], s[82:83], v[188:189] op_sel_hi:[1,0,1]
 v_pk_fma_f32 v[190:191], v[182:183], s[82:83], v[190:191] op_sel_hi:[1,0,1]
 v_pk_fma_f32 v[204:205], v[196:197], s[82:83], v[204:205] op_sel_hi:[1,0,1]
 v_pk_fma_f32 v[206:207], v[198:199], s[82:83], v[206:207] op_sel_hi:[1,0,1]
 v_pk_fma_f32 v[220:221], v[212:213], s[82:83], v[220:221] op_sel_hi:[1,0,1]
 v_pk_fma_f32 v[222:223], v[214:215], s[82:83], v[222:223] op_sel_hi:[1,0,1]
 v_pk_fma_f32 v[236:237], v[228:229], s[82:83], v[236:237] op_sel_hi:[1,0,1]
 v_pk_fma_f32 v[238:239], v[230:231], s[82:83], v[238:239] op_sel_hi:[1,0,1]
 v_pk_mul_f32 v[184:185], v[184:185], s[60:61] op_sel_hi:[1,0]
 v_pk_mul_f32 v[186:187], v[186:187], s[60:61] op_sel_hi:[1,0]
 v_pk_mul_f32 v[200:201], v[200:201], s[60:61] op_sel_hi:[1,0]
 v_pk_mul_f32 v[202:203], v[202:203], s[60:61] op_sel_hi:[1,0]
 v_pk_mul_f32 v[216:217], v[216:217], s[62:63] op_sel_hi:[1,0]
 v_pk_mul_f32 v[218:219], v[218:219], s[62:63] op_sel_hi:[1,0]
 v_pk_mul_f32 v[232:233], v[232:233], s[62:63] op_sel_hi:[1,0]
 v_pk_mul_f32 v[234:235], v[234:235], s[62:63] op_sel_hi:[1,0]
 v_min_f32 v184, s35, v184
 v_min_f32 v185, s35, v185
 v_min_f32 v186, s35, v186
 v_min_f32 v187, s35, v187
 v_min_f32 v200, s35, v200
 v_min_f32 v201, s35, v201
 v_min_f32 v202, s35, v202
 v_min_f32 v203, s35, v203
 v_exp_f32 v216, v216
 v_exp_f32 v217, v217
 v_exp_f32 v218, v218
 v_exp_f32 v219, v219
 v_exp_f32 v232, v232
 v_exp_f32 v233, v233
 v_exp_f32 v234, v234
 v_exp_f32 v235, v235
 v_exp_f32 v184, v184
 v_exp_f32 v185, v185
 v_exp_f32 v186, v186
 v_exp_f32 v187, v187
 v_exp_f32 v200, v200
 v_exp_f32 v201, v201
 v_exp_f32 v202, v202
 v_exp_f32 v203, v203
 v_pk_fma_f32 v[184:185], v[184:185], s[72:73], s[72:73] op_sel_hi:[1,0,0]
 v_pk_fma_f32 v[186:187], v[186:187], s[72:73], s[72:73] op_sel_hi:[1,0,0]
 v_pk_fma_f32 v[200:201], v[200:201], s[72:73], s[72:73] op_sel_hi:[1,0,0]
 v_pk_fma_f32 v[202:203], v[202:203], s[72:73], s[72:73] op_sel_hi:[1,0,0]
 v_pk_fma_f32 v[216:217], v[184:185], v[216:217], v[184:185]
 v_pk_fma_f32 v[218:219], v[186:187], v[218:219], v[186:187]
 v_pk_fma_f32 v[232:233], v[200:201], v[232:233], v[200:201]
 v_pk_fma_f32 v[234:235], v[202:203], v[234:235], v[202:203]
 v_rcp_f32 v216, v216
 v_rcp_f32 v217, v217
 v_rcp_f32 v218, v218
 v_rcp_f32 v219, v219
 v_rcp_f32 v232, v232
 v_rcp_f32 v233, v233
 v_rcp_f32 v234, v234
 v_rcp_f32 v235, v235
 s_nop 0
 v_pk_fma_f32 v[184:185], v[184:185], v[216:217], v[216:217] neg_lo:[0,0,1] neg_hi:[0,0,1]
 v_pk_fma_f32 v[186:187], v[186:187], v[218:219], v[218:219] neg_lo:[0,0,1] neg_hi:[0,0,1]
 v_pk_fma_f32 v[200:201], v[200:201], v[232:233], v[232:233] neg_lo:[0,0,1] neg_hi:[0,0,1]
 v_pk_fma_f32 v[202:203], v[202:203], v[234:235], v[234:235] neg_lo:[0,0,1] neg_hi:[0,0,1]
 v_cvt_pk_bf16_f32 v216, v184, v200
 v_cvt_pk_bf16_f32 v217, v185, v201
 v_cvt_pk_bf16_f32 v218, v186, v202
 v_cvt_pk_bf16_f32 v219, v187, v203
 buffer_store_dwordx4 v[216:219], v9, s[24:27], s50 offen offset:0 nt
 v_pk_mul_f32 v[180:181], v[180:181], s[64:65] op_sel_hi:[1,0]
 v_pk_mul_f32 v[182:183], v[182:183], s[64:65] op_sel_hi:[1,0]
 v_pk_mul_f32 v[196:197], v[196:197], s[64:65] op_sel_hi:[1,0]
 v_pk_mul_f32 v[198:199], v[198:199], s[64:65] op_sel_hi:[1,0]
 v_pk_mul_f32 v[212:213], v[212:213], s[66:67] op_sel_hi:[1,0]
 v_pk_mul_f32 v[214:215], v[214:215], s[66:67] op_sel_hi:[1,0]
 v_pk_mul_f32 v[228:229], v[228:229], s[66:67] op_sel_hi:[1,0]
 v_pk_mul_f32 v[230:231], v[230:231], s[66:67] op_sel_hi:[1,0]
 v_min_f32 v180, s35, v180
 v_min_f32 v181, s35, v181
 v_min_f32 v182, s35, v182
 v_min_f32 v183, s35, v183
 v_min_f32 v196, s35, v196
 v_min_f32 v197, s35, v197
 v_min_f32 v198, s35, v198
 v_min_f32 v199, s35, v199
 v_exp_f32 v212, v212
 v_exp_f32 v213, v213
 v_exp_f32 v214, v214
 v_exp_f32 v215, v215
 v_exp_f32 v228, v228
 v_exp_f32 v229, v229
 v_exp_f32 v230, v230
 v_exp_f32 v231, v231
 v_exp_f32 v180, v180
 v_exp_f32 v181, v181
 v_exp_f32 v182, v182
 v_exp_f32 v183, v183
 v_exp_f32 v196, v196
 v_exp_f32 v197, v197
 v_exp_f32 v198, v198
 v_exp_f32 v199, v199
 v_pk_fma_f32 v[180:181], v[180:181], s[72:73], s[72:73] op_sel_hi:[1,0,0]
 v_pk_fma_f32 v[182:183], v[182:183], s[72:73], s[72:73] op_sel_hi:[1,0,0]
 v_pk_fma_f32 v[196:197], v[196:197], s[72:73], s[72:73] op_sel_hi:[1,0,0]
 v_pk_fma_f32 v[198:199], v[198:199], s[72:73], s[72:73] op_sel_hi:[1,0,0]
 v_pk_fma_f32 v[212:213], v[180:181], v[212:213], v[180:181]
 v_pk_fma_f32 v[214:215], v[182:183], v[214:215], v[182:183]
 v_pk_fma_f32 v[228:229], v[196:197], v[228:229], v[196:197]
 v_pk_fma_f32 v[230:231], v[198:199], v[230:231], v[198:199]
 v_rcp_f32 v212, v212
 v_rcp_f32 v213, v213
 v_rcp_f32 v214, v214
 v_rcp_f32 v215, v215
 v_rcp_f32 v228, v228
 v_rcp_f32 v229, v229
 v_rcp_f32 v230, v230
 v_rcp_f32 v231, v231
 s_nop 0
 v_pk_fma_f32 v[180:181], v[180:181], v[212:213], v[212:213] neg_lo:[0,0,1] neg_hi:[0,0,1]
 v_pk_fma_f32 v[182:183], v[182:183], v[214:215], v[214:215] neg_lo:[0,0,1] neg_hi:[0,0,1]
 v_pk_fma_f32 v[196:197], v[196:197], v[228:229], v[228:229] neg_lo:[0,0,1] neg_hi:[0,0,1]
 v_pk_fma_f32 v[198:199], v[198:199], v[230:231], v[230:231] neg_lo:[0,0,1] neg_hi:[0,0,1]
 v_cvt_pk_bf16_f32 v212, v180, v196
 v_cvt_pk_bf16_f32 v213, v181, v197
 v_cvt_pk_bf16_f32 v214, v182, v198
 v_cvt_pk_bf16_f32 v215, v183, v199
 buffer_store_dwordx4 v[212:215], v9, s[24:27], s50 offen offset:2048 nt
 v_pk_mul_f32 v[176:177], v[176:177], s[68:69] op_sel_hi:[1,0]
 v_pk_mul_f32 v[178:179], v[178:179], s[68:69] op_sel_hi:[1,0]
 v_pk_mul_f32 v[192:193], v[192:193], s[68:69] op_sel_hi:[1,0]
 v_pk_mul_f32 v[194:195], v[194:195], s[68:69] op_sel_hi:[1,0]
 v_pk_mul_f32 v[208:209], v[208:209], s[70:71] op_sel_hi:[1,0]
 v_pk_mul_f32 v[210:211], v[210:211], s[70:71] op_sel_hi:[1,0]
 v_pk_mul_f32 v[224:225], v[224:225], s[70:71] op_sel_hi:[1,0]
 v_pk_mul_f32 v[226:227], v[226:227], s[70:71] op_sel_hi:[1,0]
 v_min_f32 v176, s35, v176
 v_min_f32 v177, s35, v177
 v_min_f32 v178, s35, v178
 v_min_f32 v179, s35, v179
 v_min_f32 v192, s35, v192
 v_min_f32 v193, s35, v193
 v_min_f32 v194, s35, v194
 v_min_f32 v195, s35, v195
 v_exp_f32 v208, v208
 v_exp_f32 v209, v209
 v_exp_f32 v210, v210
 v_exp_f32 v211, v211
 v_exp_f32 v224, v224
 v_exp_f32 v225, v225
 v_exp_f32 v226, v226
 v_exp_f32 v227, v227
 v_exp_f32 v176, v176
 v_exp_f32 v177, v177
 v_exp_f32 v178, v178
 v_exp_f32 v179, v179
 v_exp_f32 v192, v192
 v_exp_f32 v193, v193
 v_exp_f32 v194, v194
 v_exp_f32 v195, v195
 v_pk_fma_f32 v[176:177], v[176:177], s[72:73], s[72:73] op_sel_hi:[1,0,0]
 v_pk_fma_f32 v[178:179], v[178:179], s[72:73], s[72:73] op_sel_hi:[1,0,0]
 v_pk_fma_f32 v[192:193], v[192:193], s[72:73], s[72:73] op_sel_hi:[1,0,0]
 v_pk_fma_f32 v[194:195], v[194:195], s[72:73], s[72:73] op_sel_hi:[1,0,0]
 v_pk_fma_f32 v[208:209], v[176:177], v[208:209], v[176:177]
 v_pk_fma_f32 v[210:211], v[178:179], v[210:211], v[178:179]
 v_pk_fma_f32 v[224:225], v[192:193], v[224:225], v[192:193]
 v_pk_fma_f32 v[226:227], v[194:195], v[226:227], v[194:195]
 v_rcp_f32 v208, v208
 v_rcp_f32 v209, v209
 v_rcp_f32 v210, v210
 v_rcp_f32 v211, v211
 v_rcp_f32 v224, v224
 v_rcp_f32 v225, v225
 v_rcp_f32 v226, v226
 v_rcp_f32 v227, v227
 s_nop 0
 v_pk_fma_f32 v[176:177], v[176:177], v[208:209], v[208:209] neg_lo:[0,0,1] neg_hi:[0,0,1]
 v_pk_fma_f32 v[178:179], v[178:179], v[210:211], v[210:211] neg_lo:[0,0,1] neg_hi:[0,0,1]
 v_pk_fma_f32 v[192:193], v[192:193], v[224:225], v[224:225] neg_lo:[0,0,1] neg_hi:[0,0,1]
 v_pk_fma_f32 v[194:195], v[194:195], v[226:227], v[226:227] neg_lo:[0,0,1] neg_hi:[0,0,1]
 v_cvt_pk_bf16_f32 v208, v176, v192
 v_cvt_pk_bf16_f32 v209, v177, v193
 v_cvt_pk_bf16_f32 v210, v178, v194
 v_cvt_pk_bf16_f32 v211, v179, v195
 buffer_store_dwordx4 v[208:211], v9, s[24:27], s51 offen offset:0 nt
 v_pk_mul_f32 v[188:189], v[188:189], s[60:61] op_sel_hi:[1,0]
 v_pk_mul_f32 v[190:191], v[190:191], s[60:61] op_sel_hi:[1,0]
 v_pk_mul_f32 v[204:205], v[204:205], s[60:61] op_sel_hi:[1,0]
 v_pk_mul_f32 v[206:207], v[206:207], s[60:61] op_sel_hi:[1,0]
 v_pk_mul_f32 v[220:221], v[220:221], s[62:63] op_sel_hi:[1,0]
 v_pk_mul_f32 v[222:223], v[222:223], s[62:63] op_sel_hi:[1,0]
 v_pk_mul_f32 v[236:237], v[236:237], s[62:63] op_sel_hi:[1,0]
 v_pk_mul_f32 v[238:239], v[238:239], s[62:63] op_sel_hi:[1,0]
 v_min_f32 v188, s35, v188
 v_min_f32 v189, s35, v189
 v_min_f32 v190, s35, v190
 v_min_f32 v191, s35, v191
 v_min_f32 v204, s35, v204
 v_min_f32 v205, s35, v205
 v_min_f32 v206, s35, v206
 v_min_f32 v207, s35, v207
 v_exp_f32 v220, v220
 v_exp_f32 v221, v221
 v_exp_f32 v222, v222
 v_exp_f32 v223, v223
 v_exp_f32 v236, v236
 v_exp_f32 v237, v237
 v_exp_f32 v238, v238
 v_exp_f32 v239, v239
 v_exp_f32 v188, v188
 v_exp_f32 v189, v189
 v_exp_f32 v190, v190
 v_exp_f32 v191, v191
 v_exp_f32 v204, v204
 v_exp_f32 v205, v205
 v_exp_f32 v206, v206
 v_exp_f32 v207, v207
 v_pk_fma_f32 v[188:189], v[188:189], s[72:73], s[72:73] op_sel_hi:[1,0,0]
 v_pk_fma_f32 v[190:191], v[190:191], s[72:73], s[72:73] op_sel_hi:[1,0,0]
 v_pk_fma_f32 v[204:205], v[204:205], s[72:73], s[72:73] op_sel_hi:[1,0,0]
 v_pk_fma_f32 v[206:207], v[206:207], s[72:73], s[72:73] op_sel_hi:[1,0,0]
 v_pk_fma_f32 v[220:221], v[188:189], v[220:221], v[188:189]
 v_pk_fma_f32 v[222:223], v[190:191], v[222:223], v[190:191]
 v_pk_fma_f32 v[236:237], v[204:205], v[236:237], v[204:205]
 v_pk_fma_f32 v[238:239], v[206:207], v[238:239], v[206:207]
 v_rcp_f32 v220, v220
 v_rcp_f32 v221, v221
 v_rcp_f32 v222, v222
 v_rcp_f32 v223, v223
 v_rcp_f32 v236, v236
 v_rcp_f32 v237, v237
 v_rcp_f32 v238, v238
 v_rcp_f32 v239, v239
 s_nop 0
 v_pk_fma_f32 v[188:189], v[188:189], v[220:221], v[220:221] neg_lo:[0,0,1] neg_hi:[0,0,1]
 v_pk_fma_f32 v[190:191], v[190:191], v[222:223], v[222:223] neg_lo:[0,0,1] neg_hi:[0,0,1]
 v_pk_fma_f32 v[204:205], v[204:205], v[236:237], v[236:237] neg_lo:[0,0,1] neg_hi:[0,0,1]
 v_pk_fma_f32 v[206:207], v[206:207], v[238:239], v[238:239] neg_lo:[0,0,1] neg_hi:[0,0,1]
 v_cvt_pk_bf16_f32 v220, v188, v204
 v_cvt_pk_bf16_f32 v221, v189, v205
 v_cvt_pk_bf16_f32 v222, v190, v206
 v_cvt_pk_bf16_f32 v223, v191, v207
 buffer_store_dwordx4 v[220:223], v9, s[24:27], s51 offen offset:2048 nt
 v_accvgpr_read_b32 v128, a0
 v_accvgpr_read_b32 v129, a1
 v_accvgpr_read_b32 v130, a2
 v_accvgpr_read_b32 v131, a3
 v_accvgpr_read_b32 v132, a4
 v_accvgpr_read_b32 v133, a5
 v_accvgpr_read_b32 v134, a6
 v_accvgpr_read_b32 v135, a7
 v_accvgpr_read_b32 v136, a8
 v_accvgpr_read_b32 v137, a9
 v_accvgpr_read_b32 v138, a10
 v_accvgpr_read_b32 v139, a11
 v_accvgpr_read_b32 v140, a12
 v_accvgpr_read_b32 v141, a13
 v_accvgpr_read_b32 v142, a14
 v_accvgpr_read_b32 v143, a15
 v_accvgpr_read_b32 v144, a16
 v_accvgpr_read_b32 v145, a17
 v_accvgpr_read_b32 v146, a18
 v_accvgpr_read_b32 v147, a19
 v_accvgpr_read_b32 v148, a20
 v_accvgpr_read_b32 v149, a21
 v_accvgpr_read_b32 v150, a22
 v_accvgpr_read_b32 v151, a23
 v_accvgpr_read_b32 v152, a24
 v_accvgpr_read_b32 v153, a25
 v_accvgpr_read_b32 v154, a26
 v_accvgpr_read_b32 v155, a27
 v_accvgpr_read_b32 v156, a28
 v_accvgpr_read_b32 v157, a29
 v_accvgpr_read_b32 v158, a30
 v_accvgpr_read_b32 v159, a31
 v_accvgpr_read_b32 v160, a32
 v_accvgpr_read_b32 v161, a33
 v_accvgpr_read_b32 v162, a34
 v_accvgpr_read_b32 v163, a35
 v_accvgpr_read_b32 v164, a36
 v_accvgpr_read_b32 v165, a37
 v_accvgpr_read_b32 v166, a38
 v_accvgpr_read_b32 v167, a39
 v_accvgpr_read_b32 v168, a40
 v_accvgpr_read_b32 v169, a41
 v_accvgpr_read_b32 v170, a42
 v_accvgpr_read_b32 v171, a43
 v_accvgpr_read_b32 v172, a44
 v_accvgpr_read_b32 v173, a45
 v_accvgpr_read_b32 v174, a46
 v_accvgpr_read_b32 v175, a47
 v_pk_add_f32 v[240:241], v[240:241], v[244:245]
 v_pk_add_f32 v[242:243], v[242:243], v[246:247]
 v_pk_add_f32 v[128:129], v[128:129], v[132:133]
 v_pk_add_f32 v[130:131], v[130:131], v[134:135]
 v_pk_add_f32 v[144:145], v[144:145], v[148:149]
 v_pk_add_f32 v[146:147], v[146:147], v[150:151]
 v_pk_add_f32 v[160:161], v[160:161], v[164:165]
 v_pk_add_f32 v[162:163], v[162:163], v[166:167]
 v_pk_fma_f32 v[244:245], v[244:245], -2.0, v[240:241] op_sel_hi:[1,0,1]
 v_pk_fma_f32 v[246:247], v[246:247], -2.0, v[242:243] op_sel_hi:[1,0,1]
 v_pk_fma_f32 v[132:133], v[132:133], -2.0, v[128:129] op_sel_hi:[1,0,1]
 v_pk_fma_f32 v[134:135], v[134:135], -2.0, v[130:131] op_sel_hi:[1,0,1]
 v_pk_fma_f32 v[148:149], v[148:149], -2.0, v[144:145] op_sel_hi:[1,0,1]
 v_pk_fma_f32 v[150:151], v[150:151], -2.0, v[146:147] op_sel_hi:[1,0,1]
 v_pk_fma_f32 v[164:165], v[164:165], -2.0, v[160:161] op_sel_hi:[1,0,1]
 v_pk_fma_f32 v[166:167], v[166:167], -2.0, v[162:163] op_sel_hi:[1,0,1]
 v_pk_fma_f32 v[248:249], v[240:241], s[80:81], v[248:249] op_sel_hi:[1,0,1]
 v_pk_fma_f32 v[250:251], v[242:243], s[80:81], v[250:251] op_sel_hi:[1,0,1]
 v_pk_fma_f32 v[136:137], v[128:129], s[80:81], v[136:137] op_sel_hi:[1,0,1]
 v_pk_fma_f32 v[138:139], v[130:131], s[80:81], v[138:139] op_sel_hi:[1,0,1]
 v_pk_fma_f32 v[152:153], v[144:145], s[80:81], v[152:153] op_sel_hi:[1,0,1]
 v_pk_fma_f32 v[154:155], v[146:147], s[80:81], v[154:155] op_sel_hi:[1,0,1]
 v_pk_fma_f32 v[168:169], v[160:161], s[80:81], v[168:169] op_sel_hi:[1,0,1]
 v_pk_fma_f32 v[170:171], v[162:163], s[80:81], v[170:171] op_sel_hi:[1,0,1]
 v_pk_fma_f32 v[252:253], v[244:245], s[82:83], v[252:253] op_sel_hi:[1,0,1]
 v_pk_fma_f32 v[254:255], v[246:247], s[82:83], v[254:255] op_sel_hi:[1,0,1]
 v_pk_fma_f32 v[140:141], v[132:133], s[82:83], v[140:141] op_sel_hi:[1,0,1]
 v_pk_fma_f32 v[142:143], v[134:135], s[82:83], v[142:143] op_sel_hi:[1,0,1]
 v_pk_fma_f32 v[156:157], v[148:149], s[82:83], v[156:157] op_sel_hi:[1,0,1]
 v_pk_fma_f32 v[158:159], v[150:151], s[82:83], v[158:159] op_sel_hi:[1,0,1]
 v_pk_fma_f32 v[172:173], v[164:165], s[82:83], v[172:173] op_sel_hi:[1,0,1]
 v_pk_fma_f32 v[174:175], v[166:167], s[82:83], v[174:175] op_sel_hi:[1,0,1]
 v_pk_mul_f32 v[248:249], v[248:249], s[60:61] op_sel_hi:[1,0]
 v_pk_mul_f32 v[250:251], v[250:251], s[60:61] op_sel_hi:[1,0]
 v_pk_mul_f32 v[136:137], v[136:137], s[60:61] op_sel_hi:[1,0]
 v_pk_mul_f32 v[138:139], v[138:139], s[60:61] op_sel_hi:[1,0]
 v_pk_mul_f32 v[152:153], v[152:153], s[62:63] op_sel_hi:[1,0]
 v_pk_mul_f32 v[154:155], v[154:155], s[62:63] op_sel_hi:[1,0]
 v_pk_mul_f32 v[168:169], v[168:169], s[62:63] op_sel_hi:[1,0]
 v_pk_mul_f32 v[170:171], v[170:171], s[62:63] op_sel_hi:[1,0]
 v_min_f32 v248, s35, v248
 v_min_f32 v249, s35, v249
 v_min_f32 v250, s35, v250
 v_min_f32 v251, s35, v251
 v_min_f32 v136, s35, v136
 v_min_f32 v137, s35, v137
 v_min_f32 v138, s35, v138
 v_min_f32 v139, s35, v139
 v_exp_f32 v152, v152
 v_exp_f32 v153, v153
 v_exp_f32 v154, v154
 v_exp_f32 v155, v155
 v_exp_f32 v168, v168
 v_exp_f32 v169, v169
 v_exp_f32 v170, v170
 v_exp_f32 v171, v171
 v_exp_f32 v248, v248
 v_exp_f32 v249, v249
 v_exp_f32 v250, v250
 v_exp_f32 v251, v251
 v_exp_f32 v136, v136
 v_exp_f32 v137, v137
 v_exp_f32 v138, v138
 v_exp_f32 v139, v139
 v_pk_fma_f32 v[248:249], v[248:249], s[72:73], s[72:73] op_sel_hi:[1,0,0]
 v_pk_fma_f32 v[250:251], v[250:251], s[72:73], s[72:73] op_sel_hi:[1,0,0]
 v_pk_fma_f32 v[136:137], v[136:137], s[72:73], s[72:73] op_sel_hi:[1,0,0]
 v_pk_fma_f32 v[138:139], v[138:139], s[72:73], s[72:73] op_sel_hi:[1,0,0]
 v_pk_fma_f32 v[152:153], v[248:249], v[152:153], v[248:249]
 v_pk_fma_f32 v[154:155], v[250:251], v[154:155], v[250:251]
 v_pk_fma_f32 v[168:169], v[136:137], v[168:169], v[136:137]
 v_pk_fma_f32 v[170:171], v[138:139], v[170:171], v[138:139]
 v_rcp_f32 v152, v152
 v_rcp_f32 v153, v153
 v_rcp_f32 v154, v154
 v_rcp_f32 v155, v155
 v_rcp_f32 v168, v168
 v_rcp_f32 v169, v169
 v_rcp_f32 v170, v170
 v_rcp_f32 v171, v171
 s_nop 0
 v_pk_fma_f32 v[248:249], v[248:249], v[152:153], v[152:153] neg_lo:[0,0,1] neg_hi:[0,0,1]
 v_pk_fma_f32 v[250:251], v[250:251], v[154:155], v[154:155] neg_lo:[0,0,1] neg_hi:[0,0,1]
 v_pk_fma_f32 v[136:137], v[136:137], v[168:169], v[168:169] neg_lo:[0,0,1] neg_hi:[0,0,1]
 v_pk_fma_f32 v[138:139], v[138:139], v[170:171], v[170:171] neg_lo:[0,0,1] neg_hi:[0,0,1]
 v_cvt_pk_bf16_f32 v152, v248, v136
 v_cvt_pk_bf16_f32 v153, v249, v137
 v_cvt_pk_bf16_f32 v154, v250, v138
 v_cvt_pk_bf16_f32 v155, v251, v139
 buffer_store_dwordx4 v[152:155], v9, s[24:27], s52 offen offset:0 nt
 v_pk_mul_f32 v[244:245], v[244:245], s[64:65] op_sel_hi:[1,0]
 v_pk_mul_f32 v[246:247], v[246:247], s[64:65] op_sel_hi:[1,0]
 v_pk_mul_f32 v[132:133], v[132:133], s[64:65] op_sel_hi:[1,0]
 v_pk_mul_f32 v[134:135], v[134:135], s[64:65] op_sel_hi:[1,0]
 v_pk_mul_f32 v[148:149], v[148:149], s[66:67] op_sel_hi:[1,0]
 v_pk_mul_f32 v[150:151], v[150:151], s[66:67] op_sel_hi:[1,0]
 v_pk_mul_f32 v[164:165], v[164:165], s[66:67] op_sel_hi:[1,0]
 v_pk_mul_f32 v[166:167], v[166:167], s[66:67] op_sel_hi:[1,0]
 v_min_f32 v244, s35, v244
 v_min_f32 v245, s35, v245
 v_min_f32 v246, s35, v246
 v_min_f32 v247, s35, v247
 v_min_f32 v132, s35, v132
 v_min_f32 v133, s35, v133
 v_min_f32 v134, s35, v134
 v_min_f32 v135, s35, v135
 v_exp_f32 v148, v148
 v_exp_f32 v149, v149
 v_exp_f32 v150, v150
 v_exp_f32 v151, v151
 v_exp_f32 v164, v164
 v_exp_f32 v165, v165
 v_exp_f32 v166, v166
 v_exp_f32 v167, v167
 v_exp_f32 v244, v244
 v_exp_f32 v245, v245
 v_exp_f32 v246, v246
 v_exp_f32 v247, v247
 v_exp_f32 v132, v132
 v_exp_f32 v133, v133
 v_exp_f32 v134, v134
 v_exp_f32 v135, v135
 v_pk_fma_f32 v[244:245], v[244:245], s[72:73], s[72:73] op_sel_hi:[1,0,0]
 v_pk_fma_f32 v[246:247], v[246:247], s[72:73], s[72:73] op_sel_hi:[1,0,0]
 v_pk_fma_f32 v[132:133], v[132:133], s[72:73], s[72:73] op_sel_hi:[1,0,0]
 v_pk_fma_f32 v[134:135], v[134:135], s[72:73], s[72:73] op_sel_hi:[1,0,0]
 v_pk_fma_f32 v[148:149], v[244:245], v[148:149], v[244:245]
 v_pk_fma_f32 v[150:151], v[246:247], v[150:151], v[246:247]
 v_pk_fma_f32 v[164:165], v[132:133], v[164:165], v[132:133]
 v_pk_fma_f32 v[166:167], v[134:135], v[166:167], v[134:135]
 v_rcp_f32 v148, v148
 v_rcp_f32 v149, v149
 v_rcp_f32 v150, v150
 v_rcp_f32 v151, v151
 v_rcp_f32 v164, v164
 v_rcp_f32 v165, v165
 v_rcp_f32 v166, v166
 v_rcp_f32 v167, v167
 s_nop 0
 v_pk_fma_f32 v[244:245], v[244:245], v[148:149], v[148:149] neg_lo:[0,0,1] neg_hi:[0,0,1]
 v_pk_fma_f32 v[246:247], v[246:247], v[150:151], v[150:151] neg_lo:[0,0,1] neg_hi:[0,0,1]
 v_pk_fma_f32 v[132:133], v[132:133], v[164:165], v[164:165] neg_lo:[0,0,1] neg_hi:[0,0,1]
 v_pk_fma_f32 v[134:135], v[134:135], v[166:167], v[166:167] neg_lo:[0,0,1] neg_hi:[0,0,1]
 v_cvt_pk_bf16_f32 v148, v244, v132
 v_cvt_pk_bf16_f32 v149, v245, v133
 v_cvt_pk_bf16_f32 v150, v246, v134
 v_cvt_pk_bf16_f32 v151, v247, v135
 buffer_store_dwordx4 v[148:151], v9, s[24:27], s52 offen offset:2048 nt
 v_pk_mul_f32 v[240:241], v[240:241], s[68:69] op_sel_hi:[1,0]
 v_pk_mul_f32 v[242:243], v[242:243], s[68:69] op_sel_hi:[1,0]
 v_pk_mul_f32 v[128:129], v[128:129], s[68:69] op_sel_hi:[1,0]
 v_pk_mul_f32 v[130:131], v[130:131], s[68:69] op_sel_hi:[1,0]
 v_pk_mul_f32 v[144:145], v[144:145], s[70:71] op_sel_hi:[1,0]
 v_pk_mul_f32 v[146:147], v[146:147], s[70:71] op_sel_hi:[1,0]
 v_pk_mul_f32 v[160:161], v[160:161], s[70:71] op_sel_hi:[1,0]
 v_pk_mul_f32 v[162:163], v[162:163], s[70:71] op_sel_hi:[1,0]
 v_min_f32 v240, s35, v240
 v_min_f32 v241, s35, v241
 v_min_f32 v242, s35, v242
 v_min_f32 v243, s35, v243
 v_min_f32 v128, s35, v128
 v_min_f32 v129, s35, v129
 v_min_f32 v130, s35, v130
 v_min_f32 v131, s35, v131
 v_exp_f32 v144, v144
 v_exp_f32 v145, v145
 v_exp_f32 v146, v146
 v_exp_f32 v147, v147
 v_exp_f32 v160, v160
 v_exp_f32 v161, v161
 v_exp_f32 v162, v162
 v_exp_f32 v163, v163
 v_exp_f32 v240, v240
 v_exp_f32 v241, v241
 v_exp_f32 v242, v242
 v_exp_f32 v243, v243
 v_exp_f32 v128, v128
 v_exp_f32 v129, v129
 v_exp_f32 v130, v130
 v_exp_f32 v131, v131
 v_pk_fma_f32 v[240:241], v[240:241], s[72:73], s[72:73] op_sel_hi:[1,0,0]
 v_pk_fma_f32 v[242:243], v[242:243], s[72:73], s[72:73] op_sel_hi:[1,0,0]
 v_pk_fma_f32 v[128:129], v[128:129], s[72:73], s[72:73] op_sel_hi:[1,0,0]
 v_pk_fma_f32 v[130:131], v[130:131], s[72:73], s[72:73] op_sel_hi:[1,0,0]
 v_pk_fma_f32 v[144:145], v[240:241], v[144:145], v[240:241]
 v_pk_fma_f32 v[146:147], v[242:243], v[146:147], v[242:243]
 v_pk_fma_f32 v[160:161], v[128:129], v[160:161], v[128:129]
 v_pk_fma_f32 v[162:163], v[130:131], v[162:163], v[130:131]
 v_rcp_f32 v144, v144
 v_rcp_f32 v145, v145
 v_rcp_f32 v146, v146
 v_rcp_f32 v147, v147
 v_rcp_f32 v160, v160
 v_rcp_f32 v161, v161
 v_rcp_f32 v162, v162
 v_rcp_f32 v163, v163
 s_nop 0
 v_pk_fma_f32 v[240:241], v[240:241], v[144:145], v[144:145] neg_lo:[0,0,1] neg_hi:[0,0,1]
 v_pk_fma_f32 v[242:243], v[242:243], v[146:147], v[146:147] neg_lo:[0,0,1] neg_hi:[0,0,1]
 v_pk_fma_f32 v[128:129], v[128:129], v[160:161], v[160:161] neg_lo:[0,0,1] neg_hi:[0,0,1]
 v_pk_fma_f32 v[130:131], v[130:131], v[162:163], v[162:163] neg_lo:[0,0,1] neg_hi:[0,0,1]
 v_cvt_pk_bf16_f32 v144, v240, v128
 v_cvt_pk_bf16_f32 v145, v241, v129
 v_cvt_pk_bf16_f32 v146, v242, v130
 v_cvt_pk_bf16_f32 v147, v243, v131
 buffer_store_dwordx4 v[144:147], v9, s[24:27], s53 offen offset:0 nt
 v_pk_mul_f32 v[252:253], v[252:253], s[60:61] op_sel_hi:[1,0]
 v_pk_mul_f32 v[254:255], v[254:255], s[60:61] op_sel_hi:[1,0]
 v_pk_mul_f32 v[140:141], v[140:141], s[60:61] op_sel_hi:[1,0]
 v_pk_mul_f32 v[142:143], v[142:143], s[60:61] op_sel_hi:[1,0]
 v_pk_mul_f32 v[156:157], v[156:157], s[62:63] op_sel_hi:[1,0]
 v_pk_mul_f32 v[158:159], v[158:159], s[62:63] op_sel_hi:[1,0]
 v_pk_mul_f32 v[172:173], v[172:173], s[62:63] op_sel_hi:[1,0]
 v_pk_mul_f32 v[174:175], v[174:175], s[62:63] op_sel_hi:[1,0]
 v_min_f32 v252, s35, v252
 v_min_f32 v253, s35, v253
 v_min_f32 v254, s35, v254
 v_min_f32 v255, s35, v255
 v_min_f32 v140, s35, v140
 v_min_f32 v141, s35, v141
 v_min_f32 v142, s35, v142
 v_min_f32 v143, s35, v143
 v_exp_f32 v156, v156
 v_exp_f32 v157, v157
 v_exp_f32 v158, v158
 v_exp_f32 v159, v159
 v_exp_f32 v172, v172
 v_exp_f32 v173, v173
 v_exp_f32 v174, v174
 v_exp_f32 v175, v175
 v_exp_f32 v252, v252
 v_exp_f32 v253, v253
 v_exp_f32 v254, v254
 v_exp_f32 v255, v255
 v_exp_f32 v140, v140
 v_exp_f32 v141, v141
 v_exp_f32 v142, v142
 v_exp_f32 v143, v143
 v_pk_fma_f32 v[252:253], v[252:253], s[72:73], s[72:73] op_sel_hi:[1,0,0]
 v_pk_fma_f32 v[254:255], v[254:255], s[72:73], s[72:73] op_sel_hi:[1,0,0]
 v_pk_fma_f32 v[140:141], v[140:141], s[72:73], s[72:73] op_sel_hi:[1,0,0]
 v_pk_fma_f32 v[142:143], v[142:143], s[72:73], s[72:73] op_sel_hi:[1,0,0]
 v_pk_fma_f32 v[156:157], v[252:253], v[156:157], v[252:253]
 v_pk_fma_f32 v[158:159], v[254:255], v[158:159], v[254:255]
 v_pk_fma_f32 v[172:173], v[140:141], v[172:173], v[140:141]
 v_pk_fma_f32 v[174:175], v[142:143], v[174:175], v[142:143]
 v_rcp_f32 v156, v156
 v_rcp_f32 v157, v157
 v_rcp_f32 v158, v158
 v_rcp_f32 v159, v159
 v_rcp_f32 v172, v172
 v_rcp_f32 v173, v173
 v_rcp_f32 v174, v174
 v_rcp_f32 v175, v175
 s_nop 0
 v_pk_fma_f32 v[252:253], v[252:253], v[156:157], v[156:157] neg_lo:[0,0,1] neg_hi:[0,0,1]
 v_pk_fma_f32 v[254:255], v[254:255], v[158:159], v[158:159] neg_lo:[0,0,1] neg_hi:[0,0,1]
 v_pk_fma_f32 v[140:141], v[140:141], v[172:173], v[172:173] neg_lo:[0,0,1] neg_hi:[0,0,1]
 v_pk_fma_f32 v[142:143], v[142:143], v[174:175], v[174:175] neg_lo:[0,0,1] neg_hi:[0,0,1]
 v_cvt_pk_bf16_f32 v156, v252, v140
 v_cvt_pk_bf16_f32 v157, v253, v141
 v_cvt_pk_bf16_f32 v158, v254, v142
 v_cvt_pk_bf16_f32 v159, v255, v143
 buffer_store_dwordx4 v[156:159], v9, s[24:27], s53 offen offset:2048 nt
 v_accvgpr_read_b32 v176, a48
 v_accvgpr_read_b32 v177, a49
 v_accvgpr_read_b32 v178, a50
 v_accvgpr_read_b32 v179, a51
 v_accvgpr_read_b32 v180, a52
 v_accvgpr_read_b32 v181, a53
 v_accvgpr_read_b32 v182, a54
 v_accvgpr_read_b32 v183, a55
 v_accvgpr_read_b32 v184, a56
 v_accvgpr_read_b32 v185, a57
 v_accvgpr_read_b32 v186, a58
 v_accvgpr_read_b32 v187, a59
 v_accvgpr_read_b32 v188, a60
 v_accvgpr_read_b32 v189, a61
 v_accvgpr_read_b32 v190, a62
 v_accvgpr_read_b32 v191, a63
 v_accvgpr_read_b32 v192, a64
 v_accvgpr_read_b32 v193, a65
 v_accvgpr_read_b32 v194, a66
 v_accvgpr_read_b32 v195, a67
 v_accvgpr_read_b32 v196, a68
 v_accvgpr_read_b32 v197, a69
 v_accvgpr_read_b32 v198, a70
 v_accvgpr_read_b32 v199, a71
 v_accvgpr_read_b32 v200, a72
 v_accvgpr_read_b32 v201, a73
 v_accvgpr_read_b32 v202, a74
 v_accvgpr_read_b32 v203, a75
 v_accvgpr_read_b32 v204, a76
 v_accvgpr_read_b32 v205, a77
 v_accvgpr_read_b32 v206, a78
 v_accvgpr_read_b32 v207, a79
 v_accvgpr_read_b32 v208, a80
 v_accvgpr_read_b32 v209, a81
 v_accvgpr_read_b32 v210, a82
 v_accvgpr_read_b32 v211, a83
 v_accvgpr_read_b32 v212, a84
 v_accvgpr_read_b32 v213, a85
 v_accvgpr_read_b32 v214, a86
 v_accvgpr_read_b32 v215, a87
 v_accvgpr_read_b32 v216, a88
 v_accvgpr_read_b32 v217, a89
 v_accvgpr_read_b32 v218, a90
 v_accvgpr_read_b32 v219, a91
 v_accvgpr_read_b32 v220, a92
 v_accvgpr_read_b32 v221, a93
 v_accvgpr_read_b32 v222, a94
 v_accvgpr_read_b32 v223, a95
 v_accvgpr_read_b32 v224, a96
 v_accvgpr_read_b32 v225, a97
 v_accvgpr_read_b32 v226, a98
 v_accvgpr_read_b32 v227, a99
 v_accvgpr_read_b32 v228, a100
 v_accvgpr_read_b32 v229, a101
 v_accvgpr_read_b32 v230, a102
 v_accvgpr_read_b32 v231, a103
 v_accvgpr_read_b32 v232, a104
 v_accvgpr_read_b32 v233, a105
 v_accvgpr_read_b32 v234, a106
 v_accvgpr_read_b32 v235, a107
 v_accvgpr_read_b32 v236, a108
 v_accvgpr_read_b32 v237, a109
 v_accvgpr_read_b32 v238, a110
 v_accvgpr_read_b32 v239, a111
 v_pk_add_f32 v[176:177], v[176:177], v[180:181]
 v_pk_add_f32 v[178:179], v[178:179], v[182:183]
 v_pk_add_f32 v[192:193], v[192:193], v[196:197]
 v_pk_add_f32 v[194:195], v[194:195], v[198:199]
 v_pk_add_f32 v[208:209], v[208:209], v[212:213]
 v_pk_add_f32 v[210:211], v[210:211], v[214:215]
 v_pk_add_f32 v[224:225], v[224:225], v[228:229]
 v_pk_add_f32 v[226:227], v[226:227], v[230:231]
 v_pk_fma_f32 v[180:181], v[180:181], -2.0, v[176:177] op_sel_hi:[1,0,1]
 v_pk_fma_f32 v[182:183], v[182:183], -2.0, v[178:179] op_sel_hi:[1,0,1]
 v_pk_fma_f32 v[196:197], v[196:197], -2.0, v[192:193] op_sel_hi:[1,0,1]
 v_pk_fma_f32 v[198:199], v[198:199], -2.0, v[194:195] op_sel_hi:[1,0,1]
 v_pk_fma_f32 v[212:213], v[212:213], -2.0, v[208:209] op_sel_hi:[1,0,1]
 v_pk_fma_f32 v[214:215], v[214:215], -2.0, v[210:211] op_sel_hi:[1,0,1]
 v_pk_fma_f32 v[228:229], v[228:229], -2.0, v[224:225] op_sel_hi:[1,0,1]
 v_pk_fma_f32 v[230:231], v[230:231], -2.0, v[226:227] op_sel_hi:[1,0,1]
 v_pk_fma_f32 v[184:185], v[176:177], s[80:81], v[184:185] op_sel_hi:[1,0,1]
 v_pk_fma_f32 v[186:187], v[178:179], s[80:81], v[186:187] op_sel_hi:[1,0,1]
 v_pk_fma_f32 v[200:201], v[192:193], s[80:81], v[200:201] op_sel_hi:[1,0,1]
 v_pk_fma_f32 v[202:203], v[194:195], s[80:81], v[202:203] op_sel_hi:[1,0,1]
 v_pk_fma_f32 v[216:217], v[208:209], s[80:81], v[216:217] op_sel_hi:[1,0,1]
 v_pk_fma_f32 v[218:219], v[210:211], s[80:81], v[218:219] op_sel_hi:[1,0,1]
 v_pk_fma_f32 v[232:233], v[224:225], s[80:81], v[232:233] op_sel_hi:[1,0,1]
 v_pk_fma_f32 v[234:235], v[226:227], s[80:81], v[234:235] op_sel_hi:[1,0,1]
 v_pk_fma_f32 v[188:189], v[180:181], s[82:83], v[188:189] op_sel_hi:[1,0,1]
 v_pk_fma_f32 v[190:191], v[182:183], s[82:83], v[190:191] op_sel_hi:[1,0,1]
 v_pk_fma_f32 v[204:205], v[196:197], s[82:83], v[204:205] op_sel_hi:[1,0,1]
 v_pk_fma_f32 v[206:207], v[198:199], s[82:83], v[206:207] op_sel_hi:[1,0,1]
 v_pk_fma_f32 v[220:221], v[212:213], s[82:83], v[220:221] op_sel_hi:[1,0,1]
 v_pk_fma_f32 v[222:223], v[214:215], s[82:83], v[222:223] op_sel_hi:[1,0,1]
 v_pk_fma_f32 v[236:237], v[228:229], s[82:83], v[236:237] op_sel_hi:[1,0,1]
 v_pk_fma_f32 v[238:239], v[230:231], s[82:83], v[238:239] op_sel_hi:[1,0,1]
 v_pk_mul_f32 v[184:185], v[184:185], s[60:61] op_sel_hi:[1,0]
 v_pk_mul_f32 v[186:187], v[186:187], s[60:61] op_sel_hi:[1,0]
 v_pk_mul_f32 v[200:201], v[200:201], s[60:61] op_sel_hi:[1,0]
 v_pk_mul_f32 v[202:203], v[202:203], s[60:61] op_sel_hi:[1,0]
 v_pk_mul_f32 v[216:217], v[216:217], s[62:63] op_sel_hi:[1,0]
 v_pk_mul_f32 v[218:219], v[218:219], s[62:63] op_sel_hi:[1,0]
 v_pk_mul_f32 v[232:233], v[232:233], s[62:63] op_sel_hi:[1,0]
 v_pk_mul_f32 v[234:235], v[234:235], s[62:63] op_sel_hi:[1,0]
 v_min_f32 v184, s35, v184
 v_min_f32 v185, s35, v185
 v_min_f32 v186, s35, v186
 v_min_f32 v187, s35, v187
 v_min_f32 v200, s35, v200
 v_min_f32 v201, s35, v201
 v_min_f32 v202, s35, v202
 v_min_f32 v203, s35, v203
 v_exp_f32 v216, v216
 v_exp_f32 v217, v217
 v_exp_f32 v218, v218
 v_exp_f32 v219, v219
 v_exp_f32 v232, v232
 v_exp_f32 v233, v233
 v_exp_f32 v234, v234
 v_exp_f32 v235, v235
 v_exp_f32 v184, v184
 v_exp_f32 v185, v185
 v_exp_f32 v186, v186
 v_exp_f32 v187, v187
 v_exp_f32 v200, v200
 v_exp_f32 v201, v201
 v_exp_f32 v202, v202
 v_exp_f32 v203, v203
 v_pk_fma_f32 v[184:185], v[184:185], s[72:73], s[72:73] op_sel_hi:[1,0,0]
 v_pk_fma_f32 v[186:187], v[186:187], s[72:73], s[72:73] op_sel_hi:[1,0,0]
 v_pk_fma_f32 v[200:201], v[200:201], s[72:73], s[72:73] op_sel_hi:[1,0,0]
 v_pk_fma_f32 v[202:203], v[202:203], s[72:73], s[72:73] op_sel_hi:[1,0,0]
 v_pk_fma_f32 v[216:217], v[184:185], v[216:217], v[184:185]
 v_pk_fma_f32 v[218:219], v[186:187], v[218:219], v[186:187]
 v_pk_fma_f32 v[232:233], v[200:201], v[232:233], v[200:201]
 v_pk_fma_f32 v[234:235], v[202:203], v[234:235], v[202:203]
 v_rcp_f32 v216, v216
 v_rcp_f32 v217, v217
 v_rcp_f32 v218, v218
 v_rcp_f32 v219, v219
 v_rcp_f32 v232, v232
 v_rcp_f32 v233, v233
 v_rcp_f32 v234, v234
 v_rcp_f32 v235, v235
 s_nop 0
 v_pk_fma_f32 v[184:185], v[184:185], v[216:217], v[216:217] neg_lo:[0,0,1] neg_hi:[0,0,1]
 v_pk_fma_f32 v[186:187], v[186:187], v[218:219], v[218:219] neg_lo:[0,0,1] neg_hi:[0,0,1]
 v_pk_fma_f32 v[200:201], v[200:201], v[232:233], v[232:233] neg_lo:[0,0,1] neg_hi:[0,0,1]
 v_pk_fma_f32 v[202:203], v[202:203], v[234:235], v[234:235] neg_lo:[0,0,1] neg_hi:[0,0,1]
 v_cvt_pk_bf16_f32 v216, v184, v200
 v_cvt_pk_bf16_f32 v217, v185, v201
 v_cvt_pk_bf16_f32 v218, v186, v202
 v_cvt_pk_bf16_f32 v219, v187, v203
 buffer_store_dwordx4 v[216:219], v9, s[24:27], s54 offen offset:0 nt
 v_pk_mul_f32 v[180:181], v[180:181], s[64:65] op_sel_hi:[1,0]
 v_pk_mul_f32 v[182:183], v[182:183], s[64:65] op_sel_hi:[1,0]
 v_pk_mul_f32 v[196:197], v[196:197], s[64:65] op_sel_hi:[1,0]
 v_pk_mul_f32 v[198:199], v[198:199], s[64:65] op_sel_hi:[1,0]
 v_pk_mul_f32 v[212:213], v[212:213], s[66:67] op_sel_hi:[1,0]
 v_pk_mul_f32 v[214:215], v[214:215], s[66:67] op_sel_hi:[1,0]
 v_pk_mul_f32 v[228:229], v[228:229], s[66:67] op_sel_hi:[1,0]
 v_pk_mul_f32 v[230:231], v[230:231], s[66:67] op_sel_hi:[1,0]
 v_min_f32 v180, s35, v180
 v_min_f32 v181, s35, v181
 v_min_f32 v182, s35, v182
 v_min_f32 v183, s35, v183
 v_min_f32 v196, s35, v196
 v_min_f32 v197, s35, v197
 v_min_f32 v198, s35, v198
 v_min_f32 v199, s35, v199
 v_exp_f32 v212, v212
 v_exp_f32 v213, v213
 v_exp_f32 v214, v214
 v_exp_f32 v215, v215
 v_exp_f32 v228, v228
 v_exp_f32 v229, v229
 v_exp_f32 v230, v230
 v_exp_f32 v231, v231
 v_exp_f32 v180, v180
 v_exp_f32 v181, v181
 v_exp_f32 v182, v182
 v_exp_f32 v183, v183
 v_exp_f32 v196, v196
 v_exp_f32 v197, v197
 v_exp_f32 v198, v198
 v_exp_f32 v199, v199
 v_pk_fma_f32 v[180:181], v[180:181], s[72:73], s[72:73] op_sel_hi:[1,0,0]
 v_pk_fma_f32 v[182:183], v[182:183], s[72:73], s[72:73] op_sel_hi:[1,0,0]
 v_pk_fma_f32 v[196:197], v[196:197], s[72:73], s[72:73] op_sel_hi:[1,0,0]
 v_pk_fma_f32 v[198:199], v[198:199], s[72:73], s[72:73] op_sel_hi:[1,0,0]
 v_pk_fma_f32 v[212:213], v[180:181], v[212:213], v[180:181]
 v_pk_fma_f32 v[214:215], v[182:183], v[214:215], v[182:183]
 v_pk_fma_f32 v[228:229], v[196:197], v[228:229], v[196:197]
 v_pk_fma_f32 v[230:231], v[198:199], v[230:231], v[198:199]
 v_rcp_f32 v212, v212
 v_rcp_f32 v213, v213
 v_rcp_f32 v214, v214
 v_rcp_f32 v215, v215
 v_rcp_f32 v228, v228
 v_rcp_f32 v229, v229
 v_rcp_f32 v230, v230
 v_rcp_f32 v231, v231
 s_nop 0
 v_pk_fma_f32 v[180:181], v[180:181], v[212:213], v[212:213] neg_lo:[0,0,1] neg_hi:[0,0,1]
 v_pk_fma_f32 v[182:183], v[182:183], v[214:215], v[214:215] neg_lo:[0,0,1] neg_hi:[0,0,1]
 v_pk_fma_f32 v[196:197], v[196:197], v[228:229], v[228:229] neg_lo:[0,0,1] neg_hi:[0,0,1]
 v_pk_fma_f32 v[198:199], v[198:199], v[230:231], v[230:231] neg_lo:[0,0,1] neg_hi:[0,0,1]
 v_cvt_pk_bf16_f32 v212, v180, v196
 v_cvt_pk_bf16_f32 v213, v181, v197
 v_cvt_pk_bf16_f32 v214, v182, v198
 v_cvt_pk_bf16_f32 v215, v183, v199
 buffer_store_dwordx4 v[212:215], v9, s[24:27], s54 offen offset:2048 nt
 v_pk_mul_f32 v[176:177], v[176:177], s[68:69] op_sel_hi:[1,0]
 v_pk_mul_f32 v[178:179], v[178:179], s[68:69] op_sel_hi:[1,0]
 v_pk_mul_f32 v[192:193], v[192:193], s[68:69] op_sel_hi:[1,0]
 v_pk_mul_f32 v[194:195], v[194:195], s[68:69] op_sel_hi:[1,0]
 v_pk_mul_f32 v[208:209], v[208:209], s[70:71] op_sel_hi:[1,0]
 v_pk_mul_f32 v[210:211], v[210:211], s[70:71] op_sel_hi:[1,0]
 v_pk_mul_f32 v[224:225], v[224:225], s[70:71] op_sel_hi:[1,0]
 v_pk_mul_f32 v[226:227], v[226:227], s[70:71] op_sel_hi:[1,0]
 v_min_f32 v176, s35, v176
 v_min_f32 v177, s35, v177
 v_min_f32 v178, s35, v178
 v_min_f32 v179, s35, v179
 v_min_f32 v192, s35, v192
 v_min_f32 v193, s35, v193
 v_min_f32 v194, s35, v194
 v_min_f32 v195, s35, v195
 v_exp_f32 v208, v208
 v_exp_f32 v209, v209
 v_exp_f32 v210, v210
 v_exp_f32 v211, v211
 v_exp_f32 v224, v224
 v_exp_f32 v225, v225
 v_exp_f32 v226, v226
 v_exp_f32 v227, v227
 v_exp_f32 v176, v176
 v_exp_f32 v177, v177
 v_exp_f32 v178, v178
 v_exp_f32 v179, v179
 v_exp_f32 v192, v192
 v_exp_f32 v193, v193
 v_exp_f32 v194, v194
 v_exp_f32 v195, v195
 v_pk_fma_f32 v[176:177], v[176:177], s[72:73], s[72:73] op_sel_hi:[1,0,0]
 v_pk_fma_f32 v[178:179], v[178:179], s[72:73], s[72:73] op_sel_hi:[1,0,0]
 v_pk_fma_f32 v[192:193], v[192:193], s[72:73], s[72:73] op_sel_hi:[1,0,0]
 v_pk_fma_f32 v[194:195], v[194:195], s[72:73], s[72:73] op_sel_hi:[1,0,0]
 v_pk_fma_f32 v[208:209], v[176:177], v[208:209], v[176:177]
 v_pk_fma_f32 v[210:211], v[178:179], v[210:211], v[178:179]
 v_pk_fma_f32 v[224:225], v[192:193], v[224:225], v[192:193]
 v_pk_fma_f32 v[226:227], v[194:195], v[226:227], v[194:195]
 v_rcp_f32 v208, v208
 v_rcp_f32 v209, v209
 v_rcp_f32 v210, v210
 v_rcp_f32 v211, v211
 v_rcp_f32 v224, v224
 v_rcp_f32 v225, v225
 v_rcp_f32 v226, v226
 v_rcp_f32 v227, v227
 s_nop 0
 v_pk_fma_f32 v[176:177], v[176:177], v[208:209], v[208:209] neg_lo:[0,0,1] neg_hi:[0,0,1]
 v_pk_fma_f32 v[178:179], v[178:179], v[210:211], v[210:211] neg_lo:[0,0,1] neg_hi:[0,0,1]
 v_pk_fma_f32 v[192:193], v[192:193], v[224:225], v[224:225] neg_lo:[0,0,1] neg_hi:[0,0,1]
 v_pk_fma_f32 v[194:195], v[194:195], v[226:227], v[226:227] neg_lo:[0,0,1] neg_hi:[0,0,1]
 v_cvt_pk_bf16_f32 v208, v176, v192
 v_cvt_pk_bf16_f32 v209, v177, v193
 v_cvt_pk_bf16_f32 v210, v178, v194
 v_cvt_pk_bf16_f32 v211, v179, v195
 buffer_store_dwordx4 v[208:211], v9, s[24:27], s55 offen offset:0 nt
 v_pk_mul_f32 v[188:189], v[188:189], s[60:61] op_sel_hi:[1,0]
 v_pk_mul_f32 v[190:191], v[190:191], s[60:61] op_sel_hi:[1,0]
 v_pk_mul_f32 v[204:205], v[204:205], s[60:61] op_sel_hi:[1,0]
 v_pk_mul_f32 v[206:207], v[206:207], s[60:61] op_sel_hi:[1,0]
 v_pk_mul_f32 v[220:221], v[220:221], s[62:63] op_sel_hi:[1,0]
 v_pk_mul_f32 v[222:223], v[222:223], s[62:63] op_sel_hi:[1,0]
 v_pk_mul_f32 v[236:237], v[236:237], s[62:63] op_sel_hi:[1,0]
 v_pk_mul_f32 v[238:239], v[238:239], s[62:63] op_sel_hi:[1,0]
 v_min_f32 v188, s35, v188
 v_min_f32 v189, s35, v189
 v_min_f32 v190, s35, v190
 v_min_f32 v191, s35, v191
 v_min_f32 v204, s35, v204
 v_min_f32 v205, s35, v205
 v_min_f32 v206, s35, v206
 v_min_f32 v207, s35, v207
 v_exp_f32 v220, v220
 v_exp_f32 v221, v221
 v_exp_f32 v222, v222
 v_exp_f32 v223, v223
 v_exp_f32 v236, v236
 v_exp_f32 v237, v237
 v_exp_f32 v238, v238
 v_exp_f32 v239, v239
 v_exp_f32 v188, v188
 v_exp_f32 v189, v189
 v_exp_f32 v190, v190
 v_exp_f32 v191, v191
 v_exp_f32 v204, v204
 v_exp_f32 v205, v205
 v_exp_f32 v206, v206
 v_exp_f32 v207, v207
 v_pk_fma_f32 v[188:189], v[188:189], s[72:73], s[72:73] op_sel_hi:[1,0,0]
 v_pk_fma_f32 v[190:191], v[190:191], s[72:73], s[72:73] op_sel_hi:[1,0,0]
 v_pk_fma_f32 v[204:205], v[204:205], s[72:73], s[72:73] op_sel_hi:[1,0,0]
 v_pk_fma_f32 v[206:207], v[206:207], s[72:73], s[72:73] op_sel_hi:[1,0,0]
 v_pk_fma_f32 v[220:221], v[188:189], v[220:221], v[188:189]
 v_pk_fma_f32 v[222:223], v[190:191], v[222:223], v[190:191]
 v_pk_fma_f32 v[236:237], v[204:205], v[236:237], v[204:205]
 v_pk_fma_f32 v[238:239], v[206:207], v[238:239], v[206:207]
 v_rcp_f32 v220, v220
 v_rcp_f32 v221, v221
 v_rcp_f32 v222, v222
 v_rcp_f32 v223, v223
 v_rcp_f32 v236, v236
 v_rcp_f32 v237, v237
 v_rcp_f32 v238, v238
 v_rcp_f32 v239, v239
 s_nop 0
 v_pk_fma_f32 v[188:189], v[188:189], v[220:221], v[220:221] neg_lo:[0,0,1] neg_hi:[0,0,1]
 v_pk_fma_f32 v[190:191], v[190:191], v[222:223], v[222:223] neg_lo:[0,0,1] neg_hi:[0,0,1]
 v_pk_fma_f32 v[204:205], v[204:205], v[236:237], v[236:237] neg_lo:[0,0,1] neg_hi:[0,0,1]
 v_pk_fma_f32 v[206:207], v[206:207], v[238:239], v[238:239] neg_lo:[0,0,1] neg_hi:[0,0,1]
 v_cvt_pk_bf16_f32 v220, v188, v204
 v_cvt_pk_bf16_f32 v221, v189, v205
 v_cvt_pk_bf16_f32 v222, v190, v206
 v_cvt_pk_bf16_f32 v223, v191, v207
 buffer_store_dwordx4 v[220:223], v9, s[24:27], s55 offen offset:2048 nt
 v_mov_b32 v9, v10
 s_sub_u32 s30, s30, 1
 s_cmp_lg_u32 s30, 0
 s_cbranch_scc1 L_TILE
 s_waitcnt vmcnt(0) lgkmcnt(0)
L_END:
 s_endpgm
.globl wprep_kernel
.p2align 8
.type wprep_kernel,@function
wprep_kernel:
 s_cmp_ge_u32 s2, 256
 s_cbranch_scc1 WP_END
 s_load_dwordx4 s[4:7], s[0:1], 0
 s_load_dwordx2 s[12:13], s[0:1], 32
 v_lshrrev_b32 v1, 6, v0
 v_and_b32 v2, 63, v0
 s_nop 0
 v_readfirstlane_b32 s92, v1
 s_and_b32 s80, s2, 7
 s_lshr_b32 s81, s2, 3
 s_and_b32 s82, s80, 1
 s_lshl_b32 s82, s82, 1
 s_and_b32 s84, s81, 1
 s_add_u32 s84, s84, s82
 s_lshr_b32 s80, s80, 1
 s_lshr_b32 s81, s81, 1
 s_mul_i32 s82, s80, 31
 s_and_b32 s83, s84, 1
 s_sub_u32 s83, 3, s83
 s_cmp_gt_u32 s80, s83
 s_cselect_b32 s83, 1, 0
 s_add_u32 s82, s82, s83
 s_add_u32 s82, s82, s81
 s_lshl_b32 s82, s82, 8
 s_lshl_b32 s84, s84, 6
 s_add_u32 s82, s82, s84
 v_lshrrev_b32 v108, 2, v0
 v_add_u32 v108, s82, v108
 v_lshlrev_b32 v109, 1, v108
 v_cmp_le_u32 vcc, 8000, v108
 v_mov_b32 v110, 15999
 s_nop 1
 v_cndmask_b32 v110, 0, v110, vcc
 v_sub_u32 v109, v109, v110
 v_cmp_le_u32 vcc, 16000, v108
 v_mov_b32 v110, 1
 s_nop 1
 v_cndmask_b32 v110, 0, v110, vcc
 v_sub_u32 v109, v109, v110
 v_cmp_le_u32 vcc, 24000, v108
 v_mov_b32 v110, 15999
 s_nop 1
 v_cndmask_b32 v110, 0, v110, vcc
 v_sub_u32 v109, v109, v110
 v_lshlrev_b32 v109, 10, v109
 v_and_b32 v108, 3, v0
 v_lshl_add_u32 v109, v108, 7, v109
 s_mov_b32 s84, 0
 s_and_b32 s29, s2, 3
 s_lshr_b32 s91, s2, 2
 s_mov_b32 s34, 0xffff0000
 v_lshrrev_b32 v4, 1, v2
 v_lshlrev_b32 v4, 2, v4
 v_and_b32 v7, 1, v2
 v_lshl_add_u32 v4, v7, 13, v4
 v_add_u32 v5, 4096, v4
 v_lshrrev_b32 v6, 5, v2
 v_lshlrev_b32 v6, 19, v6
 v_lshl_add_u32 v6, v7, 3, v6
 v_bfe_u32 v7, v2, 1, 4
 v_lshl_add_u32 v6, v7, 4, v6
 s_lshr_b32 s44, s92, 1
 s_lshl_b32 s45, s44, 10
 s_lshl_b32 s46, s29, 8
 s_add_u32 s45, s45, s46
 s_and_b32 s46, s92, 1
 s_lshl_b32 s46, s46, 7
 s_add_u32 s45, s45, s46
 s_lshl_b32 s46, s91, 14
 s_add_u32 s72, s45, s46
 s_add_u32 s73, s72, 1048576
 s_add_u32 s74, s72, 2097152
 s_add_u32 s75, s72, 3145728
 s_add_u32 s76, s72, 4194304
 s_waitcnt lgkmcnt(0)
 s_mov_b32 s64, s6
 s_and_b32 s65, s7, 0xffff
 s_mov_b32 s66, 5242880
 s_mov_b32 s67, 0x00020000
 s_mov_b32 s68, s12
 s_and_b32 s69, s13, 0xffff
 s_mov_b32 s70, 8388608
 s_mov_b32 s71, 0x00020000
 buffer_load_dword v8, v4, s[64:67], s72 offen offset:0
 buffer_load_dword v9, v4, s[64:67], s73 offen offset:0
 buffer_load_dword v10, v4, s[64:67], s74 offen offset:0
 buffer_load_dword v11, v4, s[64:67], s75 offen offset:0
 buffer_load_dword v12, v4, s[64:67], s76 offen offset:0
 buffer_load_dword v13, v4, s[64:67], s72 offen offset:2048
 buffer_load_dword v14, v4, s[64:67], s73 offen offset:2048
 buffer_load_dword v15, v4, s[64:67], s74 offen offset:2048
 buffer_load_dword v16, v4, s[64:67], s75 offen offset:2048
 buffer_load_dword v17, v4, s[64:67], s76 offen offset:2048
 buffer_load_dword v18, v5, s[64:67], s72 offen offset:0
 buffer_load_dword v19, v5, s[64:67], s73 offen offset:0
 buffer_load_dword v20, v5, s[64:67], s74 offen offset:0
 buffer_load_dword v21, v5, s[64:67], s75 offen offset:0
 buffer_load_dword v22, v5, s[64:67], s76 offen offset:0
 buffer_load_dword v23, v5, s[64:67], s72 offen offset:2048
 buffer_load_dword v24, v5, s[64:67], s73 offen offset:2048
 buffer_load_dword v25, v5, s[64:67], s74 offen offset:2048
 buffer_load_dword v26, v5, s[64:67], s75 offen offset:2048
 buffer_load_dword v27, v5, s[64:67], s76 offen offset:2048
 s_mov_b32 s16, s4
 s_and_b32 s17, s5, 0xffff
 s_mov_b32 s18, 32768000
 s_mov_b32 s19, 0x00020000
 buffer_load_dword v110, v109, s[16:19], s84 offen offset:0
 s_lshl_b32 s45, s29, 1
 s_and_b32 s44, s92, 1
 s_add_u32 s45, s45, s44
 s_lshl_b32 s45, s45, 20
 s_lshr_b32 s44, s92, 1
 s_lshl_b32 s44, s44, 11
 s_add_u32 s45, s45, s44
 s_lshr_b32 s44, s91, 2
 s_lshl_b32 s44, s44, 14
 s_add_u32 s45, s45, s44
 s_and_b32 s44, s91, 3
 s_lshl_b32 s44, s44, 8
 s_add_u32 s48, s45, s44
 s_add_u32 s49, s48, 4096
 s_add_u32 s50, s48, 8192
 s_add_u32 s51, s48, 12288
 s_add_u32 s52, s48, 262144
 s_add_u32 s53, s48, 266240
 s_add_u32 s54, s48, 270336
 s_add_u32 s55, s48, 274432
 s_mov_b32 s80, 0x3e800000
 s_mov_b32 s82, 0x3d800000
 s_mov_b32 s84, 0xbe2aaaab
 s_mov_b32 s86, 0x3faaaaab
 s_mov_b32 s88, 0x3f2aaaab
 s_mov_b32 s90, 0x3d888889
 s_mov_b32 s92, 0x3e088889
 s_mov_b32 s94, 0x41800000
 s_mov_b32 s96, 0x05040100
 s_mov_b32 s97, 0x07060302
 s_waitcnt vmcnt(11)
 v_lshlrev_b32 v28, 16, v8
 v_and_b32 v29, s34, v8
 v_lshlrev_b32 v30, 16, v9
 v_and_b32 v31, s34, v9
 v_lshlrev_b32 v32, 16, v10
 v_and_b32 v33, s34, v10
 v_lshlrev_b32 v34, 16, v11
 v_and_b32 v35, s34, v11
 v_lshlrev_b32 v36, 16, v12
 v_and_b32 v37, s34, v12
 v_pk_add_f32 v[38:39], v[28:29], v[32:33]
 v_pk_add_f32 v[40:41], v[30:31], v[34:35]
 v_pk_fma_f32 v[42:43], v[32:33], s[80:81], v[28:29] op_sel_hi:[1,0,1]
 v_pk_fma_f32 v[44:45], v[34:35], s[80:81], v[30:31] op_sel_hi:[1,0,1]
 v_pk_fma_f32 v[46:47], v[32:33], 4.0, v[28:29] op_sel_hi:[1,0,1]
 v_pk_fma_f32 v[48:49], v[34:35], 4.0, v[30:31] op_sel_hi:[1,0,1]
 v_pk_add_f32 v[38:39], v[38:39], v[36:37]
 v_pk_mul_f32 v[40:41], v[40:41], s[84:85] op_sel_hi:[1,0]
 v_pk_fma_f32 v[42:43], v[36:37], s[82:83], v[42:43] op_sel_hi:[1,0,1]
 v_pk_mul_f32 v[44:45], v[44:45], s[88:89] op_sel_hi:[1,0]
 v_pk_fma_f32 v[46:47], v[36:37], s[94:95], v[46:47] op_sel_hi:[1,0,1]
 v_pk_mul_f32 v[48:49], v[48:49], s[92:93] op_sel_hi:[1,0]
 v_pk_fma_f32 v[52:53], v[38:39], s[84:85], v[40:41] op_sel_hi:[1,0,1]
 v_pk_fma_f32 v[54:55], v[38:39], s[84:85], v[40:41] op_sel_hi:[1,0,1] neg_lo:[0,0,1] neg_hi:[0,0,1]
 v_pk_fma_f32 v[56:57], v[42:43], s[86:87], v[44:45] op_sel_hi:[1,0,1]
 v_pk_fma_f32 v[58:59], v[42:43], s[86:87], v[44:45] op_sel_hi:[1,0,1] neg_lo:[0,0,1] neg_hi:[0,0,1]
 v_pk_fma_f32 v[60:61], v[46:47], s[90:91], v[48:49] op_sel_hi:[1,0,1]
 v_pk_fma_f32 v[62:63], v[46:47], s[90:91], v[48:49] op_sel_hi:[1,0,1] neg_lo:[0,0,1] neg_hi:[0,0,1]
 v_lshlrev_b32 v28, 16, v13
 v_and_b32 v29, s34, v13
 v_lshlrev_b32 v30, 16, v14
 v_and_b32 v31, s34, v14
 v_lshlrev_b32 v32, 16, v15
 v_and_b32 v33, s34, v15
 v_lshlrev_b32 v34, 16, v16
 v_and_b32 v35, s34, v16
 v_lshlrev_b32 v36, 16, v17
 v_and_b32 v37, s34, v17
 v_pk_add_f32 v[38:39], v[28:29], v[32:33]
 v_pk_add_f32 v[40:41], v[30:31], v[34:35]
 v_pk_fma_f32 v[42:43], v[32:33], s[80:81], v[28:29] op_sel_hi:[1,0,1]
 v_pk_fma_f32 v[44:45], v[34:35], s[80:81], v[30:31] op_sel_hi:[1,0,1]
 v_pk_fma_f32 v[46:47], v[32:33], 4.0, v[28:29] op_sel_hi:[1,0,1]
 v_pk_fma_f32 v[48:49], v[34:35], 4.0, v[30:31] op_sel_hi:[1,0,1]
 v_pk_add_f32 v[38:39], v[38:39], v[36:37]
 v_pk_mul_f32 v[40:41], v[40:41], s[84:85] op_sel_hi:[1,0]
 v_pk_fma_f32 v[42:43], v[36:37], s[82:83], v[42:43] op_sel_hi:[1,0,1]
 v_pk_mul_f32 v[44:45], v[44:45], s[88:89] op_sel_hi:[1,0]
 v_pk_fma_f32 v[46:47], v[36:37], s[94:95], v[46:47] op_sel_hi:[1,0,1]
 v_pk_mul_f32 v[48:49], v[48:49], s[92:93] op_sel_hi:[1,0]
 v_pk_fma_f32 v[64:65], v[38:39], s[84:85], v[40:41] op_sel_hi:[1,0,1]
 v_pk_fma_f32 v[66:67], v[38:39], s[84:85], v[40:41] op_sel_hi:[1,0,1] neg_lo:[0,0,1] neg_hi:[0,0,1]
 v_pk_fma_f32 v[68:69], v[42:43], s[86:87], v[44:45] op_sel_hi:[1,0,1]
 v_pk_fma_f32 v[70:71], v[42:43], s[86:87], v[44:45] op_sel_hi:[1,0,1] neg_lo:[0,0,1] neg_hi:[0,0,1]
 v_pk_fma_f32 v[72:73], v[46:47], s[90:91], v[48:49] op_sel_hi:[1,0,1]
 v_pk_fma_f32 v[74:75], v[46:47], s[90:91], v[48:49] op_sel_hi:[1,0,1] neg_lo:[0,0,1] neg_hi:[0,0,1]
 v_cvt_pk_bf16_f32 v76, v52, v64
 v_cvt_pk_bf16_f32 v80, v54, v66
 v_cvt_pk_bf16_f32 v84, v56, v68
 v_cvt_pk_bf16_f32 v88, v58, v70
 v_cvt_pk_bf16_f32 v92, v60, v72
 v_cvt_pk_bf16_f32 v96, v62, v74
 v_perm_b32 v100, v13, v8, s96
 v_perm_b32 v104, v17, v12, s96
 v_cvt_pk_bf16_f32 v78, v53, v65
 v_cvt_pk_bf16_f32 v82, v55, v67
 v_cvt_pk_bf16_f32 v86, v57, v69
 v_cvt_pk_bf16_f32 v90, v59, v71
 v_cvt_pk_bf16_f32 v94, v61, v73
 v_cvt_pk_bf16_f32 v98, v63, v75
 v_perm_b32 v102, v13, v8, s97
 v_perm_b32 v106, v17, v12, s97
 s_waitcnt vmcnt(1)
 v_lshlrev_b32 v28, 16, v18
 v_and_b32 v29, s34, v18
 v_lshlrev_b32 v30, 16, v19
 v_and_b32 v31, s34, v19
 v_lshlrev_b32 v32, 16, v20
 v_and_b32 v33, s34, v20
 v_lshlrev_b32 v34, 16, v21
 v_and_b32 v35, s34, v21
 v_lshlrev_b32 v36, 16, v22
 v_and_b32 v37, s34, v22
 v_pk_add_f32 v[38:39], v[28:29], v[32:33]
 v_pk_add_f32 v[40:41], v[30:31], v[34:35]
 v_pk_fma_f32 v[42:43], v[32:33], s[80:81], v[28:29] op_sel_hi:[1,0,1]
 v_pk_fma_f32 v[44:45], v[34:35], s[80:81], v[30:31] op_sel_hi:[1,0,1]
 v_pk_fma_f32 v[46:47], v[32:33], 4.0, v[28:29] op_sel_hi:[1,0,1]
 v_pk_fma_f32 v[48:49], v[34:35], 4.0, v[30:31] op_sel_hi:[1,0,1]
 v_pk_add_f32 v[38:39], v[38:39], v[36:37]
 v_pk_mul_f32 v[40:41], v[40:41], s[84:85] op_sel_hi:[1,0]
 v_pk_fma_f32 v[42:43], v[36:37], s[82:83], v[42:43] op_sel_hi:[1,0,1]
 v_pk_mul_f32 v[44:45], v[44:45], s[88:89] op_sel_hi:[1,0]
 v_pk_fma_f32 v[46:47], v[36:37], s[94:95], v[46:47] op_sel_hi:[1,0,1]
 v_pk_mul_f32 v[48:49], v[48:49], s[92:93] op_sel_hi:[1,0]
 v_pk_fma_f32 v[52:53], v[38:39], s[84:85], v[40:41] op_sel_hi:[1,0,1]
 v_pk_fma_f32 v[54:55], v[38:39], s[84:85], v[40:41] op_sel_hi:[1,0,1] neg_lo:[0,0,1] neg_hi:[0,0,1]
 v_pk_fma_f32 v[56:57], v[42:43], s[86:87], v[44:45] op_sel_hi:[1,0,1]
 v_pk_fma_f32 v[58:59], v[42:43], s[86:87], v[44:45] op_sel_hi:[1,0,1] neg_lo:[0,0,1] neg_hi:[0,0,1]
 v_pk_fma_f32 v[60:61], v[46:47], s[90:91], v[48:49] op_sel_hi:[1,0,1]
 v_pk_fma_f32 v[62:63], v[46:47], s[90:91], v[48:49] op_sel_hi:[1,0,1] neg_lo:[0,0,1] neg_hi:[0,0,1]
 v_lshlrev_b32 v28, 16, v23
 v_and_b32 v29, s34, v23
 v_lshlrev_b32 v30, 16, v24
 v_and_b32 v31, s34, v24
 v_lshlrev_b32 v32, 16, v25
 v_and_b32 v33, s34, v25
 v_lshlrev_b32 v34, 16, v26
 v_and_b32 v35, s34, v26
 v_lshlrev_b32 v36, 16, v27
 v_and_b32 v37, s34, v27
 v_pk_add_f32 v[38:39], v[28:29], v[32:33]
 v_pk_add_f32 v[40:41], v[30:31], v[34:35]
 v_pk_fma_f32 v[42:43], v[32:33], s[80:81], v[28:29] op_sel_hi:[1,0,1]
 v_pk_fma_f32 v[44:45], v[34:35], s[80:81], v[30:31] op_sel_hi:[1,0,1]
 v_pk_fma_f32 v[46:47], v[32:33], 4.0, v[28:29] op_sel_hi:[1,0,1]
 v_pk_fma_f32 v[48:49], v[34:35], 4.0, v[30:31] op_sel_hi:[1,0,1]
 v_pk_add_f32 v[38:39], v[38:39], v[36:37]
 v_pk_mul_f32 v[40:41], v[40:41], s[84:85] op_sel_hi:[1,0]
 v_pk_fma_f32 v[42:43], v[36:37], s[82:83], v[42:43] op_sel_hi:[1,0,1]
 v_pk_mul_f32 v[44:45], v[44:45], s[88:89] op_sel_hi:[1,0]
 v_pk_fma_f32 v[46:47], v[36:37], s[94:95], v[46:47] op_sel_hi:[1,0,1]
 v_pk_mul_f32 v[48:49], v[48:49], s[92:93] op_sel_hi:[1,0]
 v_pk_fma_f32 v[64:65], v[38:39], s[84:85], v[40:41] op_sel_hi:[1,0,1]
 v_pk_fma_f32 v[66:67], v[38:39], s[84:85], v[40:41] op_sel_hi:[1,0,1] neg_lo:[0,0,1] neg_hi:[0,0,1]
 v_pk_fma_f32 v[68:69], v[42:43], s[86:87], v[44:45] op_sel_hi:[1,0,1]
 v_pk_fma_f32 v[70:71], v[42:43], s[86:87], v[44:45] op_sel_hi:[1,0,1] neg_lo:[0,0,1] neg_hi:[0,0,1]
 v_pk_fma_f32 v[72:73], v[46:47], s[90:91], v[48:49] op_sel_hi:[1,0,1]
 v_pk_fma_f32 v[74:75], v[46:47], s[90:91], v[48:49] op_sel_hi:[1,0,1] neg_lo:[0,0,1] neg_hi:[0,0,1]
 v_cvt_pk_bf16_f32 v77, v52, v64
 v_cvt_pk_bf16_f32 v81, v54, v66
 v_cvt_pk_bf16_f32 v85, v56, v68
 v_cvt_pk_bf16_f32 v89, v58, v70
 v_cvt_pk_bf16_f32 v93, v60, v72
 v_cvt_pk_bf16_f32 v97, v62, v74
 v_perm_b32 v101, v23, v18, s96
 v_perm_b32 v105, v27, v22, s96
 v_cvt_pk_bf16_f32 v79, v53, v65
 v_cvt_pk_bf16_f32 v83, v55, v67
 v_cvt_pk_bf16_f32 v87, v57, v69
 v_cvt_pk_bf16_f32 v91, v59, v71
 v_cvt_pk_bf16_f32 v95, v61, v73
 v_cvt_pk_bf16_f32 v99, v63, v75
 v_perm_b32 v103, v23, v18, s97
 v_perm_b32 v107, v27, v22, s97
 buffer_store_dwordx2 v[76:77], v6, s[68:71], s48 offen offset:0
 buffer_store_dwordx2 v[78:79], v6, s[68:71], s48 offen offset:1024
 buffer_store_dwordx2 v[80:81], v6, s[68:71], s49 offen offset:0
 buffer_store_dwordx2 v[82:83], v6, s[68:71], s49 offen offset:1024
 buffer_store_dwordx2 v[84:85], v6, s[68:71], s50 offen offset:0
 buffer_store_dwordx2 v[86:87], v6, s[68:71], s50 offen offset:1024
 buffer_store_dwordx2 v[88:89], v6, s[68:71], s51 offen offset:0
 buffer_store_dwordx2 v[90:91], v6, s[68:71], s51 offen offset:1024
 buffer_store_dwordx2 v[92:93], v6, s[68:71], s52 offen offset:0
 buffer_store_dwordx2 v[94:95], v6, s[68:71], s52 offen offset:1024
 buffer_store_dwordx2 v[96:97], v6, s[68:71], s53 offen offset:0
 buffer_store_dwordx2 v[98:99], v6, s[68:71], s53 offen offset:1024
 buffer_store_dwordx2 v[100:101], v6, s[68:71], s54 offen offset:0
 buffer_store_dwordx2 v[102:103], v6, s[68:71], s54 offen offset:1024
 buffer_store_dwordx2 v[104:105], v6, s[68:71], s55 offen offset:0
 buffer_store_dwordx2 v[106:107], v6, s[68:71], s55 offen offset:1024
 s_waitcnt vmcnt(0)
WP_END:
 s_endpgm
.section .rodata,"a"
.p2align 6
.amdhsa_kernel standalone__autoregressive_conv_wavernn__speech_kernel
  .amdhsa_next_free_vgpr 512
  .amdhsa_next_free_sgpr 102
  .amdhsa_accum_offset 256
  .amdhsa_group_segment_fixed_size 0
  .amdhsa_kernarg_size 40
  .amdhsa_user_sgpr_count 2
  .amdhsa_user_sgpr_kernarg_segment_ptr 1
  .amdhsa_system_sgpr_workgroup_id_x 1
.end_amdhsa_kernel
.p2align 6
.amdhsa_kernel wprep_kernel
  .amdhsa_next_free_vgpr 112
  .amdhsa_next_free_sgpr 102
  .amdhsa_accum_offset 112
  .amdhsa_group_segment_fixed_size 0
  .amdhsa_kernarg_size 40
  .amdhsa_user_sgpr_count 2
  .amdhsa_user_sgpr_kernarg_segment_ptr 1
  .amdhsa_system_sgpr_workgroup_id_x 1
.end_amdhsa_kernel
```
